```python
import torch

def _softmax(x, axis=-1):
    return torch.softmax(x, dim=axis)
def _gelu(x):
    return torch.nn.functional.gelu(x, approximate="tanh")
def _silu(x):
    return torch.nn.functional.silu(x)
def _sigmoid(x):
    return torch.sigmoid(x)
def _layernorm(x, axis=-1, eps=1e-5):
    m = x.mean(dim=axis, keepdim=True)
    v = x.var(dim=axis, keepdim=True, unbiased=False)
    return (x - m) / torch.sqrt(v + eps)
def _scatter_add(tgt, idx, src, axis=0):
    return tgt.clone().index_add_(axis, idx, src)
def _segment_sum(src, seg, n):
    out = torch.zeros((n,) + src.shape[1:], dtype=src.dtype)
    return out.index_add_(0, seg, src)
def _pad(x, pw):
    flat = tuple(v for pair in reversed(pw) for v in pair)
    return torch.nn.functional.pad(x, flat)

kernel_name = 'concat_heads__gqa_block_cached__gqa_block_cached__near_ridge'

def setup_inputs():

    _w = (lambda a: (lambda t: t.to(torch.bfloat16) if t.is_floating_point() else t)(torch.as_tensor(a)))
    def _A_setup():
        B, Sq, D = 8, 192, 640
        Hq, Hkv, Sk, Dh = 32, 32, 512, 192
        assert Hq % Hkv == 0, (Hq, Hkv)
        return {
            "x": _w((lambda *s: torch.randn(*s, dtype=torch.bfloat16) * 0.8)(B, Sq, D)),
            "k_cache": _w((lambda *s: torch.randn(*s, dtype=torch.bfloat16) * 0.8)(B, Hkv, Sk, Dh)),
            "v_cache": _w((lambda *s: torch.randn(*s, dtype=torch.bfloat16) * 0.05)(B, Hkv, Sk, Dh)),
            "wq": _w((lambda *s: torch.randn(*s, dtype=torch.bfloat16) * 0.8)(D, Hq * Dh) * (D ** -0.5)),
            "wo": _w((lambda *s: torch.randn(*s, dtype=torch.bfloat16) * 0.05)(Hq * Dh, D) * ((Hq * Dh) ** -0.5)),
        }
    _A_in = _A_setup()

    def _B_setup():
        B, Sq, D = 8, 192, 640
        Hq, Hkv, Sk, Dh = 32, 32, 512, 192
        assert Hq % Hkv == 0, (Hq, Hkv)
        return {
            "x": _w((lambda *s: torch.randn(*s, dtype=torch.bfloat16) * 0.8)(B, Sq, D)),
            "k_cache": _w((lambda *s: torch.randn(*s, dtype=torch.bfloat16) * 0.8)(B, Hkv, Sk, Dh)),
            "v_cache": _w((lambda *s: torch.randn(*s, dtype=torch.bfloat16) * 0.05)(B, Hkv, Sk, Dh)),
            "wq": _w((lambda *s: torch.randn(*s, dtype=torch.bfloat16) * 0.8)(D, Hq * Dh) * (D ** -0.5)),
            "wo": _w((lambda *s: torch.randn(*s, dtype=torch.bfloat16) * 0.05)(Hq * Dh, D) * ((Hq * Dh) ** -0.5)),
        }
    _B_in = _B_setup()

    return {
        "A_x": _A_in["x"],
        "A_k_cache": _A_in["k_cache"],
        "A_v_cache": _A_in["v_cache"],
        "A_wq": _A_in["wq"],
        "A_wo": _A_in["wo"],
        "B_x": _B_in["x"],
        "B_k_cache": _B_in["k_cache"],
        "B_v_cache": _B_in["v_cache"],
        "B_wq": _B_in["wq"],
        "B_wo": _B_in["wo"],
    }

def reference(A_x, A_k_cache, A_v_cache, A_wq, A_wo, B_x, B_k_cache, B_v_cache, B_wq, B_wo):
    def _A_ref(x, k_cache, v_cache, wq, wo):
        B, Sq, D = x.shape
        Hq, Dh = 32, 192
        Hkv = k_cache.shape[1]
        rep = Hq // Hkv
        q = (lambda x, *d: x.permute(*d))((x @ wq).reshape(B, Sq, Hq, Dh), 0, 2, 1, 3)
        k = (lambda x, n, axis: torch.repeat_interleave(x, n, dim=axis))(k_cache, rep, axis=1)
        v = (lambda x, n, axis: torch.repeat_interleave(x, n, dim=axis))(v_cache, rep, axis=1)
        scores = torch.einsum("bhqd,bhkd->bhqk", q, k) * (Dh ** -0.5)
        p = _softmax(scores, axis=-1)
        o = torch.einsum("bhqk,bhkd->bhqd", p, v)
        return (lambda x, *d: x.permute(*d))(o, 0, 2, 1, 3).reshape(B, Sq, Hq * Dh) @ wo

    def _B_ref(x, k_cache, v_cache, wq, wo):
        B, Sq, D = x.shape
        Hq, Dh = 32, 192
        Hkv = k_cache.shape[1]
        rep = Hq // Hkv
        q = (lambda x, *d: x.permute(*d))((x @ wq).reshape(B, Sq, Hq, Dh), 0, 2, 1, 3)
        k = (lambda x, n, axis: torch.repeat_interleave(x, n, dim=axis))(k_cache, rep, axis=1)
        v = (lambda x, n, axis: torch.repeat_interleave(x, n, dim=axis))(v_cache, rep, axis=1)
        scores = torch.einsum("bhqd,bhkd->bhqk", q, k) * (Dh ** -0.5)
        p = _softmax(scores, axis=-1)
        o = torch.einsum("bhqk,bhkd->bhqd", p, v)
        return (lambda x, *d: x.permute(*d))(o, 0, 2, 1, 3).reshape(B, Sq, Hq * Dh) @ wo

    a = _A_ref(A_x, A_k_cache, A_v_cache, A_wq, A_wo)
    b = _B_ref(B_x, B_k_cache, B_v_cache, B_wq, B_wo)
    return torch.concatenate([a, b], axis=-1)
```

```asm
; @launch kernel=attn_kernel grid=(256,1,1) block=(256,1,1) lds=147456
; @launch kernel=oproj_kernel grid=(256,1,1) block=(512,1,1) lds=147456
; @launch kernel=ored_kernel grid=(960,1,1) block=(256,1,1) lds=0
.amdgcn_target "amdgcn-amd-amdhsa--gfx950"
.text
.globl attn_kernel
.p2align 8
.type attn_kernel,@function
attn_kernel:
    s_cmp_ge_u32 s2, 256
    s_cbranch_scc1 L1_end
    s_load_dwordx16 s[4:19], s[0:1], 0
    s_load_dwordx4 s[20:23], s[0:1], 64
    s_load_dwordx2 s[24:25], s[0:1], 96
    s_and_b32 s67, s2, 7
    s_lshr_b32 s68, s2, 3
    s_lshr_b32 s52, s67, 2
    s_and_b32 s67, s67, 3
    s_lshl_b32 s67, s67, 2
    s_lshr_b32 s69, s68, 3
    s_add_u32 s67, s67, s69
    s_lshl_b32 s54, s67, 1
    s_and_b32 s53, s68, 7
    v_lshrrev_b32 v2, 6, v0
    v_and_b32 v1, 63, v0
    v_readfirstlane_b32 s55, v2
    s_nop 3
    s_mul_i32 s66, s55, 6144
    v_lshrrev_b32 v2, 4, v1
    v_and_b32 v3, 15, v1
    v_add_u32 v40, 0, v1
    v_mul_u32_u24 v41, 2731, v40
    v_lshrrev_b32 v41, 16, v41
    v_mul_u32_u24 v42, 24, v41
    v_sub_u32 v42, v40, v42
    v_xor_b32 v43, v42, v41
    v_and_b32 v43, 7, v43
    v_and_b32 v44, 24, v42
    v_or_b32 v43, v43, v44
    v_mul_u32_u24 v45, 384, v41
    v_lshl_add_u32 v45, v43, 4, v45
    v_add_u32 v45, s66, v45
    v_mov_b32 v4, v45
    v_and_b32 v43, 2, v41
    v_xor_b32 v43, v42, v43
    v_and_b32 v43, 7, v43
    v_or_b32 v43, v43, v44
    s_lshl_b32 s67, s55, 4
    v_add_u32 v45, 0, v41
    v_add_u32 v45, s67, v45
    v_mul_u32_u24 v45, 12288, v45
    v_lshl_add_u32 v45, v43, 4, v45
    v_mov_b32 v216, v45
    v_and_b32 v43, 2, v41
    v_or_b32 v43, 4, v43
    v_xor_b32 v43, v42, v43
    v_and_b32 v43, 7, v43
    v_or_b32 v43, v43, v44
    s_lshl_b32 s67, s55, 4
    v_add_u32 v45, 8, v41
    v_add_u32 v45, s67, v45
    v_mul_u32_u24 v45, 12288, v45
    v_lshl_add_u32 v45, v43, 4, v45
    v_mov_b32 v219, v45
    v_add_u32 v40, 64, v1
    v_mul_u32_u24 v41, 2731, v40
    v_lshrrev_b32 v41, 16, v41
    v_mul_u32_u24 v42, 24, v41
    v_sub_u32 v42, v40, v42
    v_xor_b32 v43, v42, v41
    v_and_b32 v43, 7, v43
    v_and_b32 v44, 24, v42
    v_or_b32 v43, v43, v44
    v_mul_u32_u24 v45, 384, v41
    v_lshl_add_u32 v45, v43, 4, v45
    v_add_u32 v45, s66, v45
    v_subrev_u32 v45, 1024, v45
    v_mov_b32 v5, v45
    v_and_b32 v43, 2, v41
    v_xor_b32 v43, v42, v43
    v_and_b32 v43, 7, v43
    v_or_b32 v43, v43, v44
    s_lshl_b32 s67, s55, 4
    v_add_u32 v45, 0, v41
    v_add_u32 v45, s67, v45
    v_mul_u32_u24 v45, 12288, v45
    v_lshl_add_u32 v45, v43, 4, v45
    v_subrev_u32 v45, 1024, v45
    v_mov_b32 v217, v45
    v_and_b32 v43, 2, v41
    v_or_b32 v43, 4, v43
    v_xor_b32 v43, v42, v43
    v_and_b32 v43, 7, v43
    v_or_b32 v43, v43, v44
    s_lshl_b32 s67, s55, 4
    v_add_u32 v45, 8, v41
    v_add_u32 v45, s67, v45
    v_mul_u32_u24 v45, 12288, v45
    v_lshl_add_u32 v45, v43, 4, v45
    v_subrev_u32 v45, 1024, v45
    v_mov_b32 v220, v45
    v_add_u32 v40, 128, v1
    v_mul_u32_u24 v41, 2731, v40
    v_lshrrev_b32 v41, 16, v41
    v_mul_u32_u24 v42, 24, v41
    v_sub_u32 v42, v40, v42
    v_xor_b32 v43, v42, v41
    v_and_b32 v43, 7, v43
    v_and_b32 v44, 24, v42
    v_or_b32 v43, v43, v44
    v_mul_u32_u24 v45, 384, v41
    v_lshl_add_u32 v45, v43, 4, v45
    v_add_u32 v45, s66, v45
    v_subrev_u32 v45, 2048, v45
    v_mov_b32 v6, v45
    v_and_b32 v43, 2, v41
    v_xor_b32 v43, v42, v43
    v_and_b32 v43, 7, v43
    v_or_b32 v43, v43, v44
    s_lshl_b32 s67, s55, 4
    v_add_u32 v45, 0, v41
    v_add_u32 v45, s67, v45
    v_mul_u32_u24 v45, 12288, v45
    v_lshl_add_u32 v45, v43, 4, v45
    v_subrev_u32 v45, 2048, v45
    v_mov_b32 v218, v45
    v_and_b32 v43, 2, v41
    v_or_b32 v43, 4, v43
    v_xor_b32 v43, v42, v43
    v_and_b32 v43, 7, v43
    v_or_b32 v43, v43, v44
    s_lshl_b32 s67, s55, 4
    v_add_u32 v45, 8, v41
    v_add_u32 v45, s67, v45
    v_mul_u32_u24 v45, 12288, v45
    v_lshl_add_u32 v45, v43, 4, v45
    v_subrev_u32 v45, 2048, v45
    v_mov_b32 v221, v45
    s_mul_i32 s67, s55, 48
    v_lshrrev_b32 v40, 2, v1
    v_add_u32 v40, s67, v40
    v_mul_u32_u24 v40, 1280, v40
    v_and_b32 v41, 3, v1
    v_lshl_add_u32 v10, v41, 4, v40
    v_lshl_add_u32 v40, v3, 2, v2
    v_lshlrev_b32 v222, 2, v40
    v_add_u32 v11, 20480, v10
    v_add_u32 v12, 40960, v10
    v_lshlrev_b32 v13, 4, v1
    s_lshl_b32 s67, s55, 12
    v_lshlrev_b32 v40, 6, v1
    v_add_u32 v223, s67, v40
    v_mov_b32 v240, v40
    s_waitcnt lgkmcnt(0)
    s_cmp_eq_u32 s52, 0
    s_cselect_b32 s28, s4, s14
    s_cselect_b32 s29, s5, s15
    s_mov_b32 s30, 1966080
    s_mov_b32 s31, 0x00020000
    s_cselect_b32 s32, s10, s20
    s_cselect_b32 s33, s11, s21
    s_mov_b32 s34, 7864320
    s_mov_b32 s35, 0x00020000
    s_cselect_b32 s36, s10, s20
    s_cselect_b32 s37, s11, s21
    s_mov_b32 s38, 7864320
    s_mov_b32 s39, 0x00020000
    s_cselect_b32 s40, s6, s16
    s_cselect_b32 s41, s7, s17
    s_mov_b32 s42, 50331648
    s_mov_b32 s43, 0x00020000
    s_cselect_b32 s44, s8, s18
    s_cselect_b32 s45, s9, s19
    s_mov_b32 s46, 50331648
    s_mov_b32 s47, 0x00020000
    s_mov_b32 s48, s24
    s_mov_b32 s49, s25
    s_mov_b32 s50, 37748736
    s_mov_b32 s51, 0x00020000
    s_cmp_eq_u32 s52, 0
    s_cselect_b32 s24, s12, s22
    s_cselect_b32 s25, s13, s23
    s_mov_b32 s26, 0
    s_mov_b32 s27, 0x00020000
    s_and_b32 s77, s2, 3
    s_mul_i32 s77, s77, 1966080
    s_lshr_b32 s68, s2, 3
    s_lshl_b32 s68, s68, 2
    s_add_u32 s68, s68, s55
    s_mul_i32 s68, s68, 15360
    s_add_u32 s77, s77, s68
    s_lshl_b32 s56, s53, 5
    s_add_u32 s56, s56, s54
    s_mul_i32 s56, s56, 196608
    s_mul_i32 s57, s54, 384
    s_mul_i32 s58, s53, 245760
    s_mul_i32 s59, s52, 96
    s_mul_i32 s67, s53, 12
    s_add_u32 s59, s59, s67
    s_mul_i32 s67, s55, 3
    s_add_u32 s59, s59, s67
    s_mul_i32 s59, s59, 192
    s_mul_i32 s67, s54, 6
    s_add_u32 s59, s59, s67
    s_lshl_b32 s59, s59, 10
    s_mov_b32 s60, 0
    s_mov_b32 s61, 24576
    s_mov_b32 s62, 49152
    s_mov_b32 s63, 73728
    s_mov_b32 s64, 98304
    s_mov_b32 s65, 122880
    s_mov_b32 s70, 0x3dd53b95
    s_mov_b32 s71, 0x41000000
    s_getpc_b64 s[74:75]
L1_pc:
    s_add_u32 s74, s74, L1_rescale-L1_pc
    s_addc_u32 s75, s75, 0
    s_add_u32 m0, s60, s66
    s_add_u32 s67, s57, 0
    buffer_load_dwordx4 v216, s[32:35], s67 offen offset:0 lds
    buffer_load_dwordx4 v217, s[32:35], s67 offen offset:1024 lds
    buffer_load_dwordx4 v218, s[32:35], s67 offen offset:2048 lds
    s_add_u32 m0, m0, 3072
    s_nop 0
    buffer_load_dwordx4 v219, s[32:35], s67 offen offset:0 lds
    buffer_load_dwordx4 v220, s[32:35], s67 offen offset:1024 lds
    buffer_load_dwordx4 v221, s[32:35], s67 offen offset:2048 lds
    buffer_load_dwordx4 v[48:51], v10, s[28:31], s58 offen offset:0
    buffer_load_dwordx4 v[52:55], v11, s[28:31], s58 offen offset:0
    buffer_load_dwordx4 v[56:59], v12, s[28:31], s58 offen offset:0
    buffer_load_dwordx4 v[60:63], v10, s[28:31], s58 offen offset:64
    buffer_load_dwordx4 v[64:67], v11, s[28:31], s58 offen offset:64
    buffer_load_dwordx4 v[68:71], v12, s[28:31], s58 offen offset:64
    s_lshl_b32 s82, s53, 2
    s_add_u32 s82, s82, s55
    s_mul_i32 s82, s82, 245760
    s_add_u32 s82, s82, s57
    s_lshr_b32 s83, s2, 6
    s_lshl_b32 s83, s83, 2
    s_add_u32 s83, s83, s55
    s_mul_i32 s83, s83, 15360
    s_add_u32 s83, s83, s58
    v_add_u32 v40, 0, v1
    v_min_u32 v40, 239, v40
    v_mul_u32_u24 v41, 5462, v40
    v_lshrrev_b32 v41, 16, v41
    v_mul_u32_u24 v42, 12, v41
    v_sub_u32 v42, v40, v42
    v_mul_u32_u24 v41, 12288, v41
    v_lshl_add_u32 v241, v42, 6, v41
    v_mul_u32_u24 v41, 3277, v40
    v_lshrrev_b32 v41, 16, v41
    v_mul_u32_u24 v42, 20, v41
    v_sub_u32 v42, v40, v42
    v_mul_u32_u24 v41, 1280, v41
    v_lshl_add_u32 v245, v42, 6, v41
    v_add_u32 v40, 64, v1
    v_min_u32 v40, 239, v40
    v_mul_u32_u24 v41, 5462, v40
    v_lshrrev_b32 v41, 16, v41
    v_mul_u32_u24 v42, 12, v41
    v_sub_u32 v42, v40, v42
    v_mul_u32_u24 v41, 12288, v41
    v_lshl_add_u32 v242, v42, 6, v41
    v_mul_u32_u24 v41, 3277, v40
    v_lshrrev_b32 v41, 16, v41
    v_mul_u32_u24 v42, 20, v41
    v_sub_u32 v42, v40, v42
    v_mul_u32_u24 v41, 1280, v41
    v_lshl_add_u32 v246, v42, 6, v41
    v_add_u32 v40, 128, v1
    v_min_u32 v40, 239, v40
    v_mul_u32_u24 v41, 5462, v40
    v_lshrrev_b32 v41, 16, v41
    v_mul_u32_u24 v42, 12, v41
    v_sub_u32 v42, v40, v42
    v_mul_u32_u24 v41, 12288, v41
    v_lshl_add_u32 v243, v42, 6, v41
    v_mul_u32_u24 v41, 3277, v40
    v_lshrrev_b32 v41, 16, v41
    v_mul_u32_u24 v42, 20, v41
    v_sub_u32 v42, v40, v42
    v_mul_u32_u24 v41, 1280, v41
    v_lshl_add_u32 v247, v42, 6, v41
    v_add_u32 v40, 192, v1
    v_min_u32 v40, 239, v40
    v_mul_u32_u24 v41, 5462, v40
    v_lshrrev_b32 v41, 16, v41
    v_mul_u32_u24 v42, 12, v41
    v_sub_u32 v42, v40, v42
    v_mul_u32_u24 v41, 12288, v41
    v_lshl_add_u32 v244, v42, 6, v41
    v_mul_u32_u24 v41, 3277, v40
    v_lshrrev_b32 v41, 16, v41
    v_mul_u32_u24 v42, 20, v41
    v_sub_u32 v42, v40, v42
    v_mul_u32_u24 v41, 1280, v41
    v_lshl_add_u32 v248, v42, 6, v41
    v_mov_b32 v252, 0x3f803f80
    v_mov_b32 v253, 0x3f803f80
    v_mov_b32 v254, 0x3f803f80
    v_mov_b32 v255, 0x3f803f80
    v_and_b32 v40, 7, v1
    v_xor_b32 v40, v40, v2
    v_mul_u32_u24 v41, 384, v3
    v_lshl_add_u32 v14, v40, 4, v41
    v_xor_b32 v15, 64, v14
    v_lshrrev_b32 v40, 2, v3
    v_lshl_add_u32 v40, v2, 2, v40
    v_and_b32 v41, 7, v40
    v_bfe_u32 v42, v3, 1, 1
    v_xor_b32 v41, v41, v42
    v_mul_u32_u24 v40, 384, v40
    v_and_b32 v43, 1, v3
    v_lshl_add_u32 v40, v43, 3, v40
    v_xor_b32 v44, 0, v41
    v_lshl_add_u32 v16, v44, 4, v40
    v_xor_b32 v44, 2, v41
    v_lshl_add_u32 v17, v44, 4, v40
    v_xor_b32 v44, 4, v41
    v_lshl_add_u32 v18, v44, 4, v40
    v_xor_b32 v44, 6, v41
    v_lshl_add_u32 v19, v44, 4, v40
    v_lshrrev_b32 v40, 2, v3
    v_lshl_add_u32 v40, v2, 3, v40
    v_bfe_u32 v41, v3, 3, 1
    v_lshlrev_b32 v41, 1, v41
    v_and_b32 v44, 1, v2
    v_lshl_or_b32 v41, v44, 2, v41
    v_xor_b32 v41, v41, v42
    v_mul_u32_u24 v40, 384, v40
    v_lshl_add_u32 v40, v43, 3, v40
    v_xor_b32 v44, 0, v41
    v_lshl_add_u32 v20, v44, 4, v40
    v_xor_b32 v44, 2, v41
    v_lshl_add_u32 v21, v44, 4, v40
    v_xor_b32 v44, 4, v41
    v_lshl_add_u32 v22, v44, 4, v40
    v_xor_b32 v44, 6, v41
    v_lshl_add_u32 v23, v44, 4, v40
    s_add_u32 m0, s61, s66
    s_add_u32 s67, s57, 786432
    buffer_load_dwordx4 v216, s[32:35], s67 offen offset:0 lds
    buffer_load_dwordx4 v217, s[32:35], s67 offen offset:1024 lds
    buffer_load_dwordx4 v218, s[32:35], s67 offen offset:2048 lds
    s_add_u32 m0, m0, 3072
    s_nop 0
    buffer_load_dwordx4 v219, s[32:35], s67 offen offset:0 lds
    buffer_load_dwordx4 v220, s[32:35], s67 offen offset:1024 lds
    buffer_load_dwordx4 v221, s[32:35], s67 offen offset:2048 lds
    s_add_u32 m0, s62, s66
    s_add_u32 s67, s57, 1572864
    buffer_load_dwordx4 v216, s[32:35], s67 offen offset:0 lds
    buffer_load_dwordx4 v217, s[32:35], s67 offen offset:1024 lds
    buffer_load_dwordx4 v218, s[32:35], s67 offen offset:2048 lds
    s_add_u32 m0, m0, 3072
    s_nop 0
    buffer_load_dwordx4 v219, s[32:35], s67 offen offset:0 lds
    buffer_load_dwordx4 v220, s[32:35], s67 offen offset:1024 lds
    buffer_load_dwordx4 v221, s[32:35], s67 offen offset:2048 lds
    s_add_u32 m0, s63, s66
    s_add_u32 s67, s57, 2359296
    buffer_load_dwordx4 v216, s[32:35], s67 offen offset:0 lds
    buffer_load_dwordx4 v217, s[32:35], s67 offen offset:1024 lds
    buffer_load_dwordx4 v218, s[32:35], s67 offen offset:2048 lds
    s_add_u32 m0, m0, 3072
    s_nop 0
    buffer_load_dwordx4 v219, s[32:35], s67 offen offset:0 lds
    buffer_load_dwordx4 v220, s[32:35], s67 offen offset:1024 lds
    buffer_load_dwordx4 v221, s[32:35], s67 offen offset:2048 lds
    buffer_load_dwordx4 v[72:75], v10, s[28:31], s58 offen offset:128
    buffer_load_dwordx4 v[76:79], v11, s[28:31], s58 offen offset:128
    buffer_load_dwordx4 v[80:83], v12, s[28:31], s58 offen offset:128
    buffer_load_dwordx4 v[84:87], v10, s[28:31], s58 offen offset:192
    buffer_load_dwordx4 v[88:91], v11, s[28:31], s58 offen offset:192
    buffer_load_dwordx4 v[92:95], v12, s[28:31], s58 offen offset:192
    buffer_load_dwordx4 v[96:99], v10, s[28:31], s58 offen offset:256
    buffer_load_dwordx4 v[100:103], v11, s[28:31], s58 offen offset:256
    buffer_load_dwordx4 v[104:107], v12, s[28:31], s58 offen offset:256
    buffer_load_dwordx4 v[108:111], v10, s[28:31], s58 offen offset:320
    buffer_load_dwordx4 v[112:115], v11, s[28:31], s58 offen offset:320
    buffer_load_dwordx4 v[116:119], v12, s[28:31], s58 offen offset:320
    buffer_load_dwordx4 v[120:123], v10, s[28:31], s58 offen offset:384
    buffer_load_dwordx4 v[124:127], v11, s[28:31], s58 offen offset:384
    buffer_load_dwordx4 v[128:131], v12, s[28:31], s58 offen offset:384
    buffer_load_dwordx4 v[132:135], v10, s[28:31], s58 offen offset:448
    buffer_load_dwordx4 v[136:139], v11, s[28:31], s58 offen offset:448
    buffer_load_dwordx4 v[140:143], v12, s[28:31], s58 offen offset:448
    buffer_load_dword v224, v241, s[32:35], s82 offen
    buffer_load_dword v228, v245, s[28:31], s83 offen
    buffer_load_dword v225, v242, s[32:35], s82 offen
    buffer_load_dword v229, v246, s[28:31], s83 offen
    buffer_load_dword v226, v243, s[32:35], s82 offen
    buffer_load_dword v230, v247, s[28:31], s83 offen
    buffer_load_dword v227, v244, s[32:35], s82 offen
    buffer_load_dword v231, v248, s[28:31], s83 offen
    s_waitcnt vmcnt(50)
    s_barrier
    v_add_u32 v26, s60, v20
    v_add_u32 v27, s60, v21
    v_add_u32 v28, s60, v22
    v_add_u32 v29, s60, v23
    s_add_u32 m0, s64, s66
    s_add_u32 s67, s57, 3145728
    buffer_load_dwordx4 v216, s[32:35], s67 offen offset:0 lds
    buffer_load_dwordx4 v217, s[32:35], s67 offen offset:1024 lds
    buffer_load_dwordx4 v218, s[32:35], s67 offen offset:2048 lds
    s_add_u32 m0, m0, 3072
    s_nop 0
    buffer_load_dwordx4 v219, s[32:35], s67 offen offset:0 lds
    buffer_load_dwordx4 v220, s[32:35], s67 offen offset:1024 lds
    buffer_load_dwordx4 v221, s[32:35], s67 offen offset:2048 lds
    ds_read_b64_tr_b16 v[168:169], v26 offset:0
    ds_read_b64_tr_b16 v[170:171], v26 offset:1536
    ds_read_b64_tr_b16 v[172:173], v27 offset:0
    ds_read_b64_tr_b16 v[174:175], v27 offset:1536
    ds_read_b64_tr_b16 v[176:177], v28 offset:0
    ds_read_b64_tr_b16 v[178:179], v28 offset:1536
    ds_read_b64_tr_b16 v[180:181], v29 offset:0
    ds_read_b64_tr_b16 v[182:183], v29 offset:1536
    ds_read_b64_tr_b16 v[184:185], v26 offset:128
    ds_read_b64_tr_b16 v[186:187], v26 offset:1664
    ds_read_b64_tr_b16 v[188:189], v27 offset:128
    ds_read_b64_tr_b16 v[190:191], v27 offset:1664
    s_mov_b32 s76, 0
    s_mov_b32 s38, 7864320
L1_head:
    s_cmp_eq_u32 s76, 1
    s_cselect_b32 s38, 0, 7864320
    s_cselect_b32 s26, 7864320, 0
    s_waitcnt vmcnt(41)
    ds_bpermute_b32 v48, v222, v48
    ds_bpermute_b32 v49, v222, v49
    ds_bpermute_b32 v50, v222, v50
    s_waitcnt lgkmcnt(12)
    ds_bpermute_b32 v51, v222, v51
    s_waitcnt vmcnt(40)
    ds_bpermute_b32 v52, v222, v52
    ds_bpermute_b32 v53, v222, v53
    s_waitcnt lgkmcnt(12)
    ds_bpermute_b32 v54, v222, v54
    ds_bpermute_b32 v55, v222, v55
    s_waitcnt vmcnt(39)
    ds_bpermute_b32 v56, v222, v56
    s_waitcnt lgkmcnt(12)
    ds_bpermute_b32 v57, v222, v57
    ds_bpermute_b32 v58, v222, v58
    ds_bpermute_b32 v59, v222, v59
    s_waitcnt vmcnt(38) lgkmcnt(12)
    ds_bpermute_b32 v60, v222, v60
    ds_bpermute_b32 v61, v222, v61
    ds_bpermute_b32 v62, v222, v62
    s_waitcnt lgkmcnt(12)
    ds_bpermute_b32 v63, v222, v63
    s_waitcnt vmcnt(37)
    ds_bpermute_b32 v64, v222, v64
    ds_bpermute_b32 v65, v222, v65
    s_waitcnt lgkmcnt(12)
    ds_bpermute_b32 v66, v222, v66
    ds_bpermute_b32 v67, v222, v67
    s_waitcnt vmcnt(36)
    ds_bpermute_b32 v68, v222, v68
    s_waitcnt lgkmcnt(12)
    ds_bpermute_b32 v69, v222, v69
    ds_bpermute_b32 v70, v222, v70
    ds_bpermute_b32 v71, v222, v71
    s_waitcnt lgkmcnt(12)
    ds_read_b64_tr_b16 v[192:193], v28 offset:128
    ds_read_b64_tr_b16 v[194:195], v28 offset:1664
    v_mfma_f32_16x16x32_bf16 a[0:3], v[168:171], v[48:51], 0
    s_waitcnt vmcnt(31)
    ds_bpermute_b32 v72, v222, v72
    v_mfma_f32_16x16x32_bf16 a[4:7], v[168:171], v[52:55], 0
    v_mfma_f32_16x16x32_bf16 a[8:11], v[168:171], v[56:59], 0
    s_waitcnt lgkmcnt(12)
    ds_read_b64_tr_b16 v[196:197], v29 offset:128
    ds_read_b64_tr_b16 v[198:199], v29 offset:1664
    v_mfma_f32_16x16x32_bf16 a[12:15], v[172:175], v[48:51], 0
    ds_bpermute_b32 v73, v222, v73
    v_mfma_f32_16x16x32_bf16 a[16:19], v[172:175], v[52:55], 0
    v_mfma_f32_16x16x32_bf16 a[20:23], v[172:175], v[56:59], 0
    s_waitcnt lgkmcnt(12)
    ds_read_b64_tr_b16 v[200:201], v26 offset:256
    ds_read_b64_tr_b16 v[202:203], v26 offset:1792
    v_mfma_f32_16x16x32_bf16 a[24:27], v[176:179], v[48:51], 0
    ds_bpermute_b32 v74, v222, v74
    v_mfma_f32_16x16x32_bf16 a[28:31], v[176:179], v[52:55], 0
    v_mfma_f32_16x16x32_bf16 a[32:35], v[176:179], v[56:59], 0
    s_waitcnt lgkmcnt(12)
    ds_read_b64_tr_b16 v[204:205], v27 offset:256
    ds_read_b64_tr_b16 v[206:207], v27 offset:1792
    v_mfma_f32_16x16x32_bf16 a[36:39], v[180:183], v[48:51], 0
    ds_bpermute_b32 v75, v222, v75
    v_mfma_f32_16x16x32_bf16 a[40:43], v[180:183], v[52:55], 0
    v_mfma_f32_16x16x32_bf16 a[44:47], v[180:183], v[56:59], 0
    s_waitcnt lgkmcnt(12)
    ds_read_b64_tr_b16 v[208:209], v28 offset:256
    ds_read_b64_tr_b16 v[210:211], v28 offset:1792
    v_mfma_f32_16x16x32_bf16 a[48:51], v[184:187], v[48:51], 0
    s_waitcnt vmcnt(30)
    ds_bpermute_b32 v76, v222, v76
    v_mfma_f32_16x16x32_bf16 a[52:55], v[184:187], v[52:55], 0
    v_mfma_f32_16x16x32_bf16 a[56:59], v[184:187], v[56:59], 0
    s_waitcnt lgkmcnt(12)
    ds_read_b64_tr_b16 v[212:213], v29 offset:256
    ds_read_b64_tr_b16 v[214:215], v29 offset:1792
    v_mfma_f32_16x16x32_bf16 a[60:63], v[188:191], v[48:51], 0
    ds_bpermute_b32 v77, v222, v77
    v_mfma_f32_16x16x32_bf16 a[64:67], v[188:191], v[52:55], 0
    v_mfma_f32_16x16x32_bf16 a[68:71], v[188:191], v[56:59], 0
    s_waitcnt lgkmcnt(12)
    ds_read_b64_tr_b16 v[168:169], v26 offset:12288
    ds_read_b64_tr_b16 v[170:171], v26 offset:13824
    v_mfma_f32_16x16x32_bf16 a[72:75], v[192:195], v[48:51], 0
    ds_bpermute_b32 v78, v222, v78
    v_mfma_f32_16x16x32_bf16 a[76:79], v[192:195], v[52:55], 0
    v_mfma_f32_16x16x32_bf16 a[80:83], v[192:195], v[56:59], 0
    s_waitcnt lgkmcnt(12)
    ds_read_b64_tr_b16 v[172:173], v27 offset:12288
    ds_read_b64_tr_b16 v[174:175], v27 offset:13824
    v_mfma_f32_16x16x32_bf16 a[84:87], v[196:199], v[48:51], 0
    ds_bpermute_b32 v79, v222, v79
    v_mfma_f32_16x16x32_bf16 a[88:91], v[196:199], v[52:55], 0
    v_mfma_f32_16x16x32_bf16 a[92:95], v[196:199], v[56:59], 0
    s_waitcnt lgkmcnt(12)
    ds_read_b64_tr_b16 v[176:177], v28 offset:12288
    ds_read_b64_tr_b16 v[178:179], v28 offset:13824
    v_mfma_f32_16x16x32_bf16 a[96:99], v[200:203], v[48:51], 0
    s_waitcnt vmcnt(29)
    ds_bpermute_b32 v80, v222, v80
    v_mfma_f32_16x16x32_bf16 a[100:103], v[200:203], v[52:55], 0
    v_mfma_f32_16x16x32_bf16 a[104:107], v[200:203], v[56:59], 0
    s_waitcnt lgkmcnt(12)
    ds_read_b64_tr_b16 v[180:181], v29 offset:12288
    ds_read_b64_tr_b16 v[182:183], v29 offset:13824
    v_mfma_f32_16x16x32_bf16 a[108:111], v[204:207], v[48:51], 0
    ds_bpermute_b32 v81, v222, v81
    v_mfma_f32_16x16x32_bf16 a[112:115], v[204:207], v[52:55], 0
    v_mfma_f32_16x16x32_bf16 a[116:119], v[204:207], v[56:59], 0
    s_waitcnt lgkmcnt(12)
    ds_read_b64_tr_b16 v[184:185], v26 offset:12416
    ds_read_b64_tr_b16 v[186:187], v26 offset:13952
    v_mfma_f32_16x16x32_bf16 a[120:123], v[208:211], v[48:51], 0
    ds_bpermute_b32 v82, v222, v82
    v_mfma_f32_16x16x32_bf16 a[124:127], v[208:211], v[52:55], 0
    v_mfma_f32_16x16x32_bf16 a[128:131], v[208:211], v[56:59], 0
    s_waitcnt lgkmcnt(12)
    ds_read_b64_tr_b16 v[188:189], v27 offset:12416
    ds_read_b64_tr_b16 v[190:191], v27 offset:13952
    v_mfma_f32_16x16x32_bf16 a[132:135], v[212:215], v[48:51], 0
    ds_bpermute_b32 v83, v222, v83
    v_mfma_f32_16x16x32_bf16 a[136:139], v[212:215], v[52:55], 0
    v_mfma_f32_16x16x32_bf16 a[140:143], v[212:215], v[56:59], 0
    s_waitcnt lgkmcnt(12)
    ds_read_b64_tr_b16 v[192:193], v28 offset:12416
    ds_read_b64_tr_b16 v[194:195], v28 offset:13952
    v_mfma_f32_16x16x32_bf16 a[0:3], v[168:171], v[60:63], a[0:3]
    s_waitcnt vmcnt(28)
    ds_bpermute_b32 v84, v222, v84
    v_mfma_f32_16x16x32_bf16 a[4:7], v[168:171], v[64:67], a[4:7]
    v_mfma_f32_16x16x32_bf16 a[8:11], v[168:171], v[68:71], a[8:11]
    s_waitcnt lgkmcnt(12)
    ds_read_b64_tr_b16 v[196:197], v29 offset:12416
    ds_read_b64_tr_b16 v[198:199], v29 offset:13952
    v_mfma_f32_16x16x32_bf16 a[12:15], v[172:175], v[60:63], a[12:15]
    ds_bpermute_b32 v85, v222, v85
    v_mfma_f32_16x16x32_bf16 a[16:19], v[172:175], v[64:67], a[16:19]
    v_mfma_f32_16x16x32_bf16 a[20:23], v[172:175], v[68:71], a[20:23]
    s_waitcnt lgkmcnt(12)
    ds_read_b64_tr_b16 v[200:201], v26 offset:12544
    ds_read_b64_tr_b16 v[202:203], v26 offset:14080
    v_mfma_f32_16x16x32_bf16 a[24:27], v[176:179], v[60:63], a[24:27]
    ds_bpermute_b32 v86, v222, v86
    v_mfma_f32_16x16x32_bf16 a[28:31], v[176:179], v[64:67], a[28:31]
    v_mfma_f32_16x16x32_bf16 a[32:35], v[176:179], v[68:71], a[32:35]
    s_waitcnt lgkmcnt(12)
    ds_read_b64_tr_b16 v[204:205], v27 offset:12544
    ds_read_b64_tr_b16 v[206:207], v27 offset:14080
    v_mfma_f32_16x16x32_bf16 a[36:39], v[180:183], v[60:63], a[36:39]
    ds_bpermute_b32 v87, v222, v87
    v_mfma_f32_16x16x32_bf16 a[40:43], v[180:183], v[64:67], a[40:43]
    v_mfma_f32_16x16x32_bf16 a[44:47], v[180:183], v[68:71], a[44:47]
    s_waitcnt lgkmcnt(12)
    ds_read_b64_tr_b16 v[208:209], v28 offset:12544
    ds_read_b64_tr_b16 v[210:211], v28 offset:14080
    v_mfma_f32_16x16x32_bf16 a[48:51], v[184:187], v[60:63], a[48:51]
    s_waitcnt vmcnt(27)
    ds_bpermute_b32 v88, v222, v88
    v_mfma_f32_16x16x32_bf16 a[52:55], v[184:187], v[64:67], a[52:55]
    v_mfma_f32_16x16x32_bf16 a[56:59], v[184:187], v[68:71], a[56:59]
    s_waitcnt lgkmcnt(12)
    ds_read_b64_tr_b16 v[212:213], v29 offset:12544
    ds_read_b64_tr_b16 v[214:215], v29 offset:14080
    v_mfma_f32_16x16x32_bf16 a[60:63], v[188:191], v[60:63], a[60:63]
    ds_bpermute_b32 v89, v222, v89
    v_mfma_f32_16x16x32_bf16 a[64:67], v[188:191], v[64:67], a[64:67]
    v_mfma_f32_16x16x32_bf16 a[68:71], v[188:191], v[68:71], a[68:71]
    s_barrier
    v_add_u32 v26, s61, v20
    v_add_u32 v27, s61, v21
    v_add_u32 v28, s61, v22
    v_add_u32 v29, s61, v23
    s_waitcnt lgkmcnt(12)
    ds_read_b64_tr_b16 v[168:169], v26 offset:0
    ds_read_b64_tr_b16 v[170:171], v26 offset:1536
    v_mfma_f32_16x16x32_bf16 a[72:75], v[192:195], v[60:63], a[72:75]
    s_add_u32 m0, s65, s66
    s_add_u32 s67, s57, 3932160
    buffer_load_dwordx4 v216, s[32:35], s67 offen offset:0 lds
    ds_bpermute_b32 v90, v222, v90
    v_mfma_f32_16x16x32_bf16 a[76:79], v[192:195], v[64:67], a[76:79]
    v_mfma_f32_16x16x32_bf16 a[80:83], v[192:195], v[68:71], a[80:83]
    s_waitcnt lgkmcnt(12)
    ds_read_b64_tr_b16 v[172:173], v27 offset:0
    ds_read_b64_tr_b16 v[174:175], v27 offset:1536
    v_mfma_f32_16x16x32_bf16 a[84:87], v[196:199], v[60:63], a[84:87]
    ds_bpermute_b32 v91, v222, v91
    v_mfma_f32_16x16x32_bf16 a[88:91], v[196:199], v[64:67], a[88:91]
    v_mfma_f32_16x16x32_bf16 a[92:95], v[196:199], v[68:71], a[92:95]
    buffer_load_dwordx4 v217, s[32:35], s67 offen offset:1024 lds
    s_waitcnt lgkmcnt(12)
    ds_read_b64_tr_b16 v[176:177], v28 offset:0
    ds_read_b64_tr_b16 v[178:179], v28 offset:1536
    v_mfma_f32_16x16x32_bf16 a[96:99], v[200:203], v[60:63], a[96:99]
    s_waitcnt vmcnt(28)
    ds_bpermute_b32 v92, v222, v92
    v_mfma_f32_16x16x32_bf16 a[100:103], v[200:203], v[64:67], a[100:103]
    v_mfma_f32_16x16x32_bf16 a[104:107], v[200:203], v[68:71], a[104:107]
    s_waitcnt lgkmcnt(12)
    ds_read_b64_tr_b16 v[180:181], v29 offset:0
    ds_read_b64_tr_b16 v[182:183], v29 offset:1536
    v_mfma_f32_16x16x32_bf16 a[108:111], v[204:207], v[60:63], a[108:111]
    ds_bpermute_b32 v93, v222, v93
    v_mfma_f32_16x16x32_bf16 a[112:115], v[204:207], v[64:67], a[112:115]
    buffer_load_dwordx4 v218, s[32:35], s67 offen offset:2048 lds
    v_mfma_f32_16x16x32_bf16 a[116:119], v[204:207], v[68:71], a[116:119]
    s_waitcnt lgkmcnt(12)
    ds_read_b64_tr_b16 v[184:185], v26 offset:128
    ds_read_b64_tr_b16 v[186:187], v26 offset:1664
    v_mfma_f32_16x16x32_bf16 a[120:123], v[208:211], v[60:63], a[120:123]
    ds_bpermute_b32 v94, v222, v94
    v_mfma_f32_16x16x32_bf16 a[124:127], v[208:211], v[64:67], a[124:127]
    v_mfma_f32_16x16x32_bf16 a[128:131], v[208:211], v[68:71], a[128:131]
    s_waitcnt lgkmcnt(12)
    ds_read_b64_tr_b16 v[188:189], v27 offset:128
    ds_read_b64_tr_b16 v[190:191], v27 offset:1664
    v_mfma_f32_16x16x32_bf16 a[132:135], v[212:215], v[60:63], a[132:135]
    s_add_u32 m0, m0, 3072
    s_nop 0
    buffer_load_dwordx4 v219, s[32:35], s67 offen offset:0 lds
    ds_bpermute_b32 v95, v222, v95
    v_mfma_f32_16x16x32_bf16 a[136:139], v[212:215], v[64:67], a[136:139]
    v_mfma_f32_16x16x32_bf16 a[140:143], v[212:215], v[68:71], a[140:143]
    buffer_load_dwordx4 v220, s[32:35], s67 offen offset:1024 lds
    buffer_load_dwordx4 v221, s[32:35], s67 offen offset:2048 lds
L1_qp1:
    s_waitcnt lgkmcnt(12)
    ds_read_b64_tr_b16 v[192:193], v28 offset:128
    ds_read_b64_tr_b16 v[194:195], v28 offset:1664
    v_mfma_f32_16x16x32_bf16 a[0:3], v[168:171], v[72:75], a[0:3]
    s_waitcnt vmcnt(31)
    ds_bpermute_b32 v96, v222, v96
    v_mfma_f32_16x16x32_bf16 a[4:7], v[168:171], v[76:79], a[4:7]
    v_mfma_f32_16x16x32_bf16 a[8:11], v[168:171], v[80:83], a[8:11]
    buffer_load_dwordx4 v[48:51], v10, s[28:31], s58 offen offset:512
    s_waitcnt lgkmcnt(12)
    ds_read_b64_tr_b16 v[196:197], v29 offset:128
    ds_read_b64_tr_b16 v[198:199], v29 offset:1664
    v_mfma_f32_16x16x32_bf16 a[12:15], v[172:175], v[72:75], a[12:15]
    ds_bpermute_b32 v97, v222, v97
    v_mfma_f32_16x16x32_bf16 a[16:19], v[172:175], v[76:79], a[16:19]
    v_mfma_f32_16x16x32_bf16 a[20:23], v[172:175], v[80:83], a[20:23]
    s_waitcnt lgkmcnt(12)
    ds_read_b64_tr_b16 v[200:201], v26 offset:256
    ds_read_b64_tr_b16 v[202:203], v26 offset:1792
    v_mfma_f32_16x16x32_bf16 a[24:27], v[176:179], v[72:75], a[24:27]
    ds_bpermute_b32 v98, v222, v98
    v_mfma_f32_16x16x32_bf16 a[28:31], v[176:179], v[76:79], a[28:31]
    buffer_load_dwordx4 v[52:55], v11, s[28:31], s58 offen offset:512
    v_mfma_f32_16x16x32_bf16 a[32:35], v[176:179], v[80:83], a[32:35]
    s_waitcnt lgkmcnt(12)
    ds_read_b64_tr_b16 v[204:205], v27 offset:256
    ds_read_b64_tr_b16 v[206:207], v27 offset:1792
    v_mfma_f32_16x16x32_bf16 a[36:39], v[180:183], v[72:75], a[36:39]
    ds_bpermute_b32 v99, v222, v99
    v_mfma_f32_16x16x32_bf16 a[40:43], v[180:183], v[76:79], a[40:43]
    v_mfma_f32_16x16x32_bf16 a[44:47], v[180:183], v[80:83], a[44:47]
    s_waitcnt lgkmcnt(12)
    ds_read_b64_tr_b16 v[208:209], v28 offset:256
    ds_read_b64_tr_b16 v[210:211], v28 offset:1792
    v_mfma_f32_16x16x32_bf16 a[48:51], v[184:187], v[72:75], a[48:51]
    buffer_load_dwordx4 v[56:59], v12, s[28:31], s58 offen offset:512
    s_waitcnt vmcnt(33)
    ds_bpermute_b32 v100, v222, v100
    v_mfma_f32_16x16x32_bf16 a[52:55], v[184:187], v[76:79], a[52:55]
    v_mfma_f32_16x16x32_bf16 a[56:59], v[184:187], v[80:83], a[56:59]
    s_waitcnt lgkmcnt(12)
    ds_read_b64_tr_b16 v[212:213], v29 offset:256
    ds_read_b64_tr_b16 v[214:215], v29 offset:1792
    v_mfma_f32_16x16x32_bf16 a[60:63], v[188:191], v[72:75], a[60:63]
    ds_bpermute_b32 v101, v222, v101
    v_mfma_f32_16x16x32_bf16 a[64:67], v[188:191], v[76:79], a[64:67]
    v_mfma_f32_16x16x32_bf16 a[68:71], v[188:191], v[80:83], a[68:71]
    buffer_load_dwordx4 v[60:63], v10, s[28:31], s58 offen offset:576
    s_waitcnt lgkmcnt(12)
    ds_read_b64_tr_b16 v[168:169], v26 offset:12288
    ds_read_b64_tr_b16 v[170:171], v26 offset:13824
    v_mfma_f32_16x16x32_bf16 a[72:75], v[192:195], v[72:75], a[72:75]
    ds_bpermute_b32 v102, v222, v102
    v_mfma_f32_16x16x32_bf16 a[76:79], v[192:195], v[76:79], a[76:79]
    v_mfma_f32_16x16x32_bf16 a[80:83], v[192:195], v[80:83], a[80:83]
    s_waitcnt lgkmcnt(12)
    ds_read_b64_tr_b16 v[172:173], v27 offset:12288
    ds_read_b64_tr_b16 v[174:175], v27 offset:13824
    v_mfma_f32_16x16x32_bf16 a[84:87], v[196:199], v[72:75], a[84:87]
    ds_bpermute_b32 v103, v222, v103
    v_mfma_f32_16x16x32_bf16 a[88:91], v[196:199], v[76:79], a[88:91]
    buffer_load_dwordx4 v[64:67], v11, s[28:31], s58 offen offset:576
    v_mfma_f32_16x16x32_bf16 a[92:95], v[196:199], v[80:83], a[92:95]
    s_waitcnt lgkmcnt(12)
    ds_read_b64_tr_b16 v[176:177], v28 offset:12288
    ds_read_b64_tr_b16 v[178:179], v28 offset:13824
    v_mfma_f32_16x16x32_bf16 a[96:99], v[200:203], v[72:75], a[96:99]
    s_waitcnt vmcnt(34)
    ds_bpermute_b32 v104, v222, v104
    v_mfma_f32_16x16x32_bf16 a[100:103], v[200:203], v[76:79], a[100:103]
    v_mfma_f32_16x16x32_bf16 a[104:107], v[200:203], v[80:83], a[104:107]
    s_waitcnt lgkmcnt(12)
    ds_read_b64_tr_b16 v[180:181], v29 offset:12288
    ds_read_b64_tr_b16 v[182:183], v29 offset:13824
    v_mfma_f32_16x16x32_bf16 a[108:111], v[204:207], v[72:75], a[108:111]
    buffer_load_dwordx4 v[68:71], v12, s[28:31], s58 offen offset:576
    ds_bpermute_b32 v105, v222, v105
    v_mfma_f32_16x16x32_bf16 a[112:115], v[204:207], v[76:79], a[112:115]
    v_mfma_f32_16x16x32_bf16 a[116:119], v[204:207], v[80:83], a[116:119]
    s_waitcnt lgkmcnt(12)
    ds_read_b64_tr_b16 v[184:185], v26 offset:12416
    ds_read_b64_tr_b16 v[186:187], v26 offset:13952
    v_mfma_f32_16x16x32_bf16 a[120:123], v[208:211], v[72:75], a[120:123]
    ds_bpermute_b32 v106, v222, v106
    v_mfma_f32_16x16x32_bf16 a[124:127], v[208:211], v[76:79], a[124:127]
    v_mfma_f32_16x16x32_bf16 a[128:131], v[208:211], v[80:83], a[128:131]
    s_waitcnt lgkmcnt(12)
    ds_read_b64_tr_b16 v[188:189], v27 offset:12416
    ds_read_b64_tr_b16 v[190:191], v27 offset:13952
    v_mfma_f32_16x16x32_bf16 a[132:135], v[212:215], v[72:75], a[132:135]
    ds_bpermute_b32 v107, v222, v107
    v_mfma_f32_16x16x32_bf16 a[136:139], v[212:215], v[76:79], a[136:139]
    v_mfma_f32_16x16x32_bf16 a[140:143], v[212:215], v[80:83], a[140:143]
    s_waitcnt lgkmcnt(12)
    ds_read_b64_tr_b16 v[192:193], v28 offset:12416
    ds_read_b64_tr_b16 v[194:195], v28 offset:13952
    v_mfma_f32_16x16x32_bf16 a[0:3], v[168:171], v[84:87], a[0:3]
    s_waitcnt vmcnt(34)
    ds_bpermute_b32 v108, v222, v108
    v_mfma_f32_16x16x32_bf16 a[4:7], v[168:171], v[88:91], a[4:7]
    v_mfma_f32_16x16x32_bf16 a[8:11], v[168:171], v[92:95], a[8:11]
    s_waitcnt lgkmcnt(12)
    ds_read_b64_tr_b16 v[196:197], v29 offset:12416
    ds_read_b64_tr_b16 v[198:199], v29 offset:13952
    v_mfma_f32_16x16x32_bf16 a[12:15], v[172:175], v[84:87], a[12:15]
    ds_bpermute_b32 v109, v222, v109
    v_mfma_f32_16x16x32_bf16 a[16:19], v[172:175], v[88:91], a[16:19]
    v_mfma_f32_16x16x32_bf16 a[20:23], v[172:175], v[92:95], a[20:23]
    s_waitcnt lgkmcnt(12)
    ds_read_b64_tr_b16 v[200:201], v26 offset:12544
    ds_read_b64_tr_b16 v[202:203], v26 offset:14080
    v_mfma_f32_16x16x32_bf16 a[24:27], v[176:179], v[84:87], a[24:27]
    ds_bpermute_b32 v110, v222, v110
    v_mfma_f32_16x16x32_bf16 a[28:31], v[176:179], v[88:91], a[28:31]
    v_mfma_f32_16x16x32_bf16 a[32:35], v[176:179], v[92:95], a[32:35]
    s_waitcnt lgkmcnt(12)
    ds_read_b64_tr_b16 v[204:205], v27 offset:12544
    ds_read_b64_tr_b16 v[206:207], v27 offset:14080
    v_mfma_f32_16x16x32_bf16 a[36:39], v[180:183], v[84:87], a[36:39]
    ds_bpermute_b32 v111, v222, v111
    v_mfma_f32_16x16x32_bf16 a[40:43], v[180:183], v[88:91], a[40:43]
    v_mfma_f32_16x16x32_bf16 a[44:47], v[180:183], v[92:95], a[44:47]
    s_waitcnt lgkmcnt(12)
    ds_read_b64_tr_b16 v[208:209], v28 offset:12544
    ds_read_b64_tr_b16 v[210:211], v28 offset:14080
    v_mfma_f32_16x16x32_bf16 a[48:51], v[184:187], v[84:87], a[48:51]
    s_waitcnt vmcnt(33)
    ds_bpermute_b32 v112, v222, v112
    v_mfma_f32_16x16x32_bf16 a[52:55], v[184:187], v[88:91], a[52:55]
    v_mfma_f32_16x16x32_bf16 a[56:59], v[184:187], v[92:95], a[56:59]
    s_waitcnt lgkmcnt(12)
    ds_read_b64_tr_b16 v[212:213], v29 offset:12544
    ds_read_b64_tr_b16 v[214:215], v29 offset:14080
    v_mfma_f32_16x16x32_bf16 a[60:63], v[188:191], v[84:87], a[60:63]
    ds_bpermute_b32 v113, v222, v113
    v_mfma_f32_16x16x32_bf16 a[64:67], v[188:191], v[88:91], a[64:67]
    v_mfma_f32_16x16x32_bf16 a[68:71], v[188:191], v[92:95], a[68:71]
    s_barrier
    v_add_u32 v26, s62, v20
    v_add_u32 v27, s62, v21
    v_add_u32 v28, s62, v22
    v_add_u32 v29, s62, v23
    s_waitcnt lgkmcnt(12)
    ds_read_b64_tr_b16 v[168:169], v26 offset:0
    ds_read_b64_tr_b16 v[170:171], v26 offset:1536
    v_mfma_f32_16x16x32_bf16 a[72:75], v[192:195], v[84:87], a[72:75]
    ds_bpermute_b32 v114, v222, v114
    v_mfma_f32_16x16x32_bf16 a[76:79], v[192:195], v[88:91], a[76:79]
    v_mfma_f32_16x16x32_bf16 a[80:83], v[192:195], v[92:95], a[80:83]
    s_waitcnt lgkmcnt(12)
    ds_read_b64_tr_b16 v[172:173], v27 offset:0
    ds_read_b64_tr_b16 v[174:175], v27 offset:1536
    v_mfma_f32_16x16x32_bf16 a[84:87], v[196:199], v[84:87], a[84:87]
    s_add_u32 m0, s60, s66
    s_add_u32 s67, s57, 4718592
    buffer_load_dwordx4 v216, s[32:35], s67 offen offset:0 lds
    ds_bpermute_b32 v115, v222, v115
    v_mfma_f32_16x16x32_bf16 a[88:91], v[196:199], v[88:91], a[88:91]
    v_mfma_f32_16x16x32_bf16 a[92:95], v[196:199], v[92:95], a[92:95]
    s_waitcnt lgkmcnt(12)
    ds_read_b64_tr_b16 v[176:177], v28 offset:0
    ds_read_b64_tr_b16 v[178:179], v28 offset:1536
    v_mfma_f32_16x16x32_bf16 a[96:99], v[200:203], v[84:87], a[96:99]
    s_waitcnt vmcnt(33)
    ds_bpermute_b32 v116, v222, v116
    v_mfma_f32_16x16x32_bf16 a[100:103], v[200:203], v[88:91], a[100:103]
    v_mfma_f32_16x16x32_bf16 a[104:107], v[200:203], v[92:95], a[104:107]
    buffer_load_dwordx4 v217, s[32:35], s67 offen offset:1024 lds
    s_waitcnt lgkmcnt(12)
    ds_read_b64_tr_b16 v[180:181], v29 offset:0
    ds_read_b64_tr_b16 v[182:183], v29 offset:1536
    v_mfma_f32_16x16x32_bf16 a[108:111], v[204:207], v[84:87], a[108:111]
    ds_bpermute_b32 v117, v222, v117
    v_mfma_f32_16x16x32_bf16 a[112:115], v[204:207], v[88:91], a[112:115]
    v_mfma_f32_16x16x32_bf16 a[116:119], v[204:207], v[92:95], a[116:119]
    s_waitcnt lgkmcnt(12)
    ds_read_b64_tr_b16 v[184:185], v26 offset:128
    ds_read_b64_tr_b16 v[186:187], v26 offset:1664
    v_mfma_f32_16x16x32_bf16 a[120:123], v[208:211], v[84:87], a[120:123]
    ds_bpermute_b32 v118, v222, v118
    v_mfma_f32_16x16x32_bf16 a[124:127], v[208:211], v[88:91], a[124:127]
    buffer_load_dwordx4 v218, s[32:35], s67 offen offset:2048 lds
    v_mfma_f32_16x16x32_bf16 a[128:131], v[208:211], v[92:95], a[128:131]
    s_waitcnt lgkmcnt(12)
    ds_read_b64_tr_b16 v[188:189], v27 offset:128
    ds_read_b64_tr_b16 v[190:191], v27 offset:1664
    v_mfma_f32_16x16x32_bf16 a[132:135], v[212:215], v[84:87], a[132:135]
    ds_bpermute_b32 v119, v222, v119
    v_mfma_f32_16x16x32_bf16 a[136:139], v[212:215], v[88:91], a[136:139]
    v_mfma_f32_16x16x32_bf16 a[140:143], v[212:215], v[92:95], a[140:143]
    s_waitcnt lgkmcnt(12)
    ds_read_b64_tr_b16 v[192:193], v28 offset:128
    ds_read_b64_tr_b16 v[194:195], v28 offset:1664
    v_mfma_f32_16x16x32_bf16 a[0:3], v[168:171], v[96:99], a[0:3]
    s_add_u32 m0, m0, 3072
    s_nop 0
    buffer_load_dwordx4 v219, s[32:35], s67 offen offset:0 lds
    s_waitcnt vmcnt(35)
    ds_bpermute_b32 v120, v222, v120
    v_mfma_f32_16x16x32_bf16 a[4:7], v[168:171], v[100:103], a[4:7]
    v_mfma_f32_16x16x32_bf16 a[8:11], v[168:171], v[104:107], a[8:11]
    s_waitcnt lgkmcnt(12)
    ds_read_b64_tr_b16 v[196:197], v29 offset:128
    ds_read_b64_tr_b16 v[198:199], v29 offset:1664
    v_mfma_f32_16x16x32_bf16 a[12:15], v[172:175], v[96:99], a[12:15]
    ds_bpermute_b32 v121, v222, v121
    v_mfma_f32_16x16x32_bf16 a[16:19], v[172:175], v[100:103], a[16:19]
    v_mfma_f32_16x16x32_bf16 a[20:23], v[172:175], v[104:107], a[20:23]
    buffer_load_dwordx4 v220, s[32:35], s67 offen offset:1024 lds
    s_waitcnt lgkmcnt(12)
    ds_read_b64_tr_b16 v[200:201], v26 offset:256
    ds_read_b64_tr_b16 v[202:203], v26 offset:1792
    v_mfma_f32_16x16x32_bf16 a[24:27], v[176:179], v[96:99], a[24:27]
    ds_bpermute_b32 v122, v222, v122
    v_mfma_f32_16x16x32_bf16 a[28:31], v[176:179], v[100:103], a[28:31]
    v_mfma_f32_16x16x32_bf16 a[32:35], v[176:179], v[104:107], a[32:35]
    s_waitcnt lgkmcnt(12)
    ds_read_b64_tr_b16 v[204:205], v27 offset:256
    ds_read_b64_tr_b16 v[206:207], v27 offset:1792
    v_mfma_f32_16x16x32_bf16 a[36:39], v[180:183], v[96:99], a[36:39]
    ds_bpermute_b32 v123, v222, v123
    v_mfma_f32_16x16x32_bf16 a[40:43], v[180:183], v[100:103], a[40:43]
    buffer_load_dwordx4 v221, s[32:35], s67 offen offset:2048 lds
    v_mfma_f32_16x16x32_bf16 a[44:47], v[180:183], v[104:107], a[44:47]
    s_waitcnt lgkmcnt(12)
    ds_read_b64_tr_b16 v[208:209], v28 offset:256
    ds_read_b64_tr_b16 v[210:211], v28 offset:1792
    v_mfma_f32_16x16x32_bf16 a[48:51], v[184:187], v[96:99], a[48:51]
    s_waitcnt vmcnt(36)
    ds_bpermute_b32 v124, v222, v124
    v_mfma_f32_16x16x32_bf16 a[52:55], v[184:187], v[100:103], a[52:55]
    v_mfma_f32_16x16x32_bf16 a[56:59], v[184:187], v[104:107], a[56:59]
    s_waitcnt lgkmcnt(12)
    ds_read_b64_tr_b16 v[212:213], v29 offset:256
    ds_read_b64_tr_b16 v[214:215], v29 offset:1792
    v_mfma_f32_16x16x32_bf16 a[60:63], v[188:191], v[96:99], a[60:63]
    buffer_load_dwordx4 v[72:75], v10, s[28:31], s58 offen offset:640
    ds_bpermute_b32 v125, v222, v125
    v_mfma_f32_16x16x32_bf16 a[64:67], v[188:191], v[100:103], a[64:67]
    v_mfma_f32_16x16x32_bf16 a[68:71], v[188:191], v[104:107], a[68:71]
    s_waitcnt lgkmcnt(12)
    ds_read_b64_tr_b16 v[168:169], v26 offset:12288
    ds_read_b64_tr_b16 v[170:171], v26 offset:13824
    v_mfma_f32_16x16x32_bf16 a[72:75], v[192:195], v[96:99], a[72:75]
    ds_bpermute_b32 v126, v222, v126
    v_mfma_f32_16x16x32_bf16 a[76:79], v[192:195], v[100:103], a[76:79]
    v_mfma_f32_16x16x32_bf16 a[80:83], v[192:195], v[104:107], a[80:83]
    buffer_load_dwordx4 v[76:79], v11, s[28:31], s58 offen offset:640
    s_waitcnt lgkmcnt(12)
    ds_read_b64_tr_b16 v[172:173], v27 offset:12288
    ds_read_b64_tr_b16 v[174:175], v27 offset:13824
    v_mfma_f32_16x16x32_bf16 a[84:87], v[196:199], v[96:99], a[84:87]
    ds_bpermute_b32 v127, v222, v127
    v_mfma_f32_16x16x32_bf16 a[88:91], v[196:199], v[100:103], a[88:91]
    v_mfma_f32_16x16x32_bf16 a[92:95], v[196:199], v[104:107], a[92:95]
    s_waitcnt lgkmcnt(12)
    ds_read_b64_tr_b16 v[176:177], v28 offset:12288
    ds_read_b64_tr_b16 v[178:179], v28 offset:13824
    v_mfma_f32_16x16x32_bf16 a[96:99], v[200:203], v[96:99], a[96:99]
    s_waitcnt vmcnt(37)
    ds_bpermute_b32 v128, v222, v128
    v_mfma_f32_16x16x32_bf16 a[100:103], v[200:203], v[100:103], a[100:103]
    buffer_load_dwordx4 v[80:83], v12, s[28:31], s58 offen offset:640
    v_mfma_f32_16x16x32_bf16 a[104:107], v[200:203], v[104:107], a[104:107]
    s_waitcnt lgkmcnt(12)
    ds_read_b64_tr_b16 v[180:181], v29 offset:12288
    ds_read_b64_tr_b16 v[182:183], v29 offset:13824
    v_mfma_f32_16x16x32_bf16 a[108:111], v[204:207], v[96:99], a[108:111]
    ds_bpermute_b32 v129, v222, v129
    v_mfma_f32_16x16x32_bf16 a[112:115], v[204:207], v[100:103], a[112:115]
    v_mfma_f32_16x16x32_bf16 a[116:119], v[204:207], v[104:107], a[116:119]
    s_waitcnt lgkmcnt(12)
    ds_read_b64_tr_b16 v[184:185], v26 offset:12416
    ds_read_b64_tr_b16 v[186:187], v26 offset:13952
    v_mfma_f32_16x16x32_bf16 a[120:123], v[208:211], v[96:99], a[120:123]
    buffer_load_dwordx4 v[84:87], v10, s[28:31], s58 offen offset:704
    ds_bpermute_b32 v130, v222, v130
    v_mfma_f32_16x16x32_bf16 a[124:127], v[208:211], v[100:103], a[124:127]
    v_mfma_f32_16x16x32_bf16 a[128:131], v[208:211], v[104:107], a[128:131]
    s_waitcnt lgkmcnt(12)
    ds_read_b64_tr_b16 v[188:189], v27 offset:12416
    ds_read_b64_tr_b16 v[190:191], v27 offset:13952
    v_mfma_f32_16x16x32_bf16 a[132:135], v[212:215], v[96:99], a[132:135]
    ds_bpermute_b32 v131, v222, v131
    v_mfma_f32_16x16x32_bf16 a[136:139], v[212:215], v[100:103], a[136:139]
    v_mfma_f32_16x16x32_bf16 a[140:143], v[212:215], v[104:107], a[140:143]
    buffer_load_dwordx4 v[88:91], v11, s[28:31], s58 offen offset:704
    s_waitcnt lgkmcnt(12)
    ds_read_b64_tr_b16 v[192:193], v28 offset:12416
    ds_read_b64_tr_b16 v[194:195], v28 offset:13952
    v_mfma_f32_16x16x32_bf16 a[0:3], v[168:171], v[108:111], a[0:3]
    s_waitcnt vmcnt(39)
    ds_bpermute_b32 v132, v222, v132
    v_mfma_f32_16x16x32_bf16 a[4:7], v[168:171], v[112:115], a[4:7]
    v_mfma_f32_16x16x32_bf16 a[8:11], v[168:171], v[116:119], a[8:11]
    s_waitcnt lgkmcnt(12)
    ds_read_b64_tr_b16 v[196:197], v29 offset:12416
    ds_read_b64_tr_b16 v[198:199], v29 offset:13952
    v_mfma_f32_16x16x32_bf16 a[12:15], v[172:175], v[108:111], a[12:15]
    ds_bpermute_b32 v133, v222, v133
    v_mfma_f32_16x16x32_bf16 a[16:19], v[172:175], v[112:115], a[16:19]
    buffer_load_dwordx4 v[92:95], v12, s[28:31], s58 offen offset:704
    v_mfma_f32_16x16x32_bf16 a[20:23], v[172:175], v[116:119], a[20:23]
    s_waitcnt lgkmcnt(12)
    ds_read_b64_tr_b16 v[200:201], v26 offset:12544
    ds_read_b64_tr_b16 v[202:203], v26 offset:14080
    v_mfma_f32_16x16x32_bf16 a[24:27], v[176:179], v[108:111], a[24:27]
    ds_bpermute_b32 v134, v222, v134
    v_mfma_f32_16x16x32_bf16 a[28:31], v[176:179], v[112:115], a[28:31]
    v_mfma_f32_16x16x32_bf16 a[32:35], v[176:179], v[116:119], a[32:35]
    s_waitcnt lgkmcnt(12)
    ds_read_b64_tr_b16 v[204:205], v27 offset:12544
    ds_read_b64_tr_b16 v[206:207], v27 offset:14080
    v_mfma_f32_16x16x32_bf16 a[36:39], v[180:183], v[108:111], a[36:39]
    ds_bpermute_b32 v135, v222, v135
    v_mfma_f32_16x16x32_bf16 a[40:43], v[180:183], v[112:115], a[40:43]
    v_mfma_f32_16x16x32_bf16 a[44:47], v[180:183], v[116:119], a[44:47]
    s_waitcnt lgkmcnt(12)
    ds_read_b64_tr_b16 v[208:209], v28 offset:12544
    ds_read_b64_tr_b16 v[210:211], v28 offset:14080
    v_mfma_f32_16x16x32_bf16 a[48:51], v[184:187], v[108:111], a[48:51]
    s_waitcnt vmcnt(39)
    ds_bpermute_b32 v136, v222, v136
    v_mfma_f32_16x16x32_bf16 a[52:55], v[184:187], v[112:115], a[52:55]
    v_mfma_f32_16x16x32_bf16 a[56:59], v[184:187], v[116:119], a[56:59]
    s_waitcnt lgkmcnt(12)
    ds_read_b64_tr_b16 v[212:213], v29 offset:12544
    ds_read_b64_tr_b16 v[214:215], v29 offset:14080
    v_mfma_f32_16x16x32_bf16 a[60:63], v[188:191], v[108:111], a[60:63]
    ds_bpermute_b32 v137, v222, v137
    v_mfma_f32_16x16x32_bf16 a[64:67], v[188:191], v[112:115], a[64:67]
    v_mfma_f32_16x16x32_bf16 a[68:71], v[188:191], v[116:119], a[68:71]
    s_barrier
    v_add_u32 v26, s63, v20
    v_add_u32 v27, s63, v21
    v_add_u32 v28, s63, v22
    v_add_u32 v29, s63, v23
    s_waitcnt lgkmcnt(12)
    ds_read_b64_tr_b16 v[168:169], v26 offset:0
    ds_read_b64_tr_b16 v[170:171], v26 offset:1536
    v_mfma_f32_16x16x32_bf16 a[72:75], v[192:195], v[108:111], a[72:75]
    ds_bpermute_b32 v138, v222, v138
    v_mfma_f32_16x16x32_bf16 a[76:79], v[192:195], v[112:115], a[76:79]
    s_add_u32 m0, s61, s66
    s_add_u32 s67, s57, 5505024
    buffer_load_dwordx4 v216, s[32:35], s67 offen offset:0 lds
    v_mfma_f32_16x16x32_bf16 a[80:83], v[192:195], v[116:119], a[80:83]
    s_waitcnt lgkmcnt(12)
    ds_read_b64_tr_b16 v[172:173], v27 offset:0
    ds_read_b64_tr_b16 v[174:175], v27 offset:1536
    v_mfma_f32_16x16x32_bf16 a[84:87], v[196:199], v[108:111], a[84:87]
    ds_bpermute_b32 v139, v222, v139
    v_mfma_f32_16x16x32_bf16 a[88:91], v[196:199], v[112:115], a[88:91]
    v_mfma_f32_16x16x32_bf16 a[92:95], v[196:199], v[116:119], a[92:95]
    s_waitcnt lgkmcnt(12)
    ds_read_b64_tr_b16 v[176:177], v28 offset:0
    ds_read_b64_tr_b16 v[178:179], v28 offset:1536
    v_mfma_f32_16x16x32_bf16 a[96:99], v[200:203], v[108:111], a[96:99]
    buffer_load_dwordx4 v217, s[32:35], s67 offen offset:1024 lds
    s_waitcnt vmcnt(40)
    ds_bpermute_b32 v140, v222, v140
    v_mfma_f32_16x16x32_bf16 a[100:103], v[200:203], v[112:115], a[100:103]
    v_mfma_f32_16x16x32_bf16 a[104:107], v[200:203], v[116:119], a[104:107]
    s_waitcnt lgkmcnt(12)
    ds_read_b64_tr_b16 v[180:181], v29 offset:0
    ds_read_b64_tr_b16 v[182:183], v29 offset:1536
    v_mfma_f32_16x16x32_bf16 a[108:111], v[204:207], v[108:111], a[108:111]
    ds_bpermute_b32 v141, v222, v141
    v_mfma_f32_16x16x32_bf16 a[112:115], v[204:207], v[112:115], a[112:115]
    v_mfma_f32_16x16x32_bf16 a[116:119], v[204:207], v[116:119], a[116:119]
    buffer_load_dwordx4 v218, s[32:35], s67 offen offset:2048 lds
    s_waitcnt lgkmcnt(12)
    ds_read_b64_tr_b16 v[184:185], v26 offset:128
    ds_read_b64_tr_b16 v[186:187], v26 offset:1664
    v_mfma_f32_16x16x32_bf16 a[120:123], v[208:211], v[108:111], a[120:123]
    ds_bpermute_b32 v142, v222, v142
    v_mfma_f32_16x16x32_bf16 a[124:127], v[208:211], v[112:115], a[124:127]
    v_mfma_f32_16x16x32_bf16 a[128:131], v[208:211], v[116:119], a[128:131]
    s_waitcnt lgkmcnt(12)
    ds_read_b64_tr_b16 v[188:189], v27 offset:128
    ds_read_b64_tr_b16 v[190:191], v27 offset:1664
    v_mfma_f32_16x16x32_bf16 a[132:135], v[212:215], v[108:111], a[132:135]
    ds_bpermute_b32 v143, v222, v143
    v_mfma_f32_16x16x32_bf16 a[136:139], v[212:215], v[112:115], a[136:139]
    s_add_u32 m0, m0, 3072
    s_nop 0
    buffer_load_dwordx4 v219, s[32:35], s67 offen offset:0 lds
    v_mfma_f32_16x16x32_bf16 a[140:143], v[212:215], v[116:119], a[140:143]
    s_waitcnt lgkmcnt(12)
    ds_read_b64_tr_b16 v[192:193], v28 offset:128
    ds_read_b64_tr_b16 v[194:195], v28 offset:1664
    v_mfma_f32_16x16x32_bf16 a[0:3], v[168:171], v[120:123], a[0:3]
    s_waitcnt vmcnt(21)
    ds_bpermute_b32 v48, v222, v48
    v_mfma_f32_16x16x32_bf16 a[4:7], v[168:171], v[124:127], a[4:7]
    v_mfma_f32_16x16x32_bf16 a[8:11], v[168:171], v[128:131], a[8:11]
    s_waitcnt lgkmcnt(12)
    ds_read_b64_tr_b16 v[196:197], v29 offset:128
    ds_read_b64_tr_b16 v[198:199], v29 offset:1664
    v_mfma_f32_16x16x32_bf16 a[12:15], v[172:175], v[120:123], a[12:15]
    buffer_load_dwordx4 v220, s[32:35], s67 offen offset:1024 lds
    ds_bpermute_b32 v49, v222, v49
    v_mfma_f32_16x16x32_bf16 a[16:19], v[172:175], v[124:127], a[16:19]
    v_mfma_f32_16x16x32_bf16 a[20:23], v[172:175], v[128:131], a[20:23]
    s_waitcnt lgkmcnt(12)
    ds_read_b64_tr_b16 v[200:201], v26 offset:256
    ds_read_b64_tr_b16 v[202:203], v26 offset:1792
    v_mfma_f32_16x16x32_bf16 a[24:27], v[176:179], v[120:123], a[24:27]
    ds_bpermute_b32 v50, v222, v50
    v_mfma_f32_16x16x32_bf16 a[28:31], v[176:179], v[124:127], a[28:31]
    v_mfma_f32_16x16x32_bf16 a[32:35], v[176:179], v[128:131], a[32:35]
    buffer_load_dwordx4 v221, s[32:35], s67 offen offset:2048 lds
    s_waitcnt lgkmcnt(12)
    ds_read_b64_tr_b16 v[204:205], v27 offset:256
    ds_read_b64_tr_b16 v[206:207], v27 offset:1792
    v_mfma_f32_16x16x32_bf16 a[36:39], v[180:183], v[120:123], a[36:39]
    ds_bpermute_b32 v51, v222, v51
    v_mfma_f32_16x16x32_bf16 a[40:43], v[180:183], v[124:127], a[40:43]
    v_mfma_f32_16x16x32_bf16 a[44:47], v[180:183], v[128:131], a[44:47]
    s_waitcnt lgkmcnt(12)
    ds_read_b64_tr_b16 v[208:209], v28 offset:256
    ds_read_b64_tr_b16 v[210:211], v28 offset:1792
    v_mfma_f32_16x16x32_bf16 a[48:51], v[184:187], v[120:123], a[48:51]
    s_waitcnt vmcnt(22)
    ds_bpermute_b32 v52, v222, v52
    v_mfma_f32_16x16x32_bf16 a[52:55], v[184:187], v[124:127], a[52:55]
    buffer_load_dwordx4 v[96:99], v10, s[28:31], s58 offen offset:768
    v_mfma_f32_16x16x32_bf16 a[56:59], v[184:187], v[128:131], a[56:59]
    s_waitcnt lgkmcnt(12)
    ds_read_b64_tr_b16 v[212:213], v29 offset:256
    ds_read_b64_tr_b16 v[214:215], v29 offset:1792
    v_mfma_f32_16x16x32_bf16 a[60:63], v[188:191], v[120:123], a[60:63]
    ds_bpermute_b32 v53, v222, v53
    v_mfma_f32_16x16x32_bf16 a[64:67], v[188:191], v[124:127], a[64:67]
    v_mfma_f32_16x16x32_bf16 a[68:71], v[188:191], v[128:131], a[68:71]
    s_waitcnt lgkmcnt(12)
    ds_read_b64_tr_b16 v[168:169], v26 offset:12288
    ds_read_b64_tr_b16 v[170:171], v26 offset:13824
    v_mfma_f32_16x16x32_bf16 a[72:75], v[192:195], v[120:123], a[72:75]
    buffer_load_dwordx4 v[100:103], v11, s[28:31], s58 offen offset:768
    ds_bpermute_b32 v54, v222, v54
    v_mfma_f32_16x16x32_bf16 a[76:79], v[192:195], v[124:127], a[76:79]
    v_mfma_f32_16x16x32_bf16 a[80:83], v[192:195], v[128:131], a[80:83]
    s_waitcnt lgkmcnt(12)
    ds_read_b64_tr_b16 v[172:173], v27 offset:12288
    ds_read_b64_tr_b16 v[174:175], v27 offset:13824
    v_mfma_f32_16x16x32_bf16 a[84:87], v[196:199], v[120:123], a[84:87]
    ds_bpermute_b32 v55, v222, v55
    v_mfma_f32_16x16x32_bf16 a[88:91], v[196:199], v[124:127], a[88:91]
    v_mfma_f32_16x16x32_bf16 a[92:95], v[196:199], v[128:131], a[92:95]
    buffer_load_dwordx4 v[104:107], v12, s[28:31], s58 offen offset:768
    s_waitcnt lgkmcnt(12)
    ds_read_b64_tr_b16 v[176:177], v28 offset:12288
    ds_read_b64_tr_b16 v[178:179], v28 offset:13824
    v_mfma_f32_16x16x32_bf16 a[96:99], v[200:203], v[120:123], a[96:99]
    s_waitcnt vmcnt(24)
    ds_bpermute_b32 v56, v222, v56
    v_mfma_f32_16x16x32_bf16 a[100:103], v[200:203], v[124:127], a[100:103]
    v_mfma_f32_16x16x32_bf16 a[104:107], v[200:203], v[128:131], a[104:107]
    s_waitcnt lgkmcnt(12)
    ds_read_b64_tr_b16 v[180:181], v29 offset:12288
    ds_read_b64_tr_b16 v[182:183], v29 offset:13824
    v_mfma_f32_16x16x32_bf16 a[108:111], v[204:207], v[120:123], a[108:111]
    ds_bpermute_b32 v57, v222, v57
    v_mfma_f32_16x16x32_bf16 a[112:115], v[204:207], v[124:127], a[112:115]
    buffer_load_dwordx4 v[108:111], v10, s[28:31], s58 offen offset:832
    v_mfma_f32_16x16x32_bf16 a[116:119], v[204:207], v[128:131], a[116:119]
    s_waitcnt lgkmcnt(12)
    ds_read_b64_tr_b16 v[184:185], v26 offset:12416
    ds_read_b64_tr_b16 v[186:187], v26 offset:13952
    v_mfma_f32_16x16x32_bf16 a[120:123], v[208:211], v[120:123], a[120:123]
    ds_bpermute_b32 v58, v222, v58
    v_mfma_f32_16x16x32_bf16 a[124:127], v[208:211], v[124:127], a[124:127]
    v_mfma_f32_16x16x32_bf16 a[128:131], v[208:211], v[128:131], a[128:131]
    s_waitcnt lgkmcnt(12)
    ds_read_b64_tr_b16 v[188:189], v27 offset:12416
    ds_read_b64_tr_b16 v[190:191], v27 offset:13952
    v_mfma_f32_16x16x32_bf16 a[132:135], v[212:215], v[120:123], a[132:135]
    buffer_load_dwordx4 v[112:115], v11, s[28:31], s58 offen offset:832
    ds_bpermute_b32 v59, v222, v59
    v_mfma_f32_16x16x32_bf16 a[136:139], v[212:215], v[124:127], a[136:139]
    v_mfma_f32_16x16x32_bf16 a[140:143], v[212:215], v[128:131], a[140:143]
    s_waitcnt lgkmcnt(12)
    ds_read_b64_tr_b16 v[192:193], v28 offset:12416
    ds_read_b64_tr_b16 v[194:195], v28 offset:13952
    v_mfma_f32_16x16x32_bf16 a[0:3], v[168:171], v[132:135], a[0:3]
    s_waitcnt vmcnt(25)
    ds_bpermute_b32 v60, v222, v60
    v_mfma_f32_16x16x32_bf16 a[4:7], v[168:171], v[136:139], a[4:7]
    v_mfma_f32_16x16x32_bf16 a[8:11], v[168:171], v[140:143], a[8:11]
    buffer_load_dwordx4 v[116:119], v12, s[28:31], s58 offen offset:832
    s_waitcnt lgkmcnt(12)
    ds_read_b64_tr_b16 v[196:197], v29 offset:12416
    ds_read_b64_tr_b16 v[198:199], v29 offset:13952
    v_mfma_f32_16x16x32_bf16 a[12:15], v[172:175], v[132:135], a[12:15]
    ds_bpermute_b32 v61, v222, v61
    v_mfma_f32_16x16x32_bf16 a[16:19], v[172:175], v[136:139], a[16:19]
    v_mfma_f32_16x16x32_bf16 a[20:23], v[172:175], v[140:143], a[20:23]
    s_waitcnt lgkmcnt(12)
    ds_read_b64_tr_b16 v[200:201], v26 offset:12544
    ds_read_b64_tr_b16 v[202:203], v26 offset:14080
    v_mfma_f32_16x16x32_bf16 a[24:27], v[176:179], v[132:135], a[24:27]
    ds_bpermute_b32 v62, v222, v62
    v_mfma_f32_16x16x32_bf16 a[28:31], v[176:179], v[136:139], a[28:31]
    v_mfma_f32_16x16x32_bf16 a[32:35], v[176:179], v[140:143], a[32:35]
    s_waitcnt lgkmcnt(12)
    ds_read_b64_tr_b16 v[204:205], v27 offset:12544
    ds_read_b64_tr_b16 v[206:207], v27 offset:14080
    v_mfma_f32_16x16x32_bf16 a[36:39], v[180:183], v[132:135], a[36:39]
    ds_bpermute_b32 v63, v222, v63
    v_mfma_f32_16x16x32_bf16 a[40:43], v[180:183], v[136:139], a[40:43]
    v_mfma_f32_16x16x32_bf16 a[44:47], v[180:183], v[140:143], a[44:47]
    s_waitcnt lgkmcnt(12)
    ds_read_b64_tr_b16 v[208:209], v28 offset:12544
    ds_read_b64_tr_b16 v[210:211], v28 offset:14080
    v_mfma_f32_16x16x32_bf16 a[48:51], v[184:187], v[132:135], a[48:51]
    s_waitcnt vmcnt(25)
    ds_bpermute_b32 v64, v222, v64
    v_mfma_f32_16x16x32_bf16 a[52:55], v[184:187], v[136:139], a[52:55]
    v_mfma_f32_16x16x32_bf16 a[56:59], v[184:187], v[140:143], a[56:59]
    s_waitcnt lgkmcnt(12)
    ds_read_b64_tr_b16 v[212:213], v29 offset:12544
    ds_read_b64_tr_b16 v[214:215], v29 offset:14080
    v_mfma_f32_16x16x32_bf16 a[60:63], v[188:191], v[132:135], a[60:63]
    ds_bpermute_b32 v65, v222, v65
    v_mfma_f32_16x16x32_bf16 a[64:67], v[188:191], v[136:139], a[64:67]
    v_mfma_f32_16x16x32_bf16 a[68:71], v[188:191], v[140:143], a[68:71]
    s_barrier
    v_add_u32 v26, s64, v20
    v_add_u32 v27, s64, v21
    v_add_u32 v28, s64, v22
    v_add_u32 v29, s64, v23
    s_waitcnt lgkmcnt(12)
    ds_read_b64_tr_b16 v[168:169], v26 offset:0
    ds_read_b64_tr_b16 v[170:171], v26 offset:1536
    v_mfma_f32_16x16x32_bf16 a[72:75], v[192:195], v[132:135], a[72:75]
    ds_bpermute_b32 v66, v222, v66
    v_mfma_f32_16x16x32_bf16 a[76:79], v[192:195], v[136:139], a[76:79]
    v_mfma_f32_16x16x32_bf16 a[80:83], v[192:195], v[140:143], a[80:83]
    s_waitcnt lgkmcnt(12)
    ds_read_b64_tr_b16 v[172:173], v27 offset:0
    ds_read_b64_tr_b16 v[174:175], v27 offset:1536
    v_mfma_f32_16x16x32_bf16 a[84:87], v[196:199], v[132:135], a[84:87]
    ds_bpermute_b32 v67, v222, v67
    v_mfma_f32_16x16x32_bf16 a[88:91], v[196:199], v[136:139], a[88:91]
    s_add_u32 m0, s62, s66
    s_add_u32 s67, s57, 6291456
    buffer_load_dwordx4 v216, s[32:35], s67 offen offset:0 lds
    v_mfma_f32_16x16x32_bf16 a[92:95], v[196:199], v[140:143], a[92:95]
    s_waitcnt lgkmcnt(12)
    ds_read_b64_tr_b16 v[176:177], v28 offset:0
    ds_read_b64_tr_b16 v[178:179], v28 offset:1536
    v_mfma_f32_16x16x32_bf16 a[96:99], v[200:203], v[132:135], a[96:99]
    s_waitcnt vmcnt(25)
    ds_bpermute_b32 v68, v222, v68
    v_mfma_f32_16x16x32_bf16 a[100:103], v[200:203], v[136:139], a[100:103]
    v_mfma_f32_16x16x32_bf16 a[104:107], v[200:203], v[140:143], a[104:107]
    s_waitcnt lgkmcnt(12)
    ds_read_b64_tr_b16 v[180:181], v29 offset:0
    ds_read_b64_tr_b16 v[182:183], v29 offset:1536
    v_mfma_f32_16x16x32_bf16 a[108:111], v[204:207], v[132:135], a[108:111]
    buffer_load_dwordx4 v217, s[32:35], s67 offen offset:1024 lds
    ds_bpermute_b32 v69, v222, v69
    v_mfma_f32_16x16x32_bf16 a[112:115], v[204:207], v[136:139], a[112:115]
    v_mfma_f32_16x16x32_bf16 a[116:119], v[204:207], v[140:143], a[116:119]
    s_waitcnt lgkmcnt(12)
    ds_read_b64_tr_b16 v[184:185], v26 offset:128
    ds_read_b64_tr_b16 v[186:187], v26 offset:1664
    v_mfma_f32_16x16x32_bf16 a[120:123], v[208:211], v[132:135], a[120:123]
    ds_bpermute_b32 v70, v222, v70
    v_mfma_f32_16x16x32_bf16 a[124:127], v[208:211], v[136:139], a[124:127]
    v_mfma_f32_16x16x32_bf16 a[128:131], v[208:211], v[140:143], a[128:131]
    buffer_load_dwordx4 v218, s[32:35], s67 offen offset:2048 lds
    s_waitcnt lgkmcnt(12)
    ds_read_b64_tr_b16 v[188:189], v27 offset:128
    ds_read_b64_tr_b16 v[190:191], v27 offset:1664
    v_mfma_f32_16x16x32_bf16 a[132:135], v[212:215], v[132:135], a[132:135]
    ds_bpermute_b32 v71, v222, v71
    v_mfma_f32_16x16x32_bf16 a[136:139], v[212:215], v[136:139], a[136:139]
    v_mfma_f32_16x16x32_bf16 a[140:143], v[212:215], v[140:143], a[140:143]
    s_waitcnt lgkmcnt(12)
    ds_read_b64_tr_b16 v[192:193], v28 offset:128
    ds_read_b64_tr_b16 v[194:195], v28 offset:1664
    v_mfma_f32_16x16x32_bf16 a[0:3], v[168:171], v[48:51], a[0:3]
    s_waitcnt vmcnt(20)
    ds_bpermute_b32 v72, v222, v72
    v_mfma_f32_16x16x32_bf16 a[4:7], v[168:171], v[52:55], a[4:7]
    s_add_u32 m0, m0, 3072
    s_nop 0
    buffer_load_dwordx4 v219, s[32:35], s67 offen offset:0 lds
    v_mfma_f32_16x16x32_bf16 a[8:11], v[168:171], v[56:59], a[8:11]
    s_waitcnt lgkmcnt(12)
    ds_read_b64_tr_b16 v[196:197], v29 offset:128
    ds_read_b64_tr_b16 v[198:199], v29 offset:1664
    v_mfma_f32_16x16x32_bf16 a[12:15], v[172:175], v[48:51], a[12:15]
    ds_bpermute_b32 v73, v222, v73
    v_mfma_f32_16x16x32_bf16 a[16:19], v[172:175], v[52:55], a[16:19]
    v_mfma_f32_16x16x32_bf16 a[20:23], v[172:175], v[56:59], a[20:23]
    s_waitcnt lgkmcnt(12)
    ds_read_b64_tr_b16 v[200:201], v26 offset:256
    ds_read_b64_tr_b16 v[202:203], v26 offset:1792
    v_mfma_f32_16x16x32_bf16 a[24:27], v[176:179], v[48:51], a[24:27]
    buffer_load_dwordx4 v220, s[32:35], s67 offen offset:1024 lds
    ds_bpermute_b32 v74, v222, v74
    v_mfma_f32_16x16x32_bf16 a[28:31], v[176:179], v[52:55], a[28:31]
    v_mfma_f32_16x16x32_bf16 a[32:35], v[176:179], v[56:59], a[32:35]
    s_waitcnt lgkmcnt(12)
    ds_read_b64_tr_b16 v[204:205], v27 offset:256
    ds_read_b64_tr_b16 v[206:207], v27 offset:1792
    v_mfma_f32_16x16x32_bf16 a[36:39], v[180:183], v[48:51], a[36:39]
    ds_bpermute_b32 v75, v222, v75
    v_mfma_f32_16x16x32_bf16 a[40:43], v[180:183], v[52:55], a[40:43]
    v_mfma_f32_16x16x32_bf16 a[44:47], v[180:183], v[56:59], a[44:47]
    buffer_load_dwordx4 v221, s[32:35], s67 offen offset:2048 lds
    s_waitcnt lgkmcnt(12)
    ds_read_b64_tr_b16 v[208:209], v28 offset:256
    ds_read_b64_tr_b16 v[210:211], v28 offset:1792
    v_mfma_f32_16x16x32_bf16 a[48:51], v[184:187], v[48:51], a[48:51]
    s_waitcnt vmcnt(22)
    ds_bpermute_b32 v76, v222, v76
    v_mfma_f32_16x16x32_bf16 a[52:55], v[184:187], v[52:55], a[52:55]
    v_mfma_f32_16x16x32_bf16 a[56:59], v[184:187], v[56:59], a[56:59]
    s_waitcnt lgkmcnt(12)
    ds_read_b64_tr_b16 v[212:213], v29 offset:256
    ds_read_b64_tr_b16 v[214:215], v29 offset:1792
    v_mfma_f32_16x16x32_bf16 a[60:63], v[188:191], v[48:51], a[60:63]
    ds_bpermute_b32 v77, v222, v77
    v_mfma_f32_16x16x32_bf16 a[64:67], v[188:191], v[52:55], a[64:67]
    buffer_load_dwordx4 v[120:123], v10, s[28:31], s58 offen offset:896
    v_mfma_f32_16x16x32_bf16 a[68:71], v[188:191], v[56:59], a[68:71]
    s_waitcnt lgkmcnt(12)
    ds_read_b64_tr_b16 v[168:169], v26 offset:12288
    ds_read_b64_tr_b16 v[170:171], v26 offset:13824
    v_mfma_f32_16x16x32_bf16 a[72:75], v[192:195], v[48:51], a[72:75]
    ds_bpermute_b32 v78, v222, v78
    v_mfma_f32_16x16x32_bf16 a[76:79], v[192:195], v[52:55], a[76:79]
    v_mfma_f32_16x16x32_bf16 a[80:83], v[192:195], v[56:59], a[80:83]
    s_waitcnt lgkmcnt(12)
    ds_read_b64_tr_b16 v[172:173], v27 offset:12288
    ds_read_b64_tr_b16 v[174:175], v27 offset:13824
    v_mfma_f32_16x16x32_bf16 a[84:87], v[196:199], v[48:51], a[84:87]
    buffer_load_dwordx4 v[124:127], v11, s[28:31], s58 offen offset:896
    ds_bpermute_b32 v79, v222, v79
    v_mfma_f32_16x16x32_bf16 a[88:91], v[196:199], v[52:55], a[88:91]
    v_mfma_f32_16x16x32_bf16 a[92:95], v[196:199], v[56:59], a[92:95]
    s_waitcnt lgkmcnt(12)
    ds_read_b64_tr_b16 v[176:177], v28 offset:12288
    ds_read_b64_tr_b16 v[178:179], v28 offset:13824
    v_mfma_f32_16x16x32_bf16 a[96:99], v[200:203], v[48:51], a[96:99]
    s_waitcnt vmcnt(23)
    ds_bpermute_b32 v80, v222, v80
    v_mfma_f32_16x16x32_bf16 a[100:103], v[200:203], v[52:55], a[100:103]
    v_mfma_f32_16x16x32_bf16 a[104:107], v[200:203], v[56:59], a[104:107]
    buffer_load_dwordx4 v[128:131], v12, s[28:31], s58 offen offset:896
    s_waitcnt lgkmcnt(12)
    ds_read_b64_tr_b16 v[180:181], v29 offset:12288
    ds_read_b64_tr_b16 v[182:183], v29 offset:13824
    v_mfma_f32_16x16x32_bf16 a[108:111], v[204:207], v[48:51], a[108:111]
    ds_bpermute_b32 v81, v222, v81
    v_mfma_f32_16x16x32_bf16 a[112:115], v[204:207], v[52:55], a[112:115]
    v_mfma_f32_16x16x32_bf16 a[116:119], v[204:207], v[56:59], a[116:119]
    s_waitcnt lgkmcnt(12)
    ds_read_b64_tr_b16 v[184:185], v26 offset:12416
    ds_read_b64_tr_b16 v[186:187], v26 offset:13952
    v_mfma_f32_16x16x32_bf16 a[120:123], v[208:211], v[48:51], a[120:123]
    ds_bpermute_b32 v82, v222, v82
    v_mfma_f32_16x16x32_bf16 a[124:127], v[208:211], v[52:55], a[124:127]
    buffer_load_dwordx4 v[132:135], v10, s[28:31], s58 offen offset:960
    v_mfma_f32_16x16x32_bf16 a[128:131], v[208:211], v[56:59], a[128:131]
    s_waitcnt lgkmcnt(12)
    ds_read_b64_tr_b16 v[188:189], v27 offset:12416
    ds_read_b64_tr_b16 v[190:191], v27 offset:13952
    v_mfma_f32_16x16x32_bf16 a[132:135], v[212:215], v[48:51], a[132:135]
    ds_bpermute_b32 v83, v222, v83
    v_mfma_f32_16x16x32_bf16 a[136:139], v[212:215], v[52:55], a[136:139]
    v_mfma_f32_16x16x32_bf16 a[140:143], v[212:215], v[56:59], a[140:143]
    s_waitcnt lgkmcnt(12)
    ds_read_b64_tr_b16 v[192:193], v28 offset:12416
    ds_read_b64_tr_b16 v[194:195], v28 offset:13952
    v_mfma_f32_16x16x32_bf16 a[0:3], v[168:171], v[60:63], a[0:3]
    buffer_load_dwordx4 v[136:139], v11, s[28:31], s58 offen offset:960
    s_waitcnt vmcnt(25)
    ds_bpermute_b32 v84, v222, v84
    v_mfma_f32_16x16x32_bf16 a[4:7], v[168:171], v[64:67], a[4:7]
    v_mfma_f32_16x16x32_bf16 a[8:11], v[168:171], v[68:71], a[8:11]
    s_waitcnt lgkmcnt(12)
    ds_read_b64_tr_b16 v[196:197], v29 offset:12416
    ds_read_b64_tr_b16 v[198:199], v29 offset:13952
    v_mfma_f32_16x16x32_bf16 a[12:15], v[172:175], v[60:63], a[12:15]
    ds_bpermute_b32 v85, v222, v85
    v_mfma_f32_16x16x32_bf16 a[16:19], v[172:175], v[64:67], a[16:19]
    v_mfma_f32_16x16x32_bf16 a[20:23], v[172:175], v[68:71], a[20:23]
    buffer_load_dwordx4 v[140:143], v12, s[28:31], s58 offen offset:960
    s_waitcnt lgkmcnt(12)
    ds_read_b64_tr_b16 v[200:201], v26 offset:12544
    ds_read_b64_tr_b16 v[202:203], v26 offset:14080
    v_mfma_f32_16x16x32_bf16 a[24:27], v[176:179], v[60:63], a[24:27]
    ds_bpermute_b32 v86, v222, v86
    v_mfma_f32_16x16x32_bf16 a[28:31], v[176:179], v[64:67], a[28:31]
    v_mfma_f32_16x16x32_bf16 a[32:35], v[176:179], v[68:71], a[32:35]
    s_waitcnt lgkmcnt(12)
    ds_read_b64_tr_b16 v[204:205], v27 offset:12544
    ds_read_b64_tr_b16 v[206:207], v27 offset:14080
    v_mfma_f32_16x16x32_bf16 a[36:39], v[180:183], v[60:63], a[36:39]
    ds_bpermute_b32 v87, v222, v87
    v_mfma_f32_16x16x32_bf16 a[40:43], v[180:183], v[64:67], a[40:43]
    v_mfma_f32_16x16x32_bf16 a[44:47], v[180:183], v[68:71], a[44:47]
    s_waitcnt lgkmcnt(12)
    ds_read_b64_tr_b16 v[208:209], v28 offset:12544
    ds_read_b64_tr_b16 v[210:211], v28 offset:14080
    v_mfma_f32_16x16x32_bf16 a[48:51], v[184:187], v[60:63], a[48:51]
    s_waitcnt vmcnt(25)
    ds_bpermute_b32 v88, v222, v88
    v_mfma_f32_16x16x32_bf16 a[52:55], v[184:187], v[64:67], a[52:55]
    v_mfma_f32_16x16x32_bf16 a[56:59], v[184:187], v[68:71], a[56:59]
    s_waitcnt lgkmcnt(12)
    ds_read_b64_tr_b16 v[212:213], v29 offset:12544
    ds_read_b64_tr_b16 v[214:215], v29 offset:14080
    v_mfma_f32_16x16x32_bf16 a[60:63], v[188:191], v[60:63], a[60:63]
    ds_bpermute_b32 v89, v222, v89
    v_mfma_f32_16x16x32_bf16 a[64:67], v[188:191], v[64:67], a[64:67]
    v_mfma_f32_16x16x32_bf16 a[68:71], v[188:191], v[68:71], a[68:71]
    s_barrier
    v_add_u32 v26, s65, v20
    v_add_u32 v27, s65, v21
    v_add_u32 v28, s65, v22
    v_add_u32 v29, s65, v23
    s_waitcnt lgkmcnt(12)
    ds_read_b64_tr_b16 v[168:169], v26 offset:0
    ds_read_b64_tr_b16 v[170:171], v26 offset:1536
    v_mfma_f32_16x16x32_bf16 a[72:75], v[192:195], v[60:63], a[72:75]
    ds_bpermute_b32 v90, v222, v90
    v_mfma_f32_16x16x32_bf16 a[76:79], v[192:195], v[64:67], a[76:79]
    v_mfma_f32_16x16x32_bf16 a[80:83], v[192:195], v[68:71], a[80:83]
    s_add_u32 m0, s63, s66
    s_add_u32 s67, s57, 7077888
    buffer_load_dwordx4 v216, s[32:35], s67 offen offset:0 lds
    s_waitcnt lgkmcnt(12)
    ds_read_b64_tr_b16 v[172:173], v27 offset:0
    ds_read_b64_tr_b16 v[174:175], v27 offset:1536
    v_mfma_f32_16x16x32_bf16 a[84:87], v[196:199], v[60:63], a[84:87]
    ds_bpermute_b32 v91, v222, v91
    v_mfma_f32_16x16x32_bf16 a[88:91], v[196:199], v[64:67], a[88:91]
    v_mfma_f32_16x16x32_bf16 a[92:95], v[196:199], v[68:71], a[92:95]
    s_waitcnt lgkmcnt(12)
    ds_read_b64_tr_b16 v[176:177], v28 offset:0
    ds_read_b64_tr_b16 v[178:179], v28 offset:1536
    v_mfma_f32_16x16x32_bf16 a[96:99], v[200:203], v[60:63], a[96:99]
    s_waitcnt vmcnt(25)
    ds_bpermute_b32 v92, v222, v92
    v_mfma_f32_16x16x32_bf16 a[100:103], v[200:203], v[64:67], a[100:103]
    buffer_load_dwordx4 v217, s[32:35], s67 offen offset:1024 lds
    v_mfma_f32_16x16x32_bf16 a[104:107], v[200:203], v[68:71], a[104:107]
    s_waitcnt lgkmcnt(12)
    ds_read_b64_tr_b16 v[180:181], v29 offset:0
    ds_read_b64_tr_b16 v[182:183], v29 offset:1536
    v_mfma_f32_16x16x32_bf16 a[108:111], v[204:207], v[60:63], a[108:111]
    ds_bpermute_b32 v93, v222, v93
    v_mfma_f32_16x16x32_bf16 a[112:115], v[204:207], v[64:67], a[112:115]
    v_mfma_f32_16x16x32_bf16 a[116:119], v[204:207], v[68:71], a[116:119]
    s_waitcnt lgkmcnt(12)
    ds_read_b64_tr_b16 v[184:185], v26 offset:128
    ds_read_b64_tr_b16 v[186:187], v26 offset:1664
    v_mfma_f32_16x16x32_bf16 a[120:123], v[208:211], v[60:63], a[120:123]
    buffer_load_dwordx4 v218, s[32:35], s67 offen offset:2048 lds
    ds_bpermute_b32 v94, v222, v94
    v_mfma_f32_16x16x32_bf16 a[124:127], v[208:211], v[64:67], a[124:127]
    v_mfma_f32_16x16x32_bf16 a[128:131], v[208:211], v[68:71], a[128:131]
    s_waitcnt lgkmcnt(12)
    ds_read_b64_tr_b16 v[188:189], v27 offset:128
    ds_read_b64_tr_b16 v[190:191], v27 offset:1664
    v_mfma_f32_16x16x32_bf16 a[132:135], v[212:215], v[60:63], a[132:135]
    ds_bpermute_b32 v95, v222, v95
    v_mfma_f32_16x16x32_bf16 a[136:139], v[212:215], v[64:67], a[136:139]
    v_mfma_f32_16x16x32_bf16 a[140:143], v[212:215], v[68:71], a[140:143]
    s_add_u32 m0, m0, 3072
    s_nop 0
    buffer_load_dwordx4 v219, s[32:35], s67 offen offset:0 lds
    s_waitcnt lgkmcnt(12)
    ds_read_b64_tr_b16 v[192:193], v28 offset:128
    ds_read_b64_tr_b16 v[194:195], v28 offset:1664
    v_mfma_f32_16x16x32_bf16 a[0:3], v[168:171], v[72:75], a[0:3]
    s_waitcnt vmcnt(21)
    ds_bpermute_b32 v96, v222, v96
    v_mfma_f32_16x16x32_bf16 a[4:7], v[168:171], v[76:79], a[4:7]
    v_mfma_f32_16x16x32_bf16 a[8:11], v[168:171], v[80:83], a[8:11]
    s_waitcnt lgkmcnt(12)
    ds_read_b64_tr_b16 v[196:197], v29 offset:128
    ds_read_b64_tr_b16 v[198:199], v29 offset:1664
    v_mfma_f32_16x16x32_bf16 a[12:15], v[172:175], v[72:75], a[12:15]
    ds_bpermute_b32 v97, v222, v97
    v_mfma_f32_16x16x32_bf16 a[16:19], v[172:175], v[76:79], a[16:19]
    buffer_load_dwordx4 v220, s[32:35], s67 offen offset:1024 lds
    v_mfma_f32_16x16x32_bf16 a[20:23], v[172:175], v[80:83], a[20:23]
    s_waitcnt lgkmcnt(12)
    ds_read_b64_tr_b16 v[200:201], v26 offset:256
    ds_read_b64_tr_b16 v[202:203], v26 offset:1792
    v_mfma_f32_16x16x32_bf16 a[24:27], v[176:179], v[72:75], a[24:27]
    ds_bpermute_b32 v98, v222, v98
    v_mfma_f32_16x16x32_bf16 a[28:31], v[176:179], v[76:79], a[28:31]
    v_mfma_f32_16x16x32_bf16 a[32:35], v[176:179], v[80:83], a[32:35]
    s_waitcnt lgkmcnt(12)
    ds_read_b64_tr_b16 v[204:205], v27 offset:256
    ds_read_b64_tr_b16 v[206:207], v27 offset:1792
    v_mfma_f32_16x16x32_bf16 a[36:39], v[180:183], v[72:75], a[36:39]
    buffer_load_dwordx4 v221, s[32:35], s67 offen offset:2048 lds
    ds_bpermute_b32 v99, v222, v99
    v_mfma_f32_16x16x32_bf16 a[40:43], v[180:183], v[76:79], a[40:43]
    v_mfma_f32_16x16x32_bf16 a[44:47], v[180:183], v[80:83], a[44:47]
    s_waitcnt lgkmcnt(12)
    ds_read_b64_tr_b16 v[208:209], v28 offset:256
    ds_read_b64_tr_b16 v[210:211], v28 offset:1792
    v_mfma_f32_16x16x32_bf16 a[48:51], v[184:187], v[72:75], a[48:51]
    s_waitcnt vmcnt(22)
    ds_bpermute_b32 v100, v222, v100
    v_mfma_f32_16x16x32_bf16 a[52:55], v[184:187], v[76:79], a[52:55]
    v_mfma_f32_16x16x32_bf16 a[56:59], v[184:187], v[80:83], a[56:59]
    buffer_load_dwordx4 v[48:51], v10, s[28:31], s58 offen offset:1024
    s_waitcnt lgkmcnt(12)
    ds_read_b64_tr_b16 v[212:213], v29 offset:256
    ds_read_b64_tr_b16 v[214:215], v29 offset:1792
    v_mfma_f32_16x16x32_bf16 a[60:63], v[188:191], v[72:75], a[60:63]
    ds_bpermute_b32 v101, v222, v101
    v_mfma_f32_16x16x32_bf16 a[64:67], v[188:191], v[76:79], a[64:67]
    v_mfma_f32_16x16x32_bf16 a[68:71], v[188:191], v[80:83], a[68:71]
    s_waitcnt lgkmcnt(12)
    ds_read_b64_tr_b16 v[168:169], v26 offset:12288
    ds_read_b64_tr_b16 v[170:171], v26 offset:13824
    v_mfma_f32_16x16x32_bf16 a[72:75], v[192:195], v[72:75], a[72:75]
    ds_bpermute_b32 v102, v222, v102
    v_mfma_f32_16x16x32_bf16 a[76:79], v[192:195], v[76:79], a[76:79]
    buffer_load_dwordx4 v[52:55], v11, s[28:31], s58 offen offset:1024
    v_mfma_f32_16x16x32_bf16 a[80:83], v[192:195], v[80:83], a[80:83]
    s_waitcnt lgkmcnt(12)
    ds_read_b64_tr_b16 v[172:173], v27 offset:12288
    ds_read_b64_tr_b16 v[174:175], v27 offset:13824
    v_mfma_f32_16x16x32_bf16 a[84:87], v[196:199], v[72:75], a[84:87]
    ds_bpermute_b32 v103, v222, v103
    v_mfma_f32_16x16x32_bf16 a[88:91], v[196:199], v[76:79], a[88:91]
    v_mfma_f32_16x16x32_bf16 a[92:95], v[196:199], v[80:83], a[92:95]
    s_waitcnt lgkmcnt(12)
    ds_read_b64_tr_b16 v[176:177], v28 offset:12288
    ds_read_b64_tr_b16 v[178:179], v28 offset:13824
    v_mfma_f32_16x16x32_bf16 a[96:99], v[200:203], v[72:75], a[96:99]
    buffer_load_dwordx4 v[56:59], v12, s[28:31], s58 offen offset:1024
    s_waitcnt vmcnt(24)
    ds_bpermute_b32 v104, v222, v104
    v_mfma_f32_16x16x32_bf16 a[100:103], v[200:203], v[76:79], a[100:103]
    v_mfma_f32_16x16x32_bf16 a[104:107], v[200:203], v[80:83], a[104:107]
    s_waitcnt lgkmcnt(12)
    ds_read_b64_tr_b16 v[180:181], v29 offset:12288
    ds_read_b64_tr_b16 v[182:183], v29 offset:13824
    v_mfma_f32_16x16x32_bf16 a[108:111], v[204:207], v[72:75], a[108:111]
    ds_bpermute_b32 v105, v222, v105
    v_mfma_f32_16x16x32_bf16 a[112:115], v[204:207], v[76:79], a[112:115]
    v_mfma_f32_16x16x32_bf16 a[116:119], v[204:207], v[80:83], a[116:119]
    buffer_load_dwordx4 v[60:63], v10, s[28:31], s58 offen offset:1088
    s_waitcnt lgkmcnt(12)
    ds_read_b64_tr_b16 v[184:185], v26 offset:12416
    ds_read_b64_tr_b16 v[186:187], v26 offset:13952
    v_mfma_f32_16x16x32_bf16 a[120:123], v[208:211], v[72:75], a[120:123]
    ds_bpermute_b32 v106, v222, v106
    v_mfma_f32_16x16x32_bf16 a[124:127], v[208:211], v[76:79], a[124:127]
    v_mfma_f32_16x16x32_bf16 a[128:131], v[208:211], v[80:83], a[128:131]
    s_waitcnt lgkmcnt(12)
    ds_read_b64_tr_b16 v[188:189], v27 offset:12416
    ds_read_b64_tr_b16 v[190:191], v27 offset:13952
    v_mfma_f32_16x16x32_bf16 a[132:135], v[212:215], v[72:75], a[132:135]
    ds_bpermute_b32 v107, v222, v107
    v_mfma_f32_16x16x32_bf16 a[136:139], v[212:215], v[76:79], a[136:139]
    buffer_load_dwordx4 v[64:67], v11, s[28:31], s58 offen offset:1088
    v_mfma_f32_16x16x32_bf16 a[140:143], v[212:215], v[80:83], a[140:143]
    s_waitcnt lgkmcnt(12)
    ds_read_b64_tr_b16 v[192:193], v28 offset:12416
    ds_read_b64_tr_b16 v[194:195], v28 offset:13952
    v_mfma_f32_16x16x32_bf16 a[0:3], v[168:171], v[84:87], a[0:3]
    s_waitcnt vmcnt(25)
    ds_bpermute_b32 v108, v222, v108
    v_mfma_f32_16x16x32_bf16 a[4:7], v[168:171], v[88:91], a[4:7]
    v_mfma_f32_16x16x32_bf16 a[8:11], v[168:171], v[92:95], a[8:11]
    s_waitcnt lgkmcnt(12)
    ds_read_b64_tr_b16 v[196:197], v29 offset:12416
    ds_read_b64_tr_b16 v[198:199], v29 offset:13952
    v_mfma_f32_16x16x32_bf16 a[12:15], v[172:175], v[84:87], a[12:15]
    buffer_load_dwordx4 v[68:71], v12, s[28:31], s58 offen offset:1088
    ds_bpermute_b32 v109, v222, v109
    v_mfma_f32_16x16x32_bf16 a[16:19], v[172:175], v[88:91], a[16:19]
    v_mfma_f32_16x16x32_bf16 a[20:23], v[172:175], v[92:95], a[20:23]
    s_waitcnt lgkmcnt(12)
    ds_read_b64_tr_b16 v[200:201], v26 offset:12544
    ds_read_b64_tr_b16 v[202:203], v26 offset:14080
    v_mfma_f32_16x16x32_bf16 a[24:27], v[176:179], v[84:87], a[24:27]
    ds_bpermute_b32 v110, v222, v110
    v_mfma_f32_16x16x32_bf16 a[28:31], v[176:179], v[88:91], a[28:31]
    v_mfma_f32_16x16x32_bf16 a[32:35], v[176:179], v[92:95], a[32:35]
    s_waitcnt lgkmcnt(12)
    ds_read_b64_tr_b16 v[204:205], v27 offset:12544
    ds_read_b64_tr_b16 v[206:207], v27 offset:14080
    v_mfma_f32_16x16x32_bf16 a[36:39], v[180:183], v[84:87], a[36:39]
    ds_bpermute_b32 v111, v222, v111
    v_mfma_f32_16x16x32_bf16 a[40:43], v[180:183], v[88:91], a[40:43]
    v_mfma_f32_16x16x32_bf16 a[44:47], v[180:183], v[92:95], a[44:47]
    s_waitcnt lgkmcnt(12)
    ds_read_b64_tr_b16 v[208:209], v28 offset:12544
    ds_read_b64_tr_b16 v[210:211], v28 offset:14080
    v_mfma_f32_16x16x32_bf16 a[48:51], v[184:187], v[84:87], a[48:51]
    s_waitcnt vmcnt(25)
    ds_bpermute_b32 v112, v222, v112
    v_mfma_f32_16x16x32_bf16 a[52:55], v[184:187], v[88:91], a[52:55]
    v_mfma_f32_16x16x32_bf16 a[56:59], v[184:187], v[92:95], a[56:59]
    s_waitcnt lgkmcnt(12)
    ds_read_b64_tr_b16 v[212:213], v29 offset:12544
    ds_read_b64_tr_b16 v[214:215], v29 offset:14080
    v_mfma_f32_16x16x32_bf16 a[60:63], v[188:191], v[84:87], a[60:63]
    ds_bpermute_b32 v113, v222, v113
    v_mfma_f32_16x16x32_bf16 a[64:67], v[188:191], v[88:91], a[64:67]
    v_mfma_f32_16x16x32_bf16 a[68:71], v[188:191], v[92:95], a[68:71]
    s_barrier
    v_add_u32 v26, s60, v20
    v_add_u32 v27, s60, v21
    v_add_u32 v28, s60, v22
    v_add_u32 v29, s60, v23
    s_waitcnt lgkmcnt(12)
    ds_read_b64_tr_b16 v[168:169], v26 offset:0
    ds_read_b64_tr_b16 v[170:171], v26 offset:1536
    v_mfma_f32_16x16x32_bf16 a[72:75], v[192:195], v[84:87], a[72:75]
    s_add_u32 m0, s64, s66
    s_add_u32 s67, s56, 0
    buffer_load_dwordx4 v4, s[40:43], s67 offen offset:0 nt lds
    ds_bpermute_b32 v114, v222, v114
    v_mfma_f32_16x16x32_bf16 a[76:79], v[192:195], v[88:91], a[76:79]
    v_mfma_f32_16x16x32_bf16 a[80:83], v[192:195], v[92:95], a[80:83]
    s_waitcnt lgkmcnt(12)
    ds_read_b64_tr_b16 v[172:173], v27 offset:0
    ds_read_b64_tr_b16 v[174:175], v27 offset:1536
    v_mfma_f32_16x16x32_bf16 a[84:87], v[196:199], v[84:87], a[84:87]
    ds_bpermute_b32 v115, v222, v115
    v_mfma_f32_16x16x32_bf16 a[88:91], v[196:199], v[88:91], a[88:91]
    v_mfma_f32_16x16x32_bf16 a[92:95], v[196:199], v[92:95], a[92:95]
    buffer_load_dwordx4 v5, s[40:43], s67 offen offset:1024 nt lds
    s_waitcnt lgkmcnt(12)
    ds_read_b64_tr_b16 v[176:177], v28 offset:0
    ds_read_b64_tr_b16 v[178:179], v28 offset:1536
    v_mfma_f32_16x16x32_bf16 a[96:99], v[200:203], v[84:87], a[96:99]
    s_waitcnt vmcnt(26)
    ds_bpermute_b32 v116, v222, v116
    v_mfma_f32_16x16x32_bf16 a[100:103], v[200:203], v[88:91], a[100:103]
    v_mfma_f32_16x16x32_bf16 a[104:107], v[200:203], v[92:95], a[104:107]
    s_waitcnt lgkmcnt(12)
    ds_read_b64_tr_b16 v[180:181], v29 offset:0
    ds_read_b64_tr_b16 v[182:183], v29 offset:1536
    v_mfma_f32_16x16x32_bf16 a[108:111], v[204:207], v[84:87], a[108:111]
    ds_bpermute_b32 v117, v222, v117
    v_mfma_f32_16x16x32_bf16 a[112:115], v[204:207], v[88:91], a[112:115]
    buffer_load_dwordx4 v6, s[40:43], s67 offen offset:2048 nt lds
    v_mfma_f32_16x16x32_bf16 a[116:119], v[204:207], v[92:95], a[116:119]
    s_waitcnt lgkmcnt(12)
    ds_read_b64_tr_b16 v[184:185], v26 offset:128
    ds_read_b64_tr_b16 v[186:187], v26 offset:1664
    v_mfma_f32_16x16x32_bf16 a[120:123], v[208:211], v[84:87], a[120:123]
    ds_bpermute_b32 v118, v222, v118
    v_mfma_f32_16x16x32_bf16 a[124:127], v[208:211], v[88:91], a[124:127]
    v_mfma_f32_16x16x32_bf16 a[128:131], v[208:211], v[92:95], a[128:131]
    s_waitcnt lgkmcnt(12)
    ds_read_b64_tr_b16 v[188:189], v27 offset:128
    ds_read_b64_tr_b16 v[190:191], v27 offset:1664
    v_mfma_f32_16x16x32_bf16 a[132:135], v[212:215], v[84:87], a[132:135]
    s_add_u32 m0, m0, 3072
    s_add_u32 s67, s67, 3072
    buffer_load_dwordx4 v4, s[40:43], s67 offen offset:0 nt lds
    ds_bpermute_b32 v119, v222, v119
    v_mfma_f32_16x16x32_bf16 a[136:139], v[212:215], v[88:91], a[136:139]
    v_mfma_f32_16x16x32_bf16 a[140:143], v[212:215], v[92:95], a[140:143]
    s_waitcnt lgkmcnt(12)
    ds_read_b64_tr_b16 v[192:193], v28 offset:128
    ds_read_b64_tr_b16 v[194:195], v28 offset:1664
    v_mfma_f32_16x16x32_bf16 a[0:3], v[168:171], v[96:99], a[0:3]
    s_waitcnt vmcnt(21)
    ds_bpermute_b32 v120, v222, v120
    v_mfma_f32_16x16x32_bf16 a[4:7], v[168:171], v[100:103], a[4:7]
    v_mfma_f32_16x16x32_bf16 a[8:11], v[168:171], v[104:107], a[8:11]
    buffer_load_dwordx4 v5, s[40:43], s67 offen offset:1024 nt lds
    s_waitcnt lgkmcnt(12)
    ds_read_b64_tr_b16 v[196:197], v29 offset:128
    ds_read_b64_tr_b16 v[198:199], v29 offset:1664
    v_mfma_f32_16x16x32_bf16 a[12:15], v[172:175], v[96:99], a[12:15]
    ds_bpermute_b32 v121, v222, v121
    v_mfma_f32_16x16x32_bf16 a[16:19], v[172:175], v[100:103], a[16:19]
    v_mfma_f32_16x16x32_bf16 a[20:23], v[172:175], v[104:107], a[20:23]
    s_waitcnt lgkmcnt(12)
    ds_read_b64_tr_b16 v[200:201], v26 offset:256
    ds_read_b64_tr_b16 v[202:203], v26 offset:1792
    v_mfma_f32_16x16x32_bf16 a[24:27], v[176:179], v[96:99], a[24:27]
    ds_bpermute_b32 v122, v222, v122
    v_mfma_f32_16x16x32_bf16 a[28:31], v[176:179], v[100:103], a[28:31]
    buffer_load_dwordx4 v6, s[40:43], s67 offen offset:2048 nt lds
    v_mfma_f32_16x16x32_bf16 a[32:35], v[176:179], v[104:107], a[32:35]
    s_waitcnt lgkmcnt(12)
    ds_read_b64_tr_b16 v[204:205], v27 offset:256
    ds_read_b64_tr_b16 v[206:207], v27 offset:1792
    v_mfma_f32_16x16x32_bf16 a[36:39], v[180:183], v[96:99], a[36:39]
    ds_bpermute_b32 v123, v222, v123
    v_mfma_f32_16x16x32_bf16 a[40:43], v[180:183], v[100:103], a[40:43]
    v_mfma_f32_16x16x32_bf16 a[44:47], v[180:183], v[104:107], a[44:47]
    s_waitcnt lgkmcnt(12)
    ds_read_b64_tr_b16 v[208:209], v28 offset:256
    ds_read_b64_tr_b16 v[210:211], v28 offset:1792
    v_mfma_f32_16x16x32_bf16 a[48:51], v[184:187], v[96:99], a[48:51]
    buffer_load_dwordx4 v[72:75], v10, s[28:31], s58 offen offset:1152
    s_waitcnt vmcnt(23)
    ds_bpermute_b32 v124, v222, v124
    v_mfma_f32_16x16x32_bf16 a[52:55], v[184:187], v[100:103], a[52:55]
    v_mfma_f32_16x16x32_bf16 a[56:59], v[184:187], v[104:107], a[56:59]
    s_waitcnt lgkmcnt(12)
    ds_read_b64_tr_b16 v[212:213], v29 offset:256
    ds_read_b64_tr_b16 v[214:215], v29 offset:1792
    v_mfma_f32_16x16x32_bf16 a[60:63], v[188:191], v[96:99], a[60:63]
    ds_bpermute_b32 v125, v222, v125
    v_mfma_f32_16x16x32_bf16 a[64:67], v[188:191], v[100:103], a[64:67]
    v_mfma_f32_16x16x32_bf16 a[68:71], v[188:191], v[104:107], a[68:71]
    buffer_load_dwordx4 v[76:79], v11, s[28:31], s58 offen offset:1152
    s_waitcnt lgkmcnt(12)
    ds_read_b64_tr_b16 v[168:169], v26 offset:12288
    ds_read_b64_tr_b16 v[170:171], v26 offset:13824
    v_mfma_f32_16x16x32_bf16 a[72:75], v[192:195], v[96:99], a[72:75]
    ds_bpermute_b32 v126, v222, v126
    v_mfma_f32_16x16x32_bf16 a[76:79], v[192:195], v[100:103], a[76:79]
    v_mfma_f32_16x16x32_bf16 a[80:83], v[192:195], v[104:107], a[80:83]
    s_waitcnt lgkmcnt(12)
    ds_read_b64_tr_b16 v[172:173], v27 offset:12288
    ds_read_b64_tr_b16 v[174:175], v27 offset:13824
    v_mfma_f32_16x16x32_bf16 a[84:87], v[196:199], v[96:99], a[84:87]
    ds_bpermute_b32 v127, v222, v127
    v_mfma_f32_16x16x32_bf16 a[88:91], v[196:199], v[100:103], a[88:91]
    buffer_load_dwordx4 v[80:83], v12, s[28:31], s58 offen offset:1152
    v_mfma_f32_16x16x32_bf16 a[92:95], v[196:199], v[104:107], a[92:95]
    s_waitcnt lgkmcnt(12)
    ds_read_b64_tr_b16 v[176:177], v28 offset:12288
    ds_read_b64_tr_b16 v[178:179], v28 offset:13824
    v_mfma_f32_16x16x32_bf16 a[96:99], v[200:203], v[96:99], a[96:99]
    s_waitcnt vmcnt(24)
    ds_bpermute_b32 v128, v222, v128
    v_mfma_f32_16x16x32_bf16 a[100:103], v[200:203], v[100:103], a[100:103]
    v_mfma_f32_16x16x32_bf16 a[104:107], v[200:203], v[104:107], a[104:107]
    s_waitcnt lgkmcnt(12)
    ds_read_b64_tr_b16 v[180:181], v29 offset:12288
    ds_read_b64_tr_b16 v[182:183], v29 offset:13824
    v_mfma_f32_16x16x32_bf16 a[108:111], v[204:207], v[96:99], a[108:111]
    buffer_load_dwordx4 v[84:87], v10, s[28:31], s58 offen offset:1216
    ds_bpermute_b32 v129, v222, v129
    v_mfma_f32_16x16x32_bf16 a[112:115], v[204:207], v[100:103], a[112:115]
    v_mfma_f32_16x16x32_bf16 a[116:119], v[204:207], v[104:107], a[116:119]
    s_waitcnt lgkmcnt(12)
    ds_read_b64_tr_b16 v[184:185], v26 offset:12416
    ds_read_b64_tr_b16 v[186:187], v26 offset:13952
    v_mfma_f32_16x16x32_bf16 a[120:123], v[208:211], v[96:99], a[120:123]
    ds_bpermute_b32 v130, v222, v130
    v_mfma_f32_16x16x32_bf16 a[124:127], v[208:211], v[100:103], a[124:127]
    v_mfma_f32_16x16x32_bf16 a[128:131], v[208:211], v[104:107], a[128:131]
    buffer_load_dwordx4 v[88:91], v11, s[28:31], s58 offen offset:1216
    s_waitcnt lgkmcnt(12)
    ds_read_b64_tr_b16 v[188:189], v27 offset:12416
    ds_read_b64_tr_b16 v[190:191], v27 offset:13952
    v_mfma_f32_16x16x32_bf16 a[132:135], v[212:215], v[96:99], a[132:135]
    ds_bpermute_b32 v131, v222, v131
    v_mfma_f32_16x16x32_bf16 a[136:139], v[212:215], v[100:103], a[136:139]
    v_mfma_f32_16x16x32_bf16 a[140:143], v[212:215], v[104:107], a[140:143]
    s_waitcnt lgkmcnt(12)
    ds_read_b64_tr_b16 v[192:193], v28 offset:12416
    ds_read_b64_tr_b16 v[194:195], v28 offset:13952
    v_mfma_f32_16x16x32_bf16 a[0:3], v[168:171], v[108:111], a[0:3]
    s_waitcnt vmcnt(25)
    ds_bpermute_b32 v132, v222, v132
    v_mfma_f32_16x16x32_bf16 a[4:7], v[168:171], v[112:115], a[4:7]
    buffer_load_dwordx4 v[92:95], v12, s[28:31], s58 offen offset:1216
    v_mfma_f32_16x16x32_bf16 a[8:11], v[168:171], v[116:119], a[8:11]
    s_waitcnt lgkmcnt(12)
    ds_read_b64_tr_b16 v[196:197], v29 offset:12416
    ds_read_b64_tr_b16 v[198:199], v29 offset:13952
    v_mfma_f32_16x16x32_bf16 a[12:15], v[172:175], v[108:111], a[12:15]
    ds_bpermute_b32 v133, v222, v133
    v_mfma_f32_16x16x32_bf16 a[16:19], v[172:175], v[112:115], a[16:19]
    v_mfma_f32_16x16x32_bf16 a[20:23], v[172:175], v[116:119], a[20:23]
    s_waitcnt lgkmcnt(12)
    ds_read_b64_tr_b16 v[200:201], v26 offset:12544
    ds_read_b64_tr_b16 v[202:203], v26 offset:14080
    v_mfma_f32_16x16x32_bf16 a[24:27], v[176:179], v[108:111], a[24:27]
    ds_bpermute_b32 v134, v222, v134
    v_mfma_f32_16x16x32_bf16 a[28:31], v[176:179], v[112:115], a[28:31]
    v_mfma_f32_16x16x32_bf16 a[32:35], v[176:179], v[116:119], a[32:35]
    s_waitcnt lgkmcnt(12)
    ds_read_b64_tr_b16 v[204:205], v27 offset:12544
    ds_read_b64_tr_b16 v[206:207], v27 offset:14080
    v_mfma_f32_16x16x32_bf16 a[36:39], v[180:183], v[108:111], a[36:39]
    ds_bpermute_b32 v135, v222, v135
    v_mfma_f32_16x16x32_bf16 a[40:43], v[180:183], v[112:115], a[40:43]
    v_mfma_f32_16x16x32_bf16 a[44:47], v[180:183], v[116:119], a[44:47]
    s_waitcnt lgkmcnt(12)
    ds_read_b64_tr_b16 v[208:209], v28 offset:12544
    ds_read_b64_tr_b16 v[210:211], v28 offset:14080
    v_mfma_f32_16x16x32_bf16 a[48:51], v[184:187], v[108:111], a[48:51]
    s_waitcnt vmcnt(25)
    ds_bpermute_b32 v136, v222, v136
    v_mfma_f32_16x16x32_bf16 a[52:55], v[184:187], v[112:115], a[52:55]
    v_mfma_f32_16x16x32_bf16 a[56:59], v[184:187], v[116:119], a[56:59]
    s_waitcnt lgkmcnt(12)
    ds_read_b64_tr_b16 v[212:213], v29 offset:12544
    ds_read_b64_tr_b16 v[214:215], v29 offset:14080
    v_mfma_f32_16x16x32_bf16 a[60:63], v[188:191], v[108:111], a[60:63]
    ds_bpermute_b32 v137, v222, v137
    v_mfma_f32_16x16x32_bf16 a[64:67], v[188:191], v[112:115], a[64:67]
    v_mfma_f32_16x16x32_bf16 a[68:71], v[188:191], v[116:119], a[68:71]
    s_barrier
    v_add_u32 v26, s61, v20
    v_add_u32 v27, s61, v21
    v_add_u32 v28, s61, v22
    v_add_u32 v29, s61, v23
    s_waitcnt lgkmcnt(12)
    ds_read_b64_tr_b16 v[168:169], v26 offset:0
    ds_read_b64_tr_b16 v[170:171], v26 offset:1536
    v_mfma_f32_16x16x32_bf16 a[72:75], v[192:195], v[108:111], a[72:75]
    ds_bpermute_b32 v138, v222, v138
    v_mfma_f32_16x16x32_bf16 a[76:79], v[192:195], v[112:115], a[76:79]
    v_mfma_f32_16x16x32_bf16 a[80:83], v[192:195], v[116:119], a[80:83]
    s_waitcnt lgkmcnt(12)
    ds_read_b64_tr_b16 v[172:173], v27 offset:0
    ds_read_b64_tr_b16 v[174:175], v27 offset:1536
    v_mfma_f32_16x16x32_bf16 a[84:87], v[196:199], v[108:111], a[84:87]
    s_add_u32 m0, s65, s66
    s_add_u32 s67, s56, 24576
    buffer_load_dwordx4 v4, s[40:43], s67 offen offset:0 nt lds
    ds_bpermute_b32 v139, v222, v139
    v_mfma_f32_16x16x32_bf16 a[88:91], v[196:199], v[112:115], a[88:91]
    v_mfma_f32_16x16x32_bf16 a[92:95], v[196:199], v[116:119], a[92:95]
    s_waitcnt lgkmcnt(12)
    ds_read_b64_tr_b16 v[176:177], v28 offset:0
    ds_read_b64_tr_b16 v[178:179], v28 offset:1536
    v_mfma_f32_16x16x32_bf16 a[96:99], v[200:203], v[108:111], a[96:99]
    s_waitcnt vmcnt(25)
    ds_bpermute_b32 v140, v222, v140
    v_mfma_f32_16x16x32_bf16 a[100:103], v[200:203], v[112:115], a[100:103]
    v_mfma_f32_16x16x32_bf16 a[104:107], v[200:203], v[116:119], a[104:107]
    buffer_load_dwordx4 v5, s[40:43], s67 offen offset:1024 nt lds
    s_waitcnt lgkmcnt(12)
    ds_read_b64_tr_b16 v[180:181], v29 offset:0
    ds_read_b64_tr_b16 v[182:183], v29 offset:1536
    v_mfma_f32_16x16x32_bf16 a[108:111], v[204:207], v[108:111], a[108:111]
    ds_bpermute_b32 v141, v222, v141
    v_mfma_f32_16x16x32_bf16 a[112:115], v[204:207], v[112:115], a[112:115]
    v_mfma_f32_16x16x32_bf16 a[116:119], v[204:207], v[116:119], a[116:119]
    s_waitcnt lgkmcnt(12)
    ds_read_b64_tr_b16 v[184:185], v26 offset:128
    ds_read_b64_tr_b16 v[186:187], v26 offset:1664
    v_mfma_f32_16x16x32_bf16 a[120:123], v[208:211], v[108:111], a[120:123]
    ds_bpermute_b32 v142, v222, v142
    v_mfma_f32_16x16x32_bf16 a[124:127], v[208:211], v[112:115], a[124:127]
    buffer_load_dwordx4 v6, s[40:43], s67 offen offset:2048 nt lds
    v_mfma_f32_16x16x32_bf16 a[128:131], v[208:211], v[116:119], a[128:131]
    s_waitcnt lgkmcnt(12)
    ds_read_b64_tr_b16 v[188:189], v27 offset:128
    ds_read_b64_tr_b16 v[190:191], v27 offset:1664
    v_mfma_f32_16x16x32_bf16 a[132:135], v[212:215], v[108:111], a[132:135]
    ds_bpermute_b32 v143, v222, v143
    v_mfma_f32_16x16x32_bf16 a[136:139], v[212:215], v[112:115], a[136:139]
    v_mfma_f32_16x16x32_bf16 a[140:143], v[212:215], v[116:119], a[140:143]
    s_waitcnt lgkmcnt(12)
    ds_read_b64_tr_b16 v[192:193], v28 offset:128
    ds_read_b64_tr_b16 v[194:195], v28 offset:1664
    v_mfma_f32_16x16x32_bf16 a[0:3], v[168:171], v[120:123], a[0:3]
    s_add_u32 m0, m0, 3072
    s_add_u32 s67, s67, 3072
    buffer_load_dwordx4 v4, s[40:43], s67 offen offset:0 nt lds
    s_waitcnt vmcnt(21)
    ds_bpermute_b32 v48, v222, v48
    v_mfma_f32_16x16x32_bf16 a[4:7], v[168:171], v[124:127], a[4:7]
    v_mfma_f32_16x16x32_bf16 a[8:11], v[168:171], v[128:131], a[8:11]
    s_waitcnt lgkmcnt(12)
    ds_read_b64_tr_b16 v[196:197], v29 offset:128
    ds_read_b64_tr_b16 v[198:199], v29 offset:1664
    v_mfma_f32_16x16x32_bf16 a[12:15], v[172:175], v[120:123], a[12:15]
    ds_bpermute_b32 v49, v222, v49
    v_mfma_f32_16x16x32_bf16 a[16:19], v[172:175], v[124:127], a[16:19]
    v_mfma_f32_16x16x32_bf16 a[20:23], v[172:175], v[128:131], a[20:23]
    buffer_load_dwordx4 v5, s[40:43], s67 offen offset:1024 nt lds
    s_waitcnt lgkmcnt(12)
    ds_read_b64_tr_b16 v[200:201], v26 offset:256
    ds_read_b64_tr_b16 v[202:203], v26 offset:1792
    v_mfma_f32_16x16x32_bf16 a[24:27], v[176:179], v[120:123], a[24:27]
    ds_bpermute_b32 v50, v222, v50
    v_mfma_f32_16x16x32_bf16 a[28:31], v[176:179], v[124:127], a[28:31]
    v_mfma_f32_16x16x32_bf16 a[32:35], v[176:179], v[128:131], a[32:35]
    s_waitcnt lgkmcnt(12)
    ds_read_b64_tr_b16 v[204:205], v27 offset:256
    ds_read_b64_tr_b16 v[206:207], v27 offset:1792
    v_mfma_f32_16x16x32_bf16 a[36:39], v[180:183], v[120:123], a[36:39]
    ds_bpermute_b32 v51, v222, v51
    v_mfma_f32_16x16x32_bf16 a[40:43], v[180:183], v[124:127], a[40:43]
    buffer_load_dwordx4 v6, s[40:43], s67 offen offset:2048 nt lds
    v_mfma_f32_16x16x32_bf16 a[44:47], v[180:183], v[128:131], a[44:47]
    s_waitcnt lgkmcnt(12)
    ds_read_b64_tr_b16 v[208:209], v28 offset:256
    ds_read_b64_tr_b16 v[210:211], v28 offset:1792
    v_mfma_f32_16x16x32_bf16 a[48:51], v[184:187], v[120:123], a[48:51]
    s_waitcnt vmcnt(22)
    ds_bpermute_b32 v52, v222, v52
    v_mfma_f32_16x16x32_bf16 a[52:55], v[184:187], v[124:127], a[52:55]
    v_mfma_f32_16x16x32_bf16 a[56:59], v[184:187], v[128:131], a[56:59]
    s_waitcnt lgkmcnt(12)
    ds_read_b64_tr_b16 v[212:213], v29 offset:256
    ds_read_b64_tr_b16 v[214:215], v29 offset:1792
    v_mfma_f32_16x16x32_bf16 a[60:63], v[188:191], v[120:123], a[60:63]
    ds_bpermute_b32 v53, v222, v53
    v_mfma_f32_16x16x32_bf16 a[64:67], v[188:191], v[124:127], a[64:67]
    v_mfma_f32_16x16x32_bf16 a[68:71], v[188:191], v[128:131], a[68:71]
    s_waitcnt lgkmcnt(12)
    ds_read_b64_tr_b16 v[168:169], v26 offset:12288
    ds_read_b64_tr_b16 v[170:171], v26 offset:13824
    v_mfma_f32_16x16x32_bf16 a[72:75], v[192:195], v[120:123], a[72:75]
    ds_bpermute_b32 v54, v222, v54
    v_mfma_f32_16x16x32_bf16 a[76:79], v[192:195], v[124:127], a[76:79]
    v_mfma_f32_16x16x32_bf16 a[80:83], v[192:195], v[128:131], a[80:83]
    s_waitcnt lgkmcnt(12)
    ds_read_b64_tr_b16 v[172:173], v27 offset:12288
    ds_read_b64_tr_b16 v[174:175], v27 offset:13824
    v_mfma_f32_16x16x32_bf16 a[84:87], v[196:199], v[120:123], a[84:87]
    ds_bpermute_b32 v55, v222, v55
    v_mfma_f32_16x16x32_bf16 a[88:91], v[196:199], v[124:127], a[88:91]
    v_mfma_f32_16x16x32_bf16 a[92:95], v[196:199], v[128:131], a[92:95]
    s_waitcnt lgkmcnt(12)
    ds_read_b64_tr_b16 v[176:177], v28 offset:12288
    ds_read_b64_tr_b16 v[178:179], v28 offset:13824
    v_mfma_f32_16x16x32_bf16 a[96:99], v[200:203], v[120:123], a[96:99]
    s_waitcnt vmcnt(21)
    ds_bpermute_b32 v56, v222, v56
    v_mfma_f32_16x16x32_bf16 a[100:103], v[200:203], v[124:127], a[100:103]
    v_mfma_f32_16x16x32_bf16 a[104:107], v[200:203], v[128:131], a[104:107]
    s_waitcnt lgkmcnt(12)
    ds_read_b64_tr_b16 v[180:181], v29 offset:12288
    ds_read_b64_tr_b16 v[182:183], v29 offset:13824
    v_mfma_f32_16x16x32_bf16 a[108:111], v[204:207], v[120:123], a[108:111]
    ds_bpermute_b32 v57, v222, v57
    v_mfma_f32_16x16x32_bf16 a[112:115], v[204:207], v[124:127], a[112:115]
    v_mfma_f32_16x16x32_bf16 a[116:119], v[204:207], v[128:131], a[116:119]
    s_waitcnt lgkmcnt(12)
    ds_read_b64_tr_b16 v[184:185], v26 offset:12416
    ds_read_b64_tr_b16 v[186:187], v26 offset:13952
    v_mfma_f32_16x16x32_bf16 a[120:123], v[208:211], v[120:123], a[120:123]
    ds_bpermute_b32 v58, v222, v58
    v_mfma_f32_16x16x32_bf16 a[124:127], v[208:211], v[124:127], a[124:127]
    v_mfma_f32_16x16x32_bf16 a[128:131], v[208:211], v[128:131], a[128:131]
    s_waitcnt lgkmcnt(12)
    ds_read_b64_tr_b16 v[188:189], v27 offset:12416
    ds_read_b64_tr_b16 v[190:191], v27 offset:13952
    v_mfma_f32_16x16x32_bf16 a[132:135], v[212:215], v[120:123], a[132:135]
    ds_bpermute_b32 v59, v222, v59
    v_mfma_f32_16x16x32_bf16 a[136:139], v[212:215], v[124:127], a[136:139]
    v_mfma_f32_16x16x32_bf16 a[140:143], v[212:215], v[128:131], a[140:143]
    s_waitcnt lgkmcnt(12)
    ds_read_b64_tr_b16 v[192:193], v28 offset:12416
    ds_read_b64_tr_b16 v[194:195], v28 offset:13952
    v_mfma_f32_16x16x32_bf16 a[0:3], v[168:171], v[132:135], a[0:3]
    s_waitcnt vmcnt(20)
    ds_bpermute_b32 v60, v222, v60
    v_mfma_f32_16x16x32_bf16 a[4:7], v[168:171], v[136:139], a[4:7]
    v_mfma_f32_16x16x32_bf16 a[8:11], v[168:171], v[140:143], a[8:11]
    s_waitcnt lgkmcnt(12)
    ds_read_b64_tr_b16 v[196:197], v29 offset:12416
    ds_read_b64_tr_b16 v[198:199], v29 offset:13952
    v_mfma_f32_16x16x32_bf16 a[12:15], v[172:175], v[132:135], a[12:15]
    ds_bpermute_b32 v61, v222, v61
    v_mfma_f32_16x16x32_bf16 a[16:19], v[172:175], v[136:139], a[16:19]
    v_mfma_f32_16x16x32_bf16 a[20:23], v[172:175], v[140:143], a[20:23]
    s_waitcnt lgkmcnt(12)
    ds_read_b64_tr_b16 v[200:201], v26 offset:12544
    ds_read_b64_tr_b16 v[202:203], v26 offset:14080
    v_mfma_f32_16x16x32_bf16 a[24:27], v[176:179], v[132:135], a[24:27]
    ds_bpermute_b32 v62, v222, v62
    v_mfma_f32_16x16x32_bf16 a[28:31], v[176:179], v[136:139], a[28:31]
    v_mfma_f32_16x16x32_bf16 a[32:35], v[176:179], v[140:143], a[32:35]
    s_waitcnt lgkmcnt(12)
    ds_read_b64_tr_b16 v[204:205], v27 offset:12544
    ds_read_b64_tr_b16 v[206:207], v27 offset:14080
    v_mfma_f32_16x16x32_bf16 a[36:39], v[180:183], v[132:135], a[36:39]
    ds_bpermute_b32 v63, v222, v63
    v_mfma_f32_16x16x32_bf16 a[40:43], v[180:183], v[136:139], a[40:43]
    v_mfma_f32_16x16x32_bf16 a[44:47], v[180:183], v[140:143], a[44:47]
    s_waitcnt lgkmcnt(12)
    ds_read_b64_tr_b16 v[208:209], v28 offset:12544
    ds_read_b64_tr_b16 v[210:211], v28 offset:14080
    v_mfma_f32_16x16x32_bf16 a[48:51], v[184:187], v[132:135], a[48:51]
    s_waitcnt vmcnt(19)
    ds_bpermute_b32 v64, v222, v64
    v_mfma_f32_16x16x32_bf16 a[52:55], v[184:187], v[136:139], a[52:55]
    v_mfma_f32_16x16x32_bf16 a[56:59], v[184:187], v[140:143], a[56:59]
    s_waitcnt lgkmcnt(12)
    ds_read_b64_tr_b16 v[212:213], v29 offset:12544
    ds_read_b64_tr_b16 v[214:215], v29 offset:14080
    v_mfma_f32_16x16x32_bf16 a[60:63], v[188:191], v[132:135], a[60:63]
    ds_bpermute_b32 v65, v222, v65
    v_mfma_f32_16x16x32_bf16 a[64:67], v[188:191], v[136:139], a[64:67]
    v_mfma_f32_16x16x32_bf16 a[68:71], v[188:191], v[140:143], a[68:71]
    s_barrier
    v_add_u32 v26, s62, v20
    v_add_u32 v27, s62, v21
    v_add_u32 v28, s62, v22
    v_add_u32 v29, s62, v23
    s_waitcnt lgkmcnt(12)
    ds_read_b64_tr_b16 v[168:169], v26 offset:0
    ds_read_b64_tr_b16 v[170:171], v26 offset:1536
    v_mfma_f32_16x16x32_bf16 a[72:75], v[192:195], v[132:135], a[72:75]
    ds_bpermute_b32 v66, v222, v66
    v_mfma_f32_16x16x32_bf16 a[76:79], v[192:195], v[136:139], a[76:79]
    s_add_u32 m0, s60, s66
    s_add_u32 s67, s56, 0
    buffer_load_dwordx4 v4, s[44:47], s67 offen offset:0 nt lds
    v_mfma_f32_16x16x32_bf16 a[80:83], v[192:195], v[140:143], a[80:83]
    s_waitcnt lgkmcnt(12)
    ds_read_b64_tr_b16 v[172:173], v27 offset:0
    ds_read_b64_tr_b16 v[174:175], v27 offset:1536
    v_mfma_f32_16x16x32_bf16 a[84:87], v[196:199], v[132:135], a[84:87]
    ds_bpermute_b32 v67, v222, v67
    v_mfma_f32_16x16x32_bf16 a[88:91], v[196:199], v[136:139], a[88:91]
    v_mfma_f32_16x16x32_bf16 a[92:95], v[196:199], v[140:143], a[92:95]
    s_waitcnt lgkmcnt(12)
    ds_read_b64_tr_b16 v[176:177], v28 offset:0
    ds_read_b64_tr_b16 v[178:179], v28 offset:1536
    v_mfma_f32_16x16x32_bf16 a[96:99], v[200:203], v[132:135], a[96:99]
    buffer_load_dwordx4 v5, s[44:47], s67 offen offset:1024 nt lds
    s_waitcnt vmcnt(20)
    ds_bpermute_b32 v68, v222, v68
    v_mfma_f32_16x16x32_bf16 a[100:103], v[200:203], v[136:139], a[100:103]
    v_mfma_f32_16x16x32_bf16 a[104:107], v[200:203], v[140:143], a[104:107]
    s_waitcnt lgkmcnt(12)
    ds_read_b64_tr_b16 v[180:181], v29 offset:0
    ds_read_b64_tr_b16 v[182:183], v29 offset:1536
    v_mfma_f32_16x16x32_bf16 a[108:111], v[204:207], v[132:135], a[108:111]
    ds_bpermute_b32 v69, v222, v69
    v_mfma_f32_16x16x32_bf16 a[112:115], v[204:207], v[136:139], a[112:115]
    v_mfma_f32_16x16x32_bf16 a[116:119], v[204:207], v[140:143], a[116:119]
    buffer_load_dwordx4 v6, s[44:47], s67 offen offset:2048 nt lds
    s_waitcnt lgkmcnt(12)
    ds_read_b64_tr_b16 v[184:185], v26 offset:128
    ds_read_b64_tr_b16 v[186:187], v26 offset:1664
    v_mfma_f32_16x16x32_bf16 a[120:123], v[208:211], v[132:135], a[120:123]
    ds_bpermute_b32 v70, v222, v70
    v_mfma_f32_16x16x32_bf16 a[124:127], v[208:211], v[136:139], a[124:127]
    v_mfma_f32_16x16x32_bf16 a[128:131], v[208:211], v[140:143], a[128:131]
    s_waitcnt lgkmcnt(12)
    ds_read_b64_tr_b16 v[188:189], v27 offset:128
    ds_read_b64_tr_b16 v[190:191], v27 offset:1664
    v_mfma_f32_16x16x32_bf16 a[132:135], v[212:215], v[132:135], a[132:135]
    ds_bpermute_b32 v71, v222, v71
    v_mfma_f32_16x16x32_bf16 a[136:139], v[212:215], v[136:139], a[136:139]
    s_add_u32 m0, m0, 3072
    s_add_u32 s67, s67, 3072
    buffer_load_dwordx4 v4, s[44:47], s67 offen offset:0 nt lds
    v_mfma_f32_16x16x32_bf16 a[140:143], v[212:215], v[140:143], a[140:143]
    s_waitcnt lgkmcnt(12)
    ds_read_b64_tr_b16 v[192:193], v28 offset:128
    ds_read_b64_tr_b16 v[194:195], v28 offset:1664
    v_mfma_f32_16x16x32_bf16 a[0:3], v[168:171], v[48:51], a[0:3]
    s_waitcnt vmcnt(15)
    ds_bpermute_b32 v72, v222, v72
    v_mfma_f32_16x16x32_bf16 a[4:7], v[168:171], v[52:55], a[4:7]
    v_mfma_f32_16x16x32_bf16 a[8:11], v[168:171], v[56:59], a[8:11]
    s_waitcnt lgkmcnt(12)
    ds_read_b64_tr_b16 v[196:197], v29 offset:128
    ds_read_b64_tr_b16 v[198:199], v29 offset:1664
    v_mfma_f32_16x16x32_bf16 a[12:15], v[172:175], v[48:51], a[12:15]
    buffer_load_dwordx4 v5, s[44:47], s67 offen offset:1024 nt lds
    ds_bpermute_b32 v73, v222, v73
    v_mfma_f32_16x16x32_bf16 a[16:19], v[172:175], v[52:55], a[16:19]
    v_mfma_f32_16x16x32_bf16 a[20:23], v[172:175], v[56:59], a[20:23]
    s_waitcnt lgkmcnt(12)
    ds_read_b64_tr_b16 v[200:201], v26 offset:256
    ds_read_b64_tr_b16 v[202:203], v26 offset:1792
    v_mfma_f32_16x16x32_bf16 a[24:27], v[176:179], v[48:51], a[24:27]
    ds_bpermute_b32 v74, v222, v74
    v_mfma_f32_16x16x32_bf16 a[28:31], v[176:179], v[52:55], a[28:31]
    v_mfma_f32_16x16x32_bf16 a[32:35], v[176:179], v[56:59], a[32:35]
    buffer_load_dwordx4 v6, s[44:47], s67 offen offset:2048 nt lds
    s_waitcnt lgkmcnt(12)
    ds_read_b64_tr_b16 v[204:205], v27 offset:256
    ds_read_b64_tr_b16 v[206:207], v27 offset:1792
    v_mfma_f32_16x16x32_bf16 a[36:39], v[180:183], v[48:51], a[36:39]
    ds_bpermute_b32 v75, v222, v75
    v_mfma_f32_16x16x32_bf16 a[40:43], v[180:183], v[52:55], a[40:43]
    v_mfma_f32_16x16x32_bf16 a[44:47], v[180:183], v[56:59], a[44:47]
    s_waitcnt lgkmcnt(12)
    ds_read_b64_tr_b16 v[208:209], v28 offset:256
    ds_read_b64_tr_b16 v[210:211], v28 offset:1792
    v_mfma_f32_16x16x32_bf16 a[48:51], v[184:187], v[48:51], a[48:51]
    s_waitcnt vmcnt(16)
    ds_bpermute_b32 v76, v222, v76
    v_mfma_f32_16x16x32_bf16 a[52:55], v[184:187], v[52:55], a[52:55]
    v_mfma_f32_16x16x32_bf16 a[56:59], v[184:187], v[56:59], a[56:59]
    s_waitcnt lgkmcnt(12)
    ds_read_b64_tr_b16 v[212:213], v29 offset:256
    ds_read_b64_tr_b16 v[214:215], v29 offset:1792
    v_mfma_f32_16x16x32_bf16 a[60:63], v[188:191], v[48:51], a[60:63]
    ds_bpermute_b32 v77, v222, v77
    v_mfma_f32_16x16x32_bf16 a[64:67], v[188:191], v[52:55], a[64:67]
    v_mfma_f32_16x16x32_bf16 a[68:71], v[188:191], v[56:59], a[68:71]
    s_waitcnt lgkmcnt(12)
    ds_read_b64_tr_b16 v[168:169], v26 offset:12288
    ds_read_b64_tr_b16 v[170:171], v26 offset:13824
    v_mfma_f32_16x16x32_bf16 a[72:75], v[192:195], v[48:51], a[72:75]
    ds_bpermute_b32 v78, v222, v78
    v_mfma_f32_16x16x32_bf16 a[76:79], v[192:195], v[52:55], a[76:79]
    v_mfma_f32_16x16x32_bf16 a[80:83], v[192:195], v[56:59], a[80:83]
    s_waitcnt lgkmcnt(12)
    ds_read_b64_tr_b16 v[172:173], v27 offset:12288
    ds_read_b64_tr_b16 v[174:175], v27 offset:13824
    v_mfma_f32_16x16x32_bf16 a[84:87], v[196:199], v[48:51], a[84:87]
    ds_bpermute_b32 v79, v222, v79
    v_mfma_f32_16x16x32_bf16 a[88:91], v[196:199], v[52:55], a[88:91]
    v_mfma_f32_16x16x32_bf16 a[92:95], v[196:199], v[56:59], a[92:95]
    s_waitcnt lgkmcnt(12)
    ds_read_b64_tr_b16 v[176:177], v28 offset:12288
    ds_read_b64_tr_b16 v[178:179], v28 offset:13824
    v_mfma_f32_16x16x32_bf16 a[96:99], v[200:203], v[48:51], a[96:99]
    s_waitcnt vmcnt(15)
    ds_bpermute_b32 v80, v222, v80
    v_mfma_f32_16x16x32_bf16 a[100:103], v[200:203], v[52:55], a[100:103]
    v_mfma_f32_16x16x32_bf16 a[104:107], v[200:203], v[56:59], a[104:107]
    s_waitcnt lgkmcnt(12)
    ds_read_b64_tr_b16 v[180:181], v29 offset:12288
    ds_read_b64_tr_b16 v[182:183], v29 offset:13824
    v_mfma_f32_16x16x32_bf16 a[108:111], v[204:207], v[48:51], a[108:111]
    ds_bpermute_b32 v81, v222, v81
    v_mfma_f32_16x16x32_bf16 a[112:115], v[204:207], v[52:55], a[112:115]
    v_mfma_f32_16x16x32_bf16 a[116:119], v[204:207], v[56:59], a[116:119]
    s_waitcnt lgkmcnt(12)
    ds_read_b64_tr_b16 v[184:185], v26 offset:12416
    ds_read_b64_tr_b16 v[186:187], v26 offset:13952
    v_mfma_f32_16x16x32_bf16 a[120:123], v[208:211], v[48:51], a[120:123]
    ds_bpermute_b32 v82, v222, v82
    v_mfma_f32_16x16x32_bf16 a[124:127], v[208:211], v[52:55], a[124:127]
    v_mfma_f32_16x16x32_bf16 a[128:131], v[208:211], v[56:59], a[128:131]
    s_waitcnt lgkmcnt(12)
    ds_read_b64_tr_b16 v[188:189], v27 offset:12416
    ds_read_b64_tr_b16 v[190:191], v27 offset:13952
    v_mfma_f32_16x16x32_bf16 a[132:135], v[212:215], v[48:51], a[132:135]
    ds_bpermute_b32 v83, v222, v83
    v_mfma_f32_16x16x32_bf16 a[136:139], v[212:215], v[52:55], a[136:139]
    v_mfma_f32_16x16x32_bf16 a[140:143], v[212:215], v[56:59], a[140:143]
    s_waitcnt lgkmcnt(12)
    ds_read_b64_tr_b16 v[192:193], v28 offset:12416
    ds_read_b64_tr_b16 v[194:195], v28 offset:13952
    v_mfma_f32_16x16x32_bf16 a[0:3], v[168:171], v[60:63], a[0:3]
    s_waitcnt vmcnt(14)
    ds_bpermute_b32 v84, v222, v84
    v_mfma_f32_16x16x32_bf16 a[4:7], v[168:171], v[64:67], a[4:7]
    v_mfma_f32_16x16x32_bf16 a[8:11], v[168:171], v[68:71], a[8:11]
    s_waitcnt lgkmcnt(12)
    ds_read_b64_tr_b16 v[196:197], v29 offset:12416
    ds_read_b64_tr_b16 v[198:199], v29 offset:13952
    v_mfma_f32_16x16x32_bf16 a[12:15], v[172:175], v[60:63], a[12:15]
    ds_bpermute_b32 v85, v222, v85
    v_mfma_f32_16x16x32_bf16 a[16:19], v[172:175], v[64:67], a[16:19]
    v_mfma_f32_16x16x32_bf16 a[20:23], v[172:175], v[68:71], a[20:23]
    s_waitcnt lgkmcnt(12)
    ds_read_b64_tr_b16 v[200:201], v26 offset:12544
    ds_read_b64_tr_b16 v[202:203], v26 offset:14080
    v_mfma_f32_16x16x32_bf16 a[24:27], v[176:179], v[60:63], a[24:27]
    ds_bpermute_b32 v86, v222, v86
    v_mfma_f32_16x16x32_bf16 a[28:31], v[176:179], v[64:67], a[28:31]
    v_mfma_f32_16x16x32_bf16 a[32:35], v[176:179], v[68:71], a[32:35]
    s_waitcnt lgkmcnt(12)
    ds_read_b64_tr_b16 v[204:205], v27 offset:12544
    ds_read_b64_tr_b16 v[206:207], v27 offset:14080
    v_mfma_f32_16x16x32_bf16 a[36:39], v[180:183], v[60:63], a[36:39]
    ds_bpermute_b32 v87, v222, v87
    v_mfma_f32_16x16x32_bf16 a[40:43], v[180:183], v[64:67], a[40:43]
    v_mfma_f32_16x16x32_bf16 a[44:47], v[180:183], v[68:71], a[44:47]
    s_waitcnt lgkmcnt(12)
    ds_read_b64_tr_b16 v[208:209], v28 offset:12544
    ds_read_b64_tr_b16 v[210:211], v28 offset:14080
    v_mfma_f32_16x16x32_bf16 a[48:51], v[184:187], v[60:63], a[48:51]
    s_waitcnt vmcnt(13)
    ds_bpermute_b32 v88, v222, v88
    v_mfma_f32_16x16x32_bf16 a[52:55], v[184:187], v[64:67], a[52:55]
    v_mfma_f32_16x16x32_bf16 a[56:59], v[184:187], v[68:71], a[56:59]
    s_waitcnt lgkmcnt(12)
    ds_read_b64_tr_b16 v[212:213], v29 offset:12544
    ds_read_b64_tr_b16 v[214:215], v29 offset:14080
    v_mfma_f32_16x16x32_bf16 a[60:63], v[188:191], v[60:63], a[60:63]
    ds_bpermute_b32 v89, v222, v89
    v_mfma_f32_16x16x32_bf16 a[64:67], v[188:191], v[64:67], a[64:67]
    v_mfma_f32_16x16x32_bf16 a[68:71], v[188:191], v[68:71], a[68:71]
    s_barrier
    v_add_u32 v26, s63, v20
    v_add_u32 v27, s63, v21
    v_add_u32 v28, s63, v22
    v_add_u32 v29, s63, v23
    s_waitcnt lgkmcnt(12)
    ds_read_b64_tr_b16 v[168:169], v26 offset:0
    ds_read_b64_tr_b16 v[170:171], v26 offset:1536
    v_mfma_f32_16x16x32_bf16 a[72:75], v[192:195], v[60:63], a[72:75]
    ds_bpermute_b32 v90, v222, v90
    v_mfma_f32_16x16x32_bf16 a[76:79], v[192:195], v[64:67], a[76:79]
    v_mfma_f32_16x16x32_bf16 a[80:83], v[192:195], v[68:71], a[80:83]
    s_waitcnt lgkmcnt(12)
    ds_read_b64_tr_b16 v[172:173], v27 offset:0
    ds_read_b64_tr_b16 v[174:175], v27 offset:1536
    v_mfma_f32_16x16x32_bf16 a[84:87], v[196:199], v[60:63], a[84:87]
    ds_bpermute_b32 v91, v222, v91
    v_mfma_f32_16x16x32_bf16 a[88:91], v[196:199], v[64:67], a[88:91]
    s_add_u32 m0, s61, s66
    s_add_u32 s67, s56, 49152
    buffer_load_dwordx4 v4, s[40:43], s67 offen offset:0 nt lds
    v_mfma_f32_16x16x32_bf16 a[92:95], v[196:199], v[68:71], a[92:95]
    s_waitcnt lgkmcnt(12)
    ds_read_b64_tr_b16 v[176:177], v28 offset:0
    ds_read_b64_tr_b16 v[178:179], v28 offset:1536
    v_mfma_f32_16x16x32_bf16 a[96:99], v[200:203], v[60:63], a[96:99]
    s_waitcnt vmcnt(13)
    ds_bpermute_b32 v92, v222, v92
    v_mfma_f32_16x16x32_bf16 a[100:103], v[200:203], v[64:67], a[100:103]
    v_mfma_f32_16x16x32_bf16 a[104:107], v[200:203], v[68:71], a[104:107]
    s_waitcnt lgkmcnt(12)
    ds_read_b64_tr_b16 v[180:181], v29 offset:0
    ds_read_b64_tr_b16 v[182:183], v29 offset:1536
    v_mfma_f32_16x16x32_bf16 a[108:111], v[204:207], v[60:63], a[108:111]
    buffer_load_dwordx4 v5, s[40:43], s67 offen offset:1024 nt lds
    ds_bpermute_b32 v93, v222, v93
    v_mfma_f32_16x16x32_bf16 a[112:115], v[204:207], v[64:67], a[112:115]
    v_mfma_f32_16x16x32_bf16 a[116:119], v[204:207], v[68:71], a[116:119]
    s_waitcnt lgkmcnt(12)
    ds_read_b64_tr_b16 v[184:185], v26 offset:128
    ds_read_b64_tr_b16 v[186:187], v26 offset:1664
    v_mfma_f32_16x16x32_bf16 a[120:123], v[208:211], v[60:63], a[120:123]
    ds_bpermute_b32 v94, v222, v94
    v_mfma_f32_16x16x32_bf16 a[124:127], v[208:211], v[64:67], a[124:127]
    v_mfma_f32_16x16x32_bf16 a[128:131], v[208:211], v[68:71], a[128:131]
    buffer_load_dwordx4 v6, s[40:43], s67 offen offset:2048 nt lds
    s_waitcnt lgkmcnt(12)
    ds_read_b64_tr_b16 v[188:189], v27 offset:128
    ds_read_b64_tr_b16 v[190:191], v27 offset:1664
    v_mfma_f32_16x16x32_bf16 a[132:135], v[212:215], v[60:63], a[132:135]
    ds_bpermute_b32 v95, v222, v95
    v_mfma_f32_16x16x32_bf16 a[136:139], v[212:215], v[64:67], a[136:139]
    v_mfma_f32_16x16x32_bf16 a[140:143], v[212:215], v[68:71], a[140:143]
    s_waitcnt lgkmcnt(12)
    ds_read_b64_tr_b16 v[192:193], v28 offset:128
    ds_read_b64_tr_b16 v[194:195], v28 offset:1664
    v_mfma_f32_16x16x32_bf16 a[0:3], v[168:171], v[72:75], a[0:3]
    v_mfma_f32_16x16x32_bf16 a[4:7], v[168:171], v[76:79], a[4:7]
    s_add_u32 m0, m0, 3072
    s_add_u32 s67, s67, 3072
    buffer_load_dwordx4 v4, s[40:43], s67 offen offset:0 nt lds
    v_mfma_f32_16x16x32_bf16 a[8:11], v[168:171], v[80:83], a[8:11]
    ds_read_b64_tr_b16 v[196:197], v29 offset:128
    s_waitcnt lgkmcnt(12)
    ds_read_b64_tr_b16 v[198:199], v29 offset:1664
    v_mfma_f32_16x16x32_bf16 a[12:15], v[172:175], v[72:75], a[12:15]
    v_mfma_f32_16x16x32_bf16 a[16:19], v[172:175], v[76:79], a[16:19]
    v_mfma_f32_16x16x32_bf16 a[20:23], v[172:175], v[80:83], a[20:23]
    ds_read_b64_tr_b16 v[200:201], v26 offset:256
    ds_read_b64_tr_b16 v[202:203], v26 offset:1792
    s_waitcnt lgkmcnt(13)
    v_mfma_f32_16x16x32_bf16 a[24:27], v[176:179], v[72:75], a[24:27]
    buffer_load_dwordx4 v5, s[40:43], s67 offen offset:1024 nt lds
    v_mfma_f32_16x16x32_bf16 a[28:31], v[176:179], v[76:79], a[28:31]
    v_mfma_f32_16x16x32_bf16 a[32:35], v[176:179], v[80:83], a[32:35]
    ds_read_b64_tr_b16 v[204:205], v27 offset:256
    ds_read_b64_tr_b16 v[206:207], v27 offset:1792
    v_mfma_f32_16x16x32_bf16 a[36:39], v[180:183], v[72:75], a[36:39]
    v_mfma_f32_16x16x32_bf16 a[40:43], v[180:183], v[76:79], a[40:43]
    v_mfma_f32_16x16x32_bf16 a[44:47], v[180:183], v[80:83], a[44:47]
    buffer_load_dwordx4 v6, s[40:43], s67 offen offset:2048 nt lds
    s_waitcnt lgkmcnt(12)
    ds_read_b64_tr_b16 v[208:209], v28 offset:256
    ds_read_b64_tr_b16 v[210:211], v28 offset:1792
    s_waitcnt lgkmcnt(11)
    v_mfma_f32_16x16x32_bf16 a[48:51], v[184:187], v[72:75], a[48:51]
    v_mfma_f32_16x16x32_bf16 a[52:55], v[184:187], v[76:79], a[52:55]
    v_mfma_f32_16x16x32_bf16 a[56:59], v[184:187], v[80:83], a[56:59]
    ds_read_b64_tr_b16 v[212:213], v29 offset:256
    ds_read_b64_tr_b16 v[214:215], v29 offset:1792
    v_mfma_f32_16x16x32_bf16 a[60:63], v[188:191], v[72:75], a[60:63]
    v_mfma_f32_16x16x32_bf16 a[64:67], v[188:191], v[76:79], a[64:67]
    v_mfma_f32_16x16x32_bf16 a[68:71], v[188:191], v[80:83], a[68:71]
    ds_read_b64_tr_b16 v[168:169], v26 offset:12288
    ds_read_b64_tr_b16 v[170:171], v26 offset:13824
    s_waitcnt lgkmcnt(10)
    v_mfma_f32_16x16x32_bf16 a[72:75], v[192:195], v[72:75], a[72:75]
    v_mfma_f32_16x16x32_bf16 a[76:79], v[192:195], v[76:79], a[76:79]
    v_mfma_f32_16x16x32_bf16 a[80:83], v[192:195], v[80:83], a[80:83]
    ds_read_b64_tr_b16 v[172:173], v27 offset:12288
    ds_read_b64_tr_b16 v[174:175], v27 offset:13824
    v_mfma_f32_16x16x32_bf16 a[84:87], v[196:199], v[72:75], a[84:87]
    v_mfma_f32_16x16x32_bf16 a[88:91], v[196:199], v[76:79], a[88:91]
    v_mfma_f32_16x16x32_bf16 a[92:95], v[196:199], v[80:83], a[92:95]
    ds_read_b64_tr_b16 v[176:177], v28 offset:12288
    ds_read_b64_tr_b16 v[178:179], v28 offset:13824
    s_waitcnt lgkmcnt(10)
    v_mfma_f32_16x16x32_bf16 a[96:99], v[200:203], v[72:75], a[96:99]
    v_mfma_f32_16x16x32_bf16 a[100:103], v[200:203], v[76:79], a[100:103]
    v_mfma_f32_16x16x32_bf16 a[104:107], v[200:203], v[80:83], a[104:107]
    ds_read_b64_tr_b16 v[180:181], v29 offset:12288
    ds_read_b64_tr_b16 v[182:183], v29 offset:13824
    v_mfma_f32_16x16x32_bf16 a[108:111], v[204:207], v[72:75], a[108:111]
    v_mfma_f32_16x16x32_bf16 a[112:115], v[204:207], v[76:79], a[112:115]
    v_mfma_f32_16x16x32_bf16 a[116:119], v[204:207], v[80:83], a[116:119]
    ds_read_b64_tr_b16 v[184:185], v26 offset:12416
    ds_read_b64_tr_b16 v[186:187], v26 offset:13952
    s_waitcnt lgkmcnt(10)
    v_mfma_f32_16x16x32_bf16 a[120:123], v[208:211], v[72:75], a[120:123]
    v_mfma_f32_16x16x32_bf16 a[124:127], v[208:211], v[76:79], a[124:127]
    v_mfma_f32_16x16x32_bf16 a[128:131], v[208:211], v[80:83], a[128:131]
    ds_read_b64_tr_b16 v[188:189], v27 offset:12416
    ds_read_b64_tr_b16 v[190:191], v27 offset:13952
    v_mfma_f32_16x16x32_bf16 a[132:135], v[212:215], v[72:75], a[132:135]
    v_mfma_f32_16x16x32_bf16 a[136:139], v[212:215], v[76:79], a[136:139]
    v_mfma_f32_16x16x32_bf16 a[140:143], v[212:215], v[80:83], a[140:143]
    ds_read_b64_tr_b16 v[192:193], v28 offset:12416
    ds_read_b64_tr_b16 v[194:195], v28 offset:13952
    s_waitcnt lgkmcnt(10)
    v_mfma_f32_16x16x32_bf16 a[0:3], v[168:171], v[84:87], a[0:3]
    v_mfma_f32_16x16x32_bf16 a[4:7], v[168:171], v[88:91], a[4:7]
    v_mfma_f32_16x16x32_bf16 a[8:11], v[168:171], v[92:95], a[8:11]
    ds_read_b64_tr_b16 v[196:197], v29 offset:12416
    ds_read_b64_tr_b16 v[198:199], v29 offset:13952
    v_mfma_f32_16x16x32_bf16 a[12:15], v[172:175], v[84:87], a[12:15]
    v_mfma_f32_16x16x32_bf16 a[16:19], v[172:175], v[88:91], a[16:19]
    v_mfma_f32_16x16x32_bf16 a[20:23], v[172:175], v[92:95], a[20:23]
    ds_read_b64_tr_b16 v[200:201], v26 offset:12544
    ds_read_b64_tr_b16 v[202:203], v26 offset:14080
    s_waitcnt lgkmcnt(10)
    v_mfma_f32_16x16x32_bf16 a[24:27], v[176:179], v[84:87], a[24:27]
    v_mfma_f32_16x16x32_bf16 a[28:31], v[176:179], v[88:91], a[28:31]
    v_mfma_f32_16x16x32_bf16 a[32:35], v[176:179], v[92:95], a[32:35]
    ds_read_b64_tr_b16 v[204:205], v27 offset:12544
    ds_read_b64_tr_b16 v[206:207], v27 offset:14080
    v_mfma_f32_16x16x32_bf16 a[36:39], v[180:183], v[84:87], a[36:39]
    v_mfma_f32_16x16x32_bf16 a[40:43], v[180:183], v[88:91], a[40:43]
    v_mfma_f32_16x16x32_bf16 a[44:47], v[180:183], v[92:95], a[44:47]
    ds_read_b64_tr_b16 v[208:209], v28 offset:12544
    ds_read_b64_tr_b16 v[210:211], v28 offset:14080
    s_waitcnt lgkmcnt(10)
    v_mfma_f32_16x16x32_bf16 a[48:51], v[184:187], v[84:87], a[48:51]
    v_mfma_f32_16x16x32_bf16 a[52:55], v[184:187], v[88:91], a[52:55]
    v_mfma_f32_16x16x32_bf16 a[56:59], v[184:187], v[92:95], a[56:59]
    ds_read_b64_tr_b16 v[212:213], v29 offset:12544
    ds_read_b64_tr_b16 v[214:215], v29 offset:14080
    v_mfma_f32_16x16x32_bf16 a[60:63], v[188:191], v[84:87], a[60:63]
    v_mfma_f32_16x16x32_bf16 a[64:67], v[188:191], v[88:91], a[64:67]
    v_mfma_f32_16x16x32_bf16 a[68:71], v[188:191], v[92:95], a[68:71]
    s_barrier
    v_add_u32 v24, s64, v14
    v_add_u32 v25, s64, v15
    ds_read_b128 v[168:171], v24 offset:0
    s_waitcnt lgkmcnt(9)
    v_mfma_f32_16x16x32_bf16 a[72:75], v[192:195], v[84:87], a[72:75]
    v_mfma_f32_16x16x32_bf16 a[76:79], v[192:195], v[88:91], a[76:79]
    v_mfma_f32_16x16x32_bf16 a[80:83], v[192:195], v[92:95], a[80:83]
    s_add_u32 m0, s62, s66
    s_add_u32 s67, s56, 24576
    buffer_load_dwordx4 v4, s[44:47], s67 offen offset:0 nt lds
    ds_read_b128 v[172:175], v25 offset:0
    v_mfma_f32_16x16x32_bf16 a[84:87], v[196:199], v[84:87], a[84:87]
    v_mfma_f32_16x16x32_bf16 a[88:91], v[196:199], v[88:91], a[88:91]
    v_mfma_f32_16x16x32_bf16 a[92:95], v[196:199], v[92:95], a[92:95]
    ds_read_b128 v[176:179], v24 offset:128
    s_waitcnt lgkmcnt(7)
    v_mfma_f32_16x16x32_bf16 a[96:99], v[200:203], v[84:87], a[96:99]
    v_mfma_f32_16x16x32_bf16 a[100:103], v[200:203], v[88:91], a[100:103]
    buffer_load_dwordx4 v5, s[44:47], s67 offen offset:1024 nt lds
    v_mfma_f32_16x16x32_bf16 a[104:107], v[200:203], v[92:95], a[104:107]
    ds_read_b128 v[180:183], v25 offset:128
    v_mfma_f32_16x16x32_bf16 a[108:111], v[204:207], v[84:87], a[108:111]
    v_mfma_f32_16x16x32_bf16 a[112:115], v[204:207], v[88:91], a[112:115]
    v_mfma_f32_16x16x32_bf16 a[116:119], v[204:207], v[92:95], a[116:119]
    ds_read_b128 v[184:187], v24 offset:256
    s_waitcnt lgkmcnt(5)
    v_mfma_f32_16x16x32_bf16 a[120:123], v[208:211], v[84:87], a[120:123]
    buffer_load_dwordx4 v6, s[44:47], s67 offen offset:2048 nt lds
    v_mfma_f32_16x16x32_bf16 a[124:127], v[208:211], v[88:91], a[124:127]
    v_mfma_f32_16x16x32_bf16 a[128:131], v[208:211], v[92:95], a[128:131]
    ds_read_b128 v[188:191], v25 offset:256
    v_mfma_f32_16x16x32_bf16 a[132:135], v[212:215], v[84:87], a[132:135]
    v_mfma_f32_16x16x32_bf16 a[136:139], v[212:215], v[88:91], a[136:139]
    v_mfma_f32_16x16x32_bf16 a[140:143], v[212:215], v[92:95], a[140:143]
    s_add_u32 m0, m0, 3072
    s_add_u32 s67, s67, 3072
    buffer_load_dwordx4 v4, s[44:47], s67 offen offset:0 nt lds
    v_accvgpr_read_b32 v96, a0
    v_accvgpr_read_b32 v97, a1
    v_accvgpr_read_b32 v98, a2
    v_accvgpr_read_b32 v99, a3
    v_accvgpr_read_b32 v100, a12
    v_accvgpr_read_b32 v101, a13
    v_accvgpr_read_b32 v102, a14
    v_accvgpr_read_b32 v103, a15
    v_cvt_pk_bf16_f32 v104, v96, v97
    v_cvt_pk_bf16_f32 v105, v98, v99
    v_cvt_pk_bf16_f32 v106, v100, v101
    v_cvt_pk_bf16_f32 v107, v102, v103
    s_nop 0
    v_permlane32_swap_b32 v104, v106
    v_permlane32_swap_b32 v105, v107
    s_nop 0
    v_permlane16_swap_b32 v104, v106
    v_permlane16_swap_b32 v105, v107
    v_accvgpr_write_b32 a144, v104
    v_accvgpr_write_b32 a145, v105
    v_accvgpr_write_b32 a146, v106
    v_accvgpr_write_b32 a147, v107
    v_accvgpr_read_b32 v108, a4
    v_accvgpr_read_b32 v109, a5
    v_accvgpr_read_b32 v110, a6
    v_accvgpr_read_b32 v111, a7
    v_accvgpr_read_b32 v112, a16
    v_accvgpr_read_b32 v113, a17
    v_accvgpr_read_b32 v114, a18
    v_accvgpr_read_b32 v115, a19
    v_cvt_pk_bf16_f32 v116, v108, v109
    v_cvt_pk_bf16_f32 v117, v110, v111
    v_cvt_pk_bf16_f32 v118, v112, v113
    v_cvt_pk_bf16_f32 v119, v114, v115
    s_nop 0
    v_permlane32_swap_b32 v116, v118
    v_permlane32_swap_b32 v117, v119
    s_nop 0
    v_permlane16_swap_b32 v116, v118
    v_permlane16_swap_b32 v117, v119
    v_accvgpr_write_b32 a148, v116
    v_accvgpr_write_b32 a149, v117
    v_accvgpr_write_b32 a150, v118
    v_accvgpr_write_b32 a151, v119
    v_accvgpr_read_b32 v120, a8
    v_accvgpr_read_b32 v121, a9
    v_accvgpr_read_b32 v122, a10
    v_accvgpr_read_b32 v123, a11
    v_accvgpr_read_b32 v124, a20
    v_accvgpr_read_b32 v125, a21
    v_accvgpr_read_b32 v126, a22
    v_accvgpr_read_b32 v127, a23
    v_cvt_pk_bf16_f32 v128, v120, v121
    v_cvt_pk_bf16_f32 v129, v122, v123
    v_cvt_pk_bf16_f32 v130, v124, v125
    v_cvt_pk_bf16_f32 v131, v126, v127
    s_nop 0
    v_permlane32_swap_b32 v128, v130
    v_permlane32_swap_b32 v129, v131
    s_nop 0
    v_permlane16_swap_b32 v128, v130
    v_permlane16_swap_b32 v129, v131
    v_accvgpr_write_b32 a152, v128
    v_accvgpr_write_b32 a153, v129
    v_accvgpr_write_b32 a154, v130
    v_accvgpr_write_b32 a155, v131
    v_accvgpr_read_b32 v132, a24
    v_accvgpr_read_b32 v133, a25
    v_accvgpr_read_b32 v134, a26
    v_accvgpr_read_b32 v135, a27
    v_accvgpr_read_b32 v136, a36
    v_accvgpr_read_b32 v137, a37
    v_accvgpr_read_b32 v138, a38
    v_accvgpr_read_b32 v139, a39
    v_cvt_pk_bf16_f32 v140, v132, v133
    v_cvt_pk_bf16_f32 v141, v134, v135
    v_cvt_pk_bf16_f32 v142, v136, v137
    v_cvt_pk_bf16_f32 v143, v138, v139
    s_nop 0
    v_permlane32_swap_b32 v140, v142
    v_permlane32_swap_b32 v141, v143
    s_nop 0
    v_permlane16_swap_b32 v140, v142
    v_permlane16_swap_b32 v141, v143
    v_accvgpr_write_b32 a156, v140
    v_accvgpr_write_b32 a157, v141
    v_accvgpr_write_b32 a158, v142
    v_accvgpr_write_b32 a159, v143
    v_accvgpr_read_b32 v96, a28
    v_accvgpr_read_b32 v97, a29
    v_accvgpr_read_b32 v98, a30
    v_accvgpr_read_b32 v99, a31
    v_accvgpr_read_b32 v100, a40
    v_accvgpr_read_b32 v101, a41
    v_accvgpr_read_b32 v102, a42
    v_accvgpr_read_b32 v103, a43
    v_cvt_pk_bf16_f32 v104, v96, v97
    v_cvt_pk_bf16_f32 v105, v98, v99
    v_cvt_pk_bf16_f32 v106, v100, v101
    v_cvt_pk_bf16_f32 v107, v102, v103
    s_nop 0
    v_permlane32_swap_b32 v104, v106
    v_permlane32_swap_b32 v105, v107
    s_nop 0
    v_permlane16_swap_b32 v104, v106
    v_permlane16_swap_b32 v105, v107
    v_accvgpr_write_b32 a160, v104
    v_accvgpr_write_b32 a161, v105
    v_accvgpr_write_b32 a162, v106
    v_accvgpr_write_b32 a163, v107
    v_accvgpr_read_b32 v108, a32
    v_accvgpr_read_b32 v109, a33
    v_accvgpr_read_b32 v110, a34
    v_accvgpr_read_b32 v111, a35
    v_accvgpr_read_b32 v112, a44
    v_accvgpr_read_b32 v113, a45
    v_accvgpr_read_b32 v114, a46
    v_accvgpr_read_b32 v115, a47
    v_cvt_pk_bf16_f32 v116, v108, v109
    v_cvt_pk_bf16_f32 v117, v110, v111
    v_cvt_pk_bf16_f32 v118, v112, v113
    v_cvt_pk_bf16_f32 v119, v114, v115
    s_nop 0
    v_permlane32_swap_b32 v116, v118
    v_permlane32_swap_b32 v117, v119
    s_nop 0
    v_permlane16_swap_b32 v116, v118
    v_permlane16_swap_b32 v117, v119
    v_accvgpr_write_b32 a164, v116
    v_accvgpr_write_b32 a165, v117
    v_accvgpr_write_b32 a166, v118
    v_accvgpr_write_b32 a167, v119
    v_accvgpr_read_b32 v120, a48
    v_accvgpr_read_b32 v121, a49
    v_accvgpr_read_b32 v122, a50
    v_accvgpr_read_b32 v123, a51
    v_accvgpr_read_b32 v124, a60
    v_accvgpr_read_b32 v125, a61
    v_accvgpr_read_b32 v126, a62
    v_accvgpr_read_b32 v127, a63
    v_cvt_pk_bf16_f32 v128, v120, v121
    v_cvt_pk_bf16_f32 v129, v122, v123
    v_cvt_pk_bf16_f32 v130, v124, v125
    v_cvt_pk_bf16_f32 v131, v126, v127
    s_nop 0
    v_permlane32_swap_b32 v128, v130
    v_permlane32_swap_b32 v129, v131
    s_nop 0
    v_permlane16_swap_b32 v128, v130
    v_permlane16_swap_b32 v129, v131
    v_accvgpr_write_b32 a168, v128
    v_accvgpr_write_b32 a169, v129
    v_accvgpr_write_b32 a170, v130
    v_accvgpr_write_b32 a171, v131
    v_accvgpr_read_b32 v132, a52
    v_accvgpr_read_b32 v133, a53
    v_accvgpr_read_b32 v134, a54
    v_accvgpr_read_b32 v135, a55
    v_accvgpr_read_b32 v136, a64
    v_accvgpr_read_b32 v137, a65
    v_accvgpr_read_b32 v138, a66
    v_accvgpr_read_b32 v139, a67
    v_cvt_pk_bf16_f32 v140, v132, v133
    v_cvt_pk_bf16_f32 v141, v134, v135
    v_cvt_pk_bf16_f32 v142, v136, v137
    v_cvt_pk_bf16_f32 v143, v138, v139
    s_nop 0
    v_permlane32_swap_b32 v140, v142
    v_permlane32_swap_b32 v141, v143
    s_nop 0
    v_permlane16_swap_b32 v140, v142
    v_permlane16_swap_b32 v141, v143
    v_accvgpr_write_b32 a172, v140
    v_accvgpr_write_b32 a173, v141
    v_accvgpr_write_b32 a174, v142
    v_accvgpr_write_b32 a175, v143
    v_accvgpr_read_b32 v96, a56
    v_accvgpr_read_b32 v97, a57
    v_accvgpr_read_b32 v98, a58
    v_accvgpr_read_b32 v99, a59
    v_accvgpr_read_b32 v100, a68
    v_accvgpr_read_b32 v101, a69
    v_accvgpr_read_b32 v102, a70
    v_accvgpr_read_b32 v103, a71
    v_cvt_pk_bf16_f32 v104, v96, v97
    v_cvt_pk_bf16_f32 v105, v98, v99
    v_cvt_pk_bf16_f32 v106, v100, v101
    v_cvt_pk_bf16_f32 v107, v102, v103
    s_nop 0
    v_permlane32_swap_b32 v104, v106
    v_permlane32_swap_b32 v105, v107
    s_nop 0
    v_permlane16_swap_b32 v104, v106
    v_permlane16_swap_b32 v105, v107
    v_accvgpr_write_b32 a176, v104
    v_accvgpr_write_b32 a177, v105
    v_accvgpr_write_b32 a178, v106
    v_accvgpr_write_b32 a179, v107
    v_accvgpr_read_b32 v108, a72
    v_accvgpr_read_b32 v109, a73
    v_accvgpr_read_b32 v110, a74
    v_accvgpr_read_b32 v111, a75
    v_accvgpr_read_b32 v112, a84
    v_accvgpr_read_b32 v113, a85
    v_accvgpr_read_b32 v114, a86
    v_accvgpr_read_b32 v115, a87
    v_cvt_pk_bf16_f32 v116, v108, v109
    v_cvt_pk_bf16_f32 v117, v110, v111
    v_cvt_pk_bf16_f32 v118, v112, v113
    v_cvt_pk_bf16_f32 v119, v114, v115
    s_nop 0
    v_permlane32_swap_b32 v116, v118
    v_permlane32_swap_b32 v117, v119
    s_nop 0
    v_permlane16_swap_b32 v116, v118
    v_permlane16_swap_b32 v117, v119
    v_accvgpr_write_b32 a180, v116
    v_accvgpr_write_b32 a181, v117
    v_accvgpr_write_b32 a182, v118
    v_accvgpr_write_b32 a183, v119
    v_accvgpr_read_b32 v120, a76
    v_accvgpr_read_b32 v121, a77
    v_accvgpr_read_b32 v122, a78
    v_accvgpr_read_b32 v123, a79
    v_accvgpr_read_b32 v124, a88
    v_accvgpr_read_b32 v125, a89
    v_accvgpr_read_b32 v126, a90
    v_accvgpr_read_b32 v127, a91
    v_cvt_pk_bf16_f32 v128, v120, v121
    v_cvt_pk_bf16_f32 v129, v122, v123
    v_cvt_pk_bf16_f32 v130, v124, v125
    v_cvt_pk_bf16_f32 v131, v126, v127
    s_nop 0
    v_permlane32_swap_b32 v128, v130
    v_permlane32_swap_b32 v129, v131
    s_nop 0
    v_permlane16_swap_b32 v128, v130
    v_permlane16_swap_b32 v129, v131
    v_accvgpr_write_b32 a184, v128
    v_accvgpr_write_b32 a185, v129
    v_accvgpr_write_b32 a186, v130
    v_accvgpr_write_b32 a187, v131
    v_accvgpr_read_b32 v132, a80
    v_accvgpr_read_b32 v133, a81
    v_accvgpr_read_b32 v134, a82
    v_accvgpr_read_b32 v135, a83
    v_accvgpr_read_b32 v136, a92
    v_accvgpr_read_b32 v137, a93
    v_accvgpr_read_b32 v138, a94
    v_accvgpr_read_b32 v139, a95
    v_cvt_pk_bf16_f32 v140, v132, v133
    v_cvt_pk_bf16_f32 v141, v134, v135
    v_cvt_pk_bf16_f32 v142, v136, v137
    v_cvt_pk_bf16_f32 v143, v138, v139
    s_nop 0
    v_permlane32_swap_b32 v140, v142
    v_permlane32_swap_b32 v141, v143
    s_nop 0
    v_permlane16_swap_b32 v140, v142
    v_permlane16_swap_b32 v141, v143
    v_accvgpr_write_b32 a188, v140
    v_accvgpr_write_b32 a189, v141
    v_accvgpr_write_b32 a190, v142
    v_accvgpr_write_b32 a191, v143
    v_accvgpr_read_b32 v96, a96
    v_accvgpr_read_b32 v97, a97
    v_accvgpr_read_b32 v98, a98
    v_accvgpr_read_b32 v99, a99
    v_accvgpr_read_b32 v100, a108
    v_accvgpr_read_b32 v101, a109
    v_accvgpr_read_b32 v102, a110
    v_accvgpr_read_b32 v103, a111
    v_cvt_pk_bf16_f32 v104, v96, v97
    v_cvt_pk_bf16_f32 v105, v98, v99
    v_cvt_pk_bf16_f32 v106, v100, v101
    v_cvt_pk_bf16_f32 v107, v102, v103
    s_nop 0
    v_permlane32_swap_b32 v104, v106
    v_permlane32_swap_b32 v105, v107
    s_nop 0
    v_permlane16_swap_b32 v104, v106
    v_permlane16_swap_b32 v105, v107
    v_accvgpr_write_b32 a192, v104
    v_accvgpr_write_b32 a193, v105
    v_accvgpr_write_b32 a194, v106
    v_accvgpr_write_b32 a195, v107
    v_accvgpr_read_b32 v108, a100
    v_accvgpr_read_b32 v109, a101
    v_accvgpr_read_b32 v110, a102
    v_accvgpr_read_b32 v111, a103
    v_accvgpr_read_b32 v112, a112
    v_accvgpr_read_b32 v113, a113
    v_accvgpr_read_b32 v114, a114
    v_accvgpr_read_b32 v115, a115
    v_cvt_pk_bf16_f32 v116, v108, v109
    v_cvt_pk_bf16_f32 v117, v110, v111
    v_cvt_pk_bf16_f32 v118, v112, v113
    v_cvt_pk_bf16_f32 v119, v114, v115
    s_nop 0
    v_permlane32_swap_b32 v116, v118
    v_permlane32_swap_b32 v117, v119
    s_nop 0
    v_permlane16_swap_b32 v116, v118
    v_permlane16_swap_b32 v117, v119
    v_accvgpr_write_b32 a196, v116
    v_accvgpr_write_b32 a197, v117
    v_accvgpr_write_b32 a198, v118
    v_accvgpr_write_b32 a199, v119
    v_accvgpr_read_b32 v120, a104
    v_accvgpr_read_b32 v121, a105
    v_accvgpr_read_b32 v122, a106
    v_accvgpr_read_b32 v123, a107
    v_accvgpr_read_b32 v124, a116
    v_accvgpr_read_b32 v125, a117
    v_accvgpr_read_b32 v126, a118
    v_accvgpr_read_b32 v127, a119
    v_cvt_pk_bf16_f32 v128, v120, v121
    v_cvt_pk_bf16_f32 v129, v122, v123
    v_cvt_pk_bf16_f32 v130, v124, v125
    v_cvt_pk_bf16_f32 v131, v126, v127
    s_nop 0
    v_permlane32_swap_b32 v128, v130
    v_permlane32_swap_b32 v129, v131
    s_nop 0
    v_permlane16_swap_b32 v128, v130
    v_permlane16_swap_b32 v129, v131
    v_accvgpr_write_b32 a200, v128
    v_accvgpr_write_b32 a201, v129
    v_accvgpr_write_b32 a202, v130
    v_accvgpr_write_b32 a203, v131
    v_accvgpr_read_b32 v132, a120
    v_accvgpr_read_b32 v133, a121
    v_accvgpr_read_b32 v134, a122
    v_accvgpr_read_b32 v135, a123
    v_accvgpr_read_b32 v136, a132
    v_accvgpr_read_b32 v137, a133
    v_accvgpr_read_b32 v138, a134
    v_accvgpr_read_b32 v139, a135
    v_cvt_pk_bf16_f32 v140, v132, v133
    v_cvt_pk_bf16_f32 v141, v134, v135
    v_cvt_pk_bf16_f32 v142, v136, v137
    v_cvt_pk_bf16_f32 v143, v138, v139
    s_nop 0
    v_permlane32_swap_b32 v140, v142
    v_permlane32_swap_b32 v141, v143
    s_nop 0
    v_permlane16_swap_b32 v140, v142
    v_permlane16_swap_b32 v141, v143
    v_accvgpr_write_b32 a204, v140
    v_accvgpr_write_b32 a205, v141
    v_accvgpr_write_b32 a206, v142
    v_accvgpr_write_b32 a207, v143
    v_accvgpr_read_b32 v96, a124
    v_accvgpr_read_b32 v97, a125
    v_accvgpr_read_b32 v98, a126
    v_accvgpr_read_b32 v99, a127
    v_accvgpr_read_b32 v100, a136
    v_accvgpr_read_b32 v101, a137
    v_accvgpr_read_b32 v102, a138
    v_accvgpr_read_b32 v103, a139
    v_cvt_pk_bf16_f32 v104, v96, v97
    v_cvt_pk_bf16_f32 v105, v98, v99
    v_cvt_pk_bf16_f32 v106, v100, v101
    v_cvt_pk_bf16_f32 v107, v102, v103
    s_nop 0
    v_permlane32_swap_b32 v104, v106
    v_permlane32_swap_b32 v105, v107
    s_nop 0
    v_permlane16_swap_b32 v104, v106
    v_permlane16_swap_b32 v105, v107
    v_accvgpr_write_b32 a208, v104
    v_accvgpr_write_b32 a209, v105
    v_accvgpr_write_b32 a210, v106
    v_accvgpr_write_b32 a211, v107
    v_accvgpr_read_b32 v108, a128
    v_accvgpr_read_b32 v109, a129
    v_accvgpr_read_b32 v110, a130
    v_accvgpr_read_b32 v111, a131
    v_accvgpr_read_b32 v112, a140
    v_accvgpr_read_b32 v113, a141
    v_accvgpr_read_b32 v114, a142
    v_accvgpr_read_b32 v115, a143
    v_cvt_pk_bf16_f32 v116, v108, v109
    v_cvt_pk_bf16_f32 v117, v110, v111
    v_cvt_pk_bf16_f32 v118, v112, v113
    v_cvt_pk_bf16_f32 v119, v114, v115
    s_nop 0
    v_permlane32_swap_b32 v116, v118
    v_permlane32_swap_b32 v117, v119
    s_nop 0
    v_permlane16_swap_b32 v116, v118
    v_permlane16_swap_b32 v117, v119
    v_accvgpr_write_b32 a212, v116
    v_accvgpr_write_b32 a213, v117
    v_accvgpr_write_b32 a214, v118
    v_accvgpr_write_b32 a215, v119
    ds_read_b128 v[192:195], v24 offset:6144
    s_waitcnt lgkmcnt(5)
    v_mfma_f32_16x16x32_bf16 v[48:51], v[168:171], a[144:147], 0
    v_mfma_f32_16x16x32_bf16 v[52:55], v[168:171], a[148:151], 0
    v_mfma_f32_16x16x32_bf16 v[56:59], v[168:171], a[152:155], 0
    ds_read_b128 v[196:199], v25 offset:6144
    v_mfma_f32_16x16x32_bf16 v[48:51], v[172:175], a[156:159], v[48:51]
    v_mfma_f32_16x16x32_bf16 v[52:55], v[172:175], a[160:163], v[52:55]
    buffer_load_dwordx4 v5, s[44:47], s67 offen offset:1024 nt lds
    v_mfma_f32_16x16x32_bf16 v[56:59], v[172:175], a[164:167], v[56:59]
    ds_read_b128 v[200:203], v24 offset:6272
    s_waitcnt lgkmcnt(5)
    v_mfma_f32_16x16x32_bf16 v[48:51], v[176:179], a[168:171], v[48:51]
    v_mfma_f32_16x16x32_bf16 v[52:55], v[176:179], a[172:175], v[52:55]
    v_mfma_f32_16x16x32_bf16 v[56:59], v[176:179], a[176:179], v[56:59]
    ds_read_b128 v[204:207], v25 offset:6272
    v_mfma_f32_16x16x32_bf16 v[48:51], v[180:183], a[180:183], v[48:51]
    buffer_load_dwordx4 v6, s[44:47], s67 offen offset:2048 nt lds
    v_mfma_f32_16x16x32_bf16 v[52:55], v[180:183], a[184:187], v[52:55]
    v_mfma_f32_16x16x32_bf16 v[56:59], v[180:183], a[188:191], v[56:59]
    ds_read_b128 v[208:211], v24 offset:6400
    s_waitcnt lgkmcnt(5)
    v_mfma_f32_16x16x32_bf16 v[48:51], v[184:187], a[192:195], v[48:51]
    v_mfma_f32_16x16x32_bf16 v[52:55], v[184:187], a[196:199], v[52:55]
    v_mfma_f32_16x16x32_bf16 v[56:59], v[184:187], a[200:203], v[56:59]
    ds_read_b128 v[212:215], v25 offset:6400
    v_mfma_f32_16x16x32_bf16 v[48:51], v[188:191], a[204:207], v[48:51]
    v_mfma_f32_16x16x32_bf16 v[52:55], v[188:191], a[208:211], v[52:55]
    v_mfma_f32_16x16x32_bf16 v[56:59], v[188:191], a[212:215], v[56:59]
    ds_read_b128 v[168:171], v24 offset:12288
    s_waitcnt lgkmcnt(5)
    v_mfma_f32_16x16x32_bf16 v[60:63], v[192:195], a[144:147], 0
    v_mfma_f32_16x16x32_bf16 v[64:67], v[192:195], a[148:151], 0
    v_mfma_f32_16x16x32_bf16 v[68:71], v[192:195], a[152:155], 0
    ds_read_b128 v[172:175], v25 offset:12288
    v_mfma_f32_16x16x32_bf16 v[60:63], v[196:199], a[156:159], v[60:63]
    v_mfma_f32_16x16x32_bf16 v[64:67], v[196:199], a[160:163], v[64:67]
    v_mfma_f32_16x16x32_bf16 v[68:71], v[196:199], a[164:167], v[68:71]
    ds_read_b128 v[176:179], v24 offset:12416
    s_waitcnt lgkmcnt(5)
    v_mfma_f32_16x16x32_bf16 v[60:63], v[200:203], a[168:171], v[60:63]
    v_mfma_f32_16x16x32_bf16 v[64:67], v[200:203], a[172:175], v[64:67]
    v_mfma_f32_16x16x32_bf16 v[68:71], v[200:203], a[176:179], v[68:71]
    ds_read_b128 v[180:183], v25 offset:12416
    v_mfma_f32_16x16x32_bf16 v[60:63], v[204:207], a[180:183], v[60:63]
    v_mfma_f32_16x16x32_bf16 v[64:67], v[204:207], a[184:187], v[64:67]
    v_mfma_f32_16x16x32_bf16 v[68:71], v[204:207], a[188:191], v[68:71]
    ds_read_b128 v[184:187], v24 offset:12544
    s_waitcnt lgkmcnt(5)
    v_mfma_f32_16x16x32_bf16 v[60:63], v[208:211], a[192:195], v[60:63]
    v_mfma_f32_16x16x32_bf16 v[64:67], v[208:211], a[196:199], v[64:67]
    v_mfma_f32_16x16x32_bf16 v[68:71], v[208:211], a[200:203], v[68:71]
    ds_read_b128 v[188:191], v25 offset:12544
    v_mfma_f32_16x16x32_bf16 v[60:63], v[212:215], a[204:207], v[60:63]
    v_mfma_f32_16x16x32_bf16 v[64:67], v[212:215], a[208:211], v[64:67]
    v_mfma_f32_16x16x32_bf16 v[68:71], v[212:215], a[212:215], v[68:71]
    ds_read_b128 v[192:195], v24 offset:18432
    s_waitcnt lgkmcnt(5)
    v_mfma_f32_16x16x32_bf16 v[72:75], v[168:171], a[144:147], 0
    v_mfma_f32_16x16x32_bf16 v[76:79], v[168:171], a[148:151], 0
    v_mfma_f32_16x16x32_bf16 v[80:83], v[168:171], a[152:155], 0
    ds_read_b128 v[196:199], v25 offset:18432
    v_mfma_f32_16x16x32_bf16 v[72:75], v[172:175], a[156:159], v[72:75]
    v_mfma_f32_16x16x32_bf16 v[76:79], v[172:175], a[160:163], v[76:79]
    v_mfma_f32_16x16x32_bf16 v[80:83], v[172:175], a[164:167], v[80:83]
    ds_read_b128 v[200:203], v24 offset:18560
    s_waitcnt lgkmcnt(5)
    v_mfma_f32_16x16x32_bf16 v[72:75], v[176:179], a[168:171], v[72:75]
    v_mfma_f32_16x16x32_bf16 v[76:79], v[176:179], a[172:175], v[76:79]
    v_mfma_f32_16x16x32_bf16 v[80:83], v[176:179], a[176:179], v[80:83]
    ds_read_b128 v[204:207], v25 offset:18560
    v_mfma_f32_16x16x32_bf16 v[72:75], v[180:183], a[180:183], v[72:75]
    v_mfma_f32_16x16x32_bf16 v[76:79], v[180:183], a[184:187], v[76:79]
    v_mfma_f32_16x16x32_bf16 v[80:83], v[180:183], a[188:191], v[80:83]
    ds_read_b128 v[208:211], v24 offset:18688
    s_waitcnt lgkmcnt(5)
    v_mfma_f32_16x16x32_bf16 v[72:75], v[184:187], a[192:195], v[72:75]
    v_mfma_f32_16x16x32_bf16 v[76:79], v[184:187], a[196:199], v[76:79]
    v_mfma_f32_16x16x32_bf16 v[80:83], v[184:187], a[200:203], v[80:83]
    ds_read_b128 v[212:215], v25 offset:18688
    v_mfma_f32_16x16x32_bf16 v[72:75], v[188:191], a[204:207], v[72:75]
    v_mfma_f32_16x16x32_bf16 v[76:79], v[188:191], a[208:211], v[76:79]
    v_mfma_f32_16x16x32_bf16 v[80:83], v[188:191], a[212:215], v[80:83]
    s_waitcnt vmcnt(18)
    s_barrier
    v_add_u32 v24, s65, v14
    v_add_u32 v25, s65, v15
    ds_read_b128 v[168:171], v24 offset:0
    s_waitcnt lgkmcnt(5)
    v_mfma_f32_16x16x32_bf16 v[84:87], v[192:195], a[144:147], 0
    s_add_u32 m0, s63, s66
    s_add_u32 s67, s56, 73728
    buffer_load_dwordx4 v4, s[40:43], s67 offen offset:0 nt lds
    v_mfma_f32_16x16x32_bf16 v[88:91], v[192:195], a[148:151], 0
    v_mfma_f32_16x16x32_bf16 v[92:95], v[192:195], a[152:155], 0
    ds_read_b128 v[172:175], v25 offset:0
    v_mfma_f32_16x16x32_bf16 v[84:87], v[196:199], a[156:159], v[84:87]
    v_mfma_f32_16x16x32_bf16 v[88:91], v[196:199], a[160:163], v[88:91]
    v_mfma_f32_16x16x32_bf16 v[92:95], v[196:199], a[164:167], v[92:95]
    buffer_load_dwordx4 v5, s[40:43], s67 offen offset:1024 nt lds
    ds_read_b128 v[176:179], v24 offset:128
    s_waitcnt lgkmcnt(5)
    v_mfma_f32_16x16x32_bf16 v[84:87], v[200:203], a[168:171], v[84:87]
    v_mfma_f32_16x16x32_bf16 v[88:91], v[200:203], a[172:175], v[88:91]
    v_mfma_f32_16x16x32_bf16 v[92:95], v[200:203], a[176:179], v[92:95]
    ds_read_b128 v[180:183], v25 offset:128
    v_mfma_f32_16x16x32_bf16 v[84:87], v[204:207], a[180:183], v[84:87]
    v_mfma_f32_16x16x32_bf16 v[88:91], v[204:207], a[184:187], v[88:91]
    buffer_load_dwordx4 v6, s[40:43], s67 offen offset:2048 nt lds
    v_mfma_f32_16x16x32_bf16 v[92:95], v[204:207], a[188:191], v[92:95]
    ds_read_b128 v[184:187], v24 offset:256
    s_waitcnt lgkmcnt(5)
    v_mfma_f32_16x16x32_bf16 v[84:87], v[208:211], a[192:195], v[84:87]
    v_mfma_f32_16x16x32_bf16 v[88:91], v[208:211], a[196:199], v[88:91]
    v_mfma_f32_16x16x32_bf16 v[92:95], v[208:211], a[200:203], v[92:95]
    ds_read_b128 v[188:191], v25 offset:256
    v_mfma_f32_16x16x32_bf16 v[84:87], v[212:215], a[204:207], v[84:87]
    s_add_u32 m0, m0, 3072
    s_add_u32 s67, s67, 3072
    buffer_load_dwordx4 v4, s[40:43], s67 offen offset:0 nt lds
    v_mfma_f32_16x16x32_bf16 v[88:91], v[212:215], a[208:211], v[88:91]
    v_mfma_f32_16x16x32_bf16 v[92:95], v[212:215], a[212:215], v[92:95]
    ds_read_b128 v[192:195], v24 offset:6144
    s_waitcnt lgkmcnt(5)
    v_mfma_f32_16x16x32_bf16 v[96:99], v[168:171], a[144:147], 0
    v_max3_f32 v36, v48, v49, v50
    v_max3_f32 v37, v52, v53, v54
    v_max3_f32 v38, v56, v57, v58
    v_mfma_f32_16x16x32_bf16 v[100:103], v[168:171], a[148:151], 0
    v_max3_f32 v36, v36, v51, v60
    v_max3_f32 v37, v37, v55, v64
    v_mfma_f32_16x16x32_bf16 v[104:107], v[168:171], a[152:155], 0
    buffer_load_dwordx4 v5, s[40:43], s67 offen offset:1024 nt lds
    v_max3_f32 v38, v38, v59, v68
    v_max3_f32 v36, v36, v61, v62
    ds_read_b128 v[196:199], v25 offset:6144
    v_mfma_f32_16x16x32_bf16 v[96:99], v[172:175], a[156:159], v[96:99]
    v_max3_f32 v37, v37, v65, v66
    v_max3_f32 v38, v38, v69, v70
    v_max3_f32 v36, v36, v63, v72
    v_mfma_f32_16x16x32_bf16 v[100:103], v[172:175], a[160:163], v[100:103]
    v_max3_f32 v37, v37, v67, v76
    v_max3_f32 v38, v38, v71, v80
    v_mfma_f32_16x16x32_bf16 v[104:107], v[172:175], a[164:167], v[104:107]
    v_max3_f32 v36, v36, v73, v74
    v_max3_f32 v37, v37, v77, v78
    ds_read_b128 v[200:203], v24 offset:6272
    s_waitcnt lgkmcnt(5)
    v_mfma_f32_16x16x32_bf16 v[96:99], v[176:179], a[168:171], v[96:99]
    v_max3_f32 v38, v38, v81, v82
    v_max3_f32 v36, v36, v75, v84
    v_max3_f32 v37, v37, v79, v88
    v_mfma_f32_16x16x32_bf16 v[100:103], v[176:179], a[172:175], v[100:103]
    buffer_load_dwordx4 v6, s[40:43], s67 offen offset:2048 nt lds
    v_max3_f32 v38, v38, v83, v92
    v_max3_f32 v36, v36, v85, v86
    v_mfma_f32_16x16x32_bf16 v[104:107], v[176:179], a[176:179], v[104:107]
    v_max3_f32 v37, v37, v89, v90
    v_max3_f32 v38, v38, v93, v94
    ds_read_b128 v[204:207], v25 offset:6272
    v_mfma_f32_16x16x32_bf16 v[96:99], v[180:183], a[180:183], v[96:99]
    v_max_f32 v36, v36, v87
    v_max_f32 v37, v37, v91
    v_mfma_f32_16x16x32_bf16 v[100:103], v[180:183], a[184:187], v[100:103]
    v_max_f32 v38, v38, v95
    v_mov_b32 v39, v36
    v_mov_b32 v40, v37
    v_mfma_f32_16x16x32_bf16 v[104:107], v[180:183], a[188:191], v[104:107]
    v_mov_b32 v41, v38
    v_permlane16_swap_b32 v36, v39
    ds_read_b128 v[208:211], v24 offset:6400
    s_waitcnt lgkmcnt(5)
    v_mfma_f32_16x16x32_bf16 v[96:99], v[184:187], a[192:195], v[96:99]
    v_permlane16_swap_b32 v37, v40
    v_permlane16_swap_b32 v38, v41
    v_mfma_f32_16x16x32_bf16 v[100:103], v[184:187], a[196:199], v[100:103]
    v_max_f32 v36, v36, v39
    v_max_f32 v37, v37, v40
    v_max_f32 v38, v38, v41
    v_mfma_f32_16x16x32_bf16 v[104:107], v[184:187], a[200:203], v[104:107]
    v_mov_b32 v39, v36
    v_mov_b32 v40, v37
    ds_read_b128 v[212:215], v25 offset:6400
    v_mfma_f32_16x16x32_bf16 v[96:99], v[188:191], a[204:207], v[96:99]
    v_mov_b32 v41, v38
    v_permlane32_swap_b32 v36, v39
    v_mfma_f32_16x16x32_bf16 v[100:103], v[188:191], a[208:211], v[100:103]
    v_permlane32_swap_b32 v37, v40
    v_permlane32_swap_b32 v38, v41
    v_mfma_f32_16x16x32_bf16 v[104:107], v[188:191], a[212:215], v[104:107]
    v_max_f32 v36, v36, v39
    v_max_f32 v37, v37, v40
    v_max_f32 v38, v38, v41
    ds_read_b128 v[168:171], v24 offset:12288
    s_waitcnt lgkmcnt(5)
    v_mfma_f32_16x16x32_bf16 v[108:111], v[192:195], a[144:147], 0
    v_mul_f32 v30, s70, v36
    v_mul_f32 v31, s70, v37
    v_mfma_f32_16x16x32_bf16 v[112:115], v[192:195], a[148:151], 0
    v_mul_f32 v32, s70, v38
    v_fma_f32 v48, v48, s70, -v30
    v_mfma_f32_16x16x32_bf16 v[116:119], v[192:195], a[152:155], 0
    v_fma_f32 v49, v49, s70, -v30
    v_fma_f32 v50, v50, s70, -v30
    v_fma_f32 v51, v51, s70, -v30
    ds_read_b128 v[172:175], v25 offset:12288
    v_mfma_f32_16x16x32_bf16 v[108:111], v[196:199], a[156:159], v[108:111]
    v_exp_f32 v48, v48
    v_exp_f32 v49, v49
    v_mfma_f32_16x16x32_bf16 v[112:115], v[196:199], a[160:163], v[112:115]
    v_exp_f32 v50, v50
    v_exp_f32 v51, v51
    v_mfma_f32_16x16x32_bf16 v[116:119], v[196:199], a[164:167], v[116:119]
    v_fma_f32 v52, v52, s70, -v31
    v_fma_f32 v53, v53, s70, -v31
    ds_read_b128 v[176:179], v24 offset:12416
    s_waitcnt lgkmcnt(5)
    v_mfma_f32_16x16x32_bf16 v[108:111], v[200:203], a[168:171], v[108:111]
    v_fma_f32 v54, v54, s70, -v31
    v_fma_f32 v55, v55, s70, -v31
    v_exp_f32 v52, v52
    v_mfma_f32_16x16x32_bf16 v[112:115], v[200:203], a[172:175], v[112:115]
    v_exp_f32 v53, v53
    v_exp_f32 v54, v54
    v_mfma_f32_16x16x32_bf16 v[116:119], v[200:203], a[176:179], v[116:119]
    v_exp_f32 v55, v55
    v_fma_f32 v56, v56, s70, -v32
    ds_read_b128 v[180:183], v25 offset:12416
    v_mfma_f32_16x16x32_bf16 v[108:111], v[204:207], a[180:183], v[108:111]
    v_fma_f32 v57, v57, s70, -v32
    v_fma_f32 v58, v58, s70, -v32
    v_fma_f32 v59, v59, s70, -v32
    v_mfma_f32_16x16x32_bf16 v[112:115], v[204:207], a[184:187], v[112:115]
    v_exp_f32 v56, v56
    v_exp_f32 v57, v57
    v_mfma_f32_16x16x32_bf16 v[116:119], v[204:207], a[188:191], v[116:119]
    v_exp_f32 v58, v58
    v_exp_f32 v59, v59
    ds_read_b128 v[184:187], v24 offset:12544
    s_waitcnt lgkmcnt(5)
    v_mfma_f32_16x16x32_bf16 v[108:111], v[208:211], a[192:195], v[108:111]
    v_fma_f32 v60, v60, s70, -v30
    v_fma_f32 v61, v61, s70, -v30
    v_fma_f32 v62, v62, s70, -v30
    v_mfma_f32_16x16x32_bf16 v[112:115], v[208:211], a[196:199], v[112:115]
    v_fma_f32 v63, v63, s70, -v30
    v_exp_f32 v60, v60
    v_mfma_f32_16x16x32_bf16 v[116:119], v[208:211], a[200:203], v[116:119]
    v_exp_f32 v61, v61
    v_exp_f32 v62, v62
    ds_read_b128 v[188:191], v25 offset:12544
    v_mfma_f32_16x16x32_bf16 v[108:111], v[212:215], a[204:207], v[108:111]
    v_exp_f32 v63, v63
    v_fma_f32 v64, v64, s70, -v31
    v_mfma_f32_16x16x32_bf16 v[112:115], v[212:215], a[208:211], v[112:115]
    v_fma_f32 v65, v65, s70, -v31
    v_fma_f32 v66, v66, s70, -v31
    v_fma_f32 v67, v67, s70, -v31
    v_mfma_f32_16x16x32_bf16 v[116:119], v[212:215], a[212:215], v[116:119]
    v_exp_f32 v64, v64
    v_exp_f32 v65, v65
    ds_read_b128 v[192:195], v24 offset:18432
    s_waitcnt lgkmcnt(5)
    v_mfma_f32_16x16x32_bf16 v[120:123], v[168:171], a[144:147], 0
    v_exp_f32 v66, v66
    v_exp_f32 v67, v67
    v_mfma_f32_16x16x32_bf16 v[124:127], v[168:171], a[148:151], 0
    v_fma_f32 v68, v68, s70, -v32
    v_fma_f32 v69, v69, s70, -v32
    v_fma_f32 v70, v70, s70, -v32
    v_mfma_f32_16x16x32_bf16 v[128:131], v[168:171], a[152:155], 0
    v_fma_f32 v71, v71, s70, -v32
    v_exp_f32 v68, v68
    ds_read_b128 v[196:199], v25 offset:18432
    v_mfma_f32_16x16x32_bf16 v[120:123], v[172:175], a[156:159], v[120:123]
    v_exp_f32 v69, v69
    v_exp_f32 v70, v70
    v_mfma_f32_16x16x32_bf16 v[124:127], v[172:175], a[160:163], v[124:127]
    v_exp_f32 v71, v71
    v_cvt_pk_bf16_f32 v144, v48, v49
    v_mfma_f32_16x16x32_bf16 v[128:131], v[172:175], a[164:167], v[128:131]
    v_cvt_pk_bf16_f32 v145, v50, v51
    v_cvt_pk_bf16_f32 v148, v52, v53
    v_cvt_pk_bf16_f32 v149, v54, v55
    ds_read_b128 v[200:203], v24 offset:18560
    s_waitcnt lgkmcnt(5)
    v_mfma_f32_16x16x32_bf16 v[120:123], v[176:179], a[168:171], v[120:123]
    v_cvt_pk_bf16_f32 v152, v56, v57
    v_cvt_pk_bf16_f32 v153, v58, v59
    v_mfma_f32_16x16x32_bf16 v[124:127], v[176:179], a[172:175], v[124:127]
    v_fma_f32 v72, v72, s70, -v30
    v_fma_f32 v73, v73, s70, -v30
    v_mfma_f32_16x16x32_bf16 v[128:131], v[176:179], a[176:179], v[128:131]
    v_fma_f32 v74, v74, s70, -v30
    v_fma_f32 v75, v75, s70, -v30
    v_exp_f32 v72, v72
    ds_read_b128 v[204:207], v25 offset:18560
    v_mfma_f32_16x16x32_bf16 v[120:123], v[180:183], a[180:183], v[120:123]
    v_exp_f32 v73, v73
    v_exp_f32 v74, v74
    v_mfma_f32_16x16x32_bf16 v[124:127], v[180:183], a[184:187], v[124:127]
    v_exp_f32 v75, v75
    v_fma_f32 v76, v76, s70, -v31
    v_mfma_f32_16x16x32_bf16 v[128:131], v[180:183], a[188:191], v[128:131]
    v_fma_f32 v77, v77, s70, -v31
    v_fma_f32 v78, v78, s70, -v31
    ds_read_b128 v[208:211], v24 offset:18688
    s_waitcnt lgkmcnt(5)
    v_mfma_f32_16x16x32_bf16 v[120:123], v[184:187], a[192:195], v[120:123]
    v_fma_f32 v79, v79, s70, -v31
    v_exp_f32 v76, v76
    v_exp_f32 v77, v77
    v_mfma_f32_16x16x32_bf16 v[124:127], v[184:187], a[196:199], v[124:127]
    v_exp_f32 v78, v78
    v_exp_f32 v79, v79
    v_mfma_f32_16x16x32_bf16 v[128:131], v[184:187], a[200:203], v[128:131]
    v_fma_f32 v80, v80, s70, -v32
    v_fma_f32 v81, v81, s70, -v32
    ds_read_b128 v[212:215], v25 offset:18688
    v_mfma_f32_16x16x32_bf16 v[120:123], v[188:191], a[204:207], v[120:123]
    v_fma_f32 v82, v82, s70, -v32
    v_fma_f32 v83, v83, s70, -v32
    v_exp_f32 v80, v80
    v_mfma_f32_16x16x32_bf16 v[124:127], v[188:191], a[208:211], v[124:127]
    v_exp_f32 v81, v81
    v_exp_f32 v82, v82
    v_mfma_f32_16x16x32_bf16 v[128:131], v[188:191], a[212:215], v[128:131]
    v_exp_f32 v83, v83
    v_cvt_pk_bf16_f32 v146, v60, v61
    s_waitcnt vmcnt(18)
    s_barrier
    v_add_u32 v26, s60, v16
    v_add_u32 v27, s60, v17
    v_add_u32 v28, s60, v18
    v_add_u32 v29, s60, v19
    ds_read_b64_tr_b16 v[168:169], v26 offset:0
    ds_read_b64_tr_b16 v[170:171], v26 offset:6144
    s_waitcnt lgkmcnt(6)
    v_mfma_f32_16x16x32_bf16 v[132:135], v[192:195], a[144:147], 0
    v_cvt_pk_bf16_f32 v147, v62, v63
    v_cvt_pk_bf16_f32 v150, v64, v65
    v_cvt_pk_bf16_f32 v151, v66, v67
    v_mfma_f32_16x16x32_bf16 v[136:139], v[192:195], a[148:151], 0
    v_cvt_pk_bf16_f32 v154, v68, v69
    v_cvt_pk_bf16_f32 v155, v70, v71
    v_mfma_f32_16x16x32_bf16 v[140:143], v[192:195], a[152:155], 0
    v_fma_f32 v84, v84, s70, -v30
    v_fma_f32 v85, v85, s70, -v30
    ds_read_b64_tr_b16 v[172:173], v27 offset:0
    ds_read_b64_tr_b16 v[174:175], v27 offset:6144
    v_mfma_f32_16x16x32_bf16 v[132:135], v[196:199], a[156:159], v[132:135]
    s_add_u32 m0, s64, s66
    s_add_u32 s67, s56, 49152
    buffer_load_dwordx4 v4, s[44:47], s67 offen offset:0 nt lds
    v_fma_f32 v86, v86, s70, -v30
    v_fma_f32 v87, v87, s70, -v30
    v_mfma_f32_16x16x32_bf16 v[136:139], v[196:199], a[160:163], v[136:139]
    v_exp_f32 v84, v84
    v_exp_f32 v85, v85
    v_exp_f32 v86, v86
    v_mfma_f32_16x16x32_bf16 v[140:143], v[196:199], a[164:167], v[140:143]
    v_exp_f32 v87, v87
    v_fma_f32 v88, v88, s70, -v31
    ds_read_b64_tr_b16 v[176:177], v28 offset:0
    ds_read_b64_tr_b16 v[178:179], v28 offset:6144
    s_waitcnt lgkmcnt(8)
    v_mfma_f32_16x16x32_bf16 v[132:135], v[200:203], a[168:171], v[132:135]
    v_fma_f32 v89, v89, s70, -v31
    v_fma_f32 v90, v90, s70, -v31
    v_mfma_f32_16x16x32_bf16 v[136:139], v[200:203], a[172:175], v[136:139]
    v_fma_f32 v91, v91, s70, -v31
    v_exp_f32 v88, v88
    v_exp_f32 v89, v89
    v_mfma_f32_16x16x32_bf16 v[140:143], v[200:203], a[176:179], v[140:143]
    buffer_load_dwordx4 v5, s[44:47], s67 offen offset:1024 nt lds
    v_exp_f32 v90, v90
    v_exp_f32 v91, v91
    ds_read_b64_tr_b16 v[180:181], v29 offset:0
    ds_read_b64_tr_b16 v[182:183], v29 offset:6144
    v_mfma_f32_16x16x32_bf16 v[132:135], v[204:207], a[180:183], v[132:135]
    v_fma_f32 v92, v92, s70, -v32
    v_fma_f32 v93, v93, s70, -v32
    v_mfma_f32_16x16x32_bf16 v[136:139], v[204:207], a[184:187], v[136:139]
    v_fma_f32 v94, v94, s70, -v32
    v_fma_f32 v95, v95, s70, -v32
    v_mfma_f32_16x16x32_bf16 v[140:143], v[204:207], a[188:191], v[140:143]
    v_exp_f32 v92, v92
    v_exp_f32 v93, v93
    v_exp_f32 v94, v94
    ds_read_b64_tr_b16 v[184:185], v26 offset:128
    ds_read_b64_tr_b16 v[186:187], v26 offset:6272
    s_waitcnt lgkmcnt(10)
    v_mfma_f32_16x16x32_bf16 v[132:135], v[208:211], a[192:195], v[132:135]
    v_exp_f32 v95, v95
    v_cvt_pk_bf16_f32 v156, v72, v73
    v_mfma_f32_16x16x32_bf16 v[136:139], v[208:211], a[196:199], v[136:139]
    buffer_load_dwordx4 v6, s[44:47], s67 offen offset:2048 nt lds
    v_cvt_pk_bf16_f32 v157, v74, v75
    v_cvt_pk_bf16_f32 v160, v76, v77
    v_mfma_f32_16x16x32_bf16 v[140:143], v[208:211], a[200:203], v[140:143]
    v_cvt_pk_bf16_f32 v161, v78, v79
    v_cvt_pk_bf16_f32 v164, v80, v81
    v_cvt_pk_bf16_f32 v165, v82, v83
    ds_read_b64_tr_b16 v[188:189], v27 offset:128
    ds_read_b64_tr_b16 v[190:191], v27 offset:6272
    v_mfma_f32_16x16x32_bf16 v[132:135], v[212:215], a[204:207], v[132:135]
    v_cvt_pk_bf16_f32 v158, v84, v85
    v_cvt_pk_bf16_f32 v159, v86, v87
    v_mfma_f32_16x16x32_bf16 v[136:139], v[212:215], a[208:211], v[136:139]
    v_cvt_pk_bf16_f32 v162, v88, v89
    v_cvt_pk_bf16_f32 v163, v90, v91
    v_mfma_f32_16x16x32_bf16 v[140:143], v[212:215], a[212:215], v[140:143]
    v_cvt_pk_bf16_f32 v166, v92, v93
    v_cvt_pk_bf16_f32 v167, v94, v95
    ds_read_b64_tr_b16 v[192:193], v28 offset:128
    ds_read_b64_tr_b16 v[194:195], v28 offset:6272
    v_mfma_f32_16x16x32_bf16 a[216:219], v[252:255], v[144:147], 0
    v_mfma_f32_16x16x32_bf16 a[220:223], v[252:255], v[148:151], 0
    v_mfma_f32_16x16x32_bf16 a[224:227], v[252:255], v[152:155], 0
    s_waitcnt lgkmcnt(10)
    v_mfma_f32_16x16x32_bf16 a[0:3], v[168:171], v[144:147], 0
    s_add_u32 m0, m0, 3072
    s_add_u32 s67, s67, 3072
    buffer_load_dwordx4 v4, s[44:47], s67 offen offset:0 nt lds
    v_max3_f32 v36, v96, v97, v98
    v_mfma_f32_16x16x32_bf16 a[4:7], v[168:171], v[148:151], 0
    v_mfma_f32_16x16x32_bf16 a[8:11], v[168:171], v[152:155], 0
    v_max3_f32 v37, v100, v101, v102
    ds_read_b64_tr_b16 v[196:197], v29 offset:128
    ds_read_b64_tr_b16 v[198:199], v29 offset:6272
    v_mfma_f32_16x16x32_bf16 a[12:15], v[172:175], v[144:147], 0
    v_mfma_f32_16x16x32_bf16 a[16:19], v[172:175], v[148:151], 0
    v_max3_f32 v38, v104, v105, v106
    v_mfma_f32_16x16x32_bf16 a[20:23], v[172:175], v[152:155], 0
    buffer_load_dwordx4 v5, s[44:47], s67 offen offset:1024 nt lds
    ds_read_b64_tr_b16 v[200:201], v26 offset:256
    ds_read_b64_tr_b16 v[202:203], v26 offset:6400
    s_waitcnt lgkmcnt(10)
    v_mfma_f32_16x16x32_bf16 a[24:27], v[176:179], v[144:147], 0
    v_mfma_f32_16x16x32_bf16 a[28:31], v[176:179], v[148:151], 0
    v_max3_f32 v36, v36, v99, v108
    v_mfma_f32_16x16x32_bf16 a[32:35], v[176:179], v[152:155], 0
    ds_read_b64_tr_b16 v[204:205], v27 offset:256
    ds_read_b64_tr_b16 v[206:207], v27 offset:6400
    v_mfma_f32_16x16x32_bf16 a[36:39], v[180:183], v[144:147], 0
    v_max3_f32 v37, v37, v103, v112
    v_mfma_f32_16x16x32_bf16 a[40:43], v[180:183], v[148:151], 0
    buffer_load_dwordx4 v6, s[44:47], s67 offen offset:2048 nt lds
    v_mfma_f32_16x16x32_bf16 a[44:47], v[180:183], v[152:155], 0
    ds_read_b64_tr_b16 v[208:209], v28 offset:256
    ds_read_b64_tr_b16 v[210:211], v28 offset:6400
    s_waitcnt lgkmcnt(10)
    v_mfma_f32_16x16x32_bf16 a[48:51], v[184:187], v[144:147], 0
    v_max3_f32 v38, v38, v107, v116
    v_mfma_f32_16x16x32_bf16 a[52:55], v[184:187], v[148:151], 0
    v_mfma_f32_16x16x32_bf16 a[56:59], v[184:187], v[152:155], 0
    v_max3_f32 v36, v36, v109, v110
    ds_read_b64_tr_b16 v[212:213], v29 offset:256
    ds_read_b64_tr_b16 v[214:215], v29 offset:6400
    v_mfma_f32_16x16x32_bf16 a[60:63], v[188:191], v[144:147], 0
    v_mfma_f32_16x16x32_bf16 a[64:67], v[188:191], v[148:151], 0
    v_mfma_f32_16x16x32_bf16 a[68:71], v[188:191], v[152:155], 0
    v_max3_f32 v37, v37, v113, v114
    ds_read_b64_tr_b16 v[168:169], v26 offset:12288
    ds_read_b64_tr_b16 v[170:171], v26 offset:18432
    s_waitcnt lgkmcnt(10)
    v_mfma_f32_16x16x32_bf16 a[72:75], v[192:195], v[144:147], 0
    v_mfma_f32_16x16x32_bf16 a[76:79], v[192:195], v[148:151], 0
    v_max3_f32 v38, v38, v117, v118
    v_mfma_f32_16x16x32_bf16 a[80:83], v[192:195], v[152:155], 0
    ds_read_b64_tr_b16 v[172:173], v27 offset:12288
    ds_read_b64_tr_b16 v[174:175], v27 offset:18432
    v_mfma_f32_16x16x32_bf16 a[84:87], v[196:199], v[144:147], 0
    v_mfma_f32_16x16x32_bf16 a[88:91], v[196:199], v[148:151], 0
    v_max3_f32 v36, v36, v111, v120
    v_mfma_f32_16x16x32_bf16 a[92:95], v[196:199], v[152:155], 0
    ds_read_b64_tr_b16 v[176:177], v28 offset:12288
    ds_read_b64_tr_b16 v[178:179], v28 offset:18432
    s_waitcnt lgkmcnt(10)
    v_mfma_f32_16x16x32_bf16 a[96:99], v[200:203], v[144:147], 0
    v_max3_f32 v37, v37, v115, v124
    v_mfma_f32_16x16x32_bf16 a[100:103], v[200:203], v[148:151], 0
    v_mfma_f32_16x16x32_bf16 a[104:107], v[200:203], v[152:155], 0
    ds_read_b64_tr_b16 v[180:181], v29 offset:12288
    ds_read_b64_tr_b16 v[182:183], v29 offset:18432
    v_mfma_f32_16x16x32_bf16 a[108:111], v[204:207], v[144:147], 0
    v_max3_f32 v38, v38, v119, v128
    v_mfma_f32_16x16x32_bf16 a[112:115], v[204:207], v[148:151], 0
    v_mfma_f32_16x16x32_bf16 a[116:119], v[204:207], v[152:155], 0
    v_max3_f32 v36, v36, v121, v122
    ds_read_b64_tr_b16 v[184:185], v26 offset:12416
    ds_read_b64_tr_b16 v[186:187], v26 offset:18560
    s_waitcnt lgkmcnt(10)
    v_mfma_f32_16x16x32_bf16 a[120:123], v[208:211], v[144:147], 0
    v_mfma_f32_16x16x32_bf16 a[124:127], v[208:211], v[148:151], 0
    v_mfma_f32_16x16x32_bf16 a[128:131], v[208:211], v[152:155], 0
    v_max3_f32 v37, v37, v125, v126
    ds_read_b64_tr_b16 v[188:189], v27 offset:12416
    ds_read_b64_tr_b16 v[190:191], v27 offset:18560
    v_mfma_f32_16x16x32_bf16 a[132:135], v[212:215], v[144:147], 0
    v_mfma_f32_16x16x32_bf16 a[136:139], v[212:215], v[148:151], 0
    v_max3_f32 v38, v38, v129, v130
    v_mfma_f32_16x16x32_bf16 a[140:143], v[212:215], v[152:155], 0
    ds_read_b64_tr_b16 v[192:193], v28 offset:12416
    ds_read_b64_tr_b16 v[194:195], v28 offset:18560
    v_mfma_f32_16x16x32_bf16 a[216:219], v[252:255], v[156:159], a[216:219]
    v_mfma_f32_16x16x32_bf16 a[220:223], v[252:255], v[160:163], a[220:223]
    v_mfma_f32_16x16x32_bf16 a[224:227], v[252:255], v[164:167], a[224:227]
    s_waitcnt lgkmcnt(10)
    v_mfma_f32_16x16x32_bf16 a[0:3], v[168:171], v[156:159], a[0:3]
    v_mfma_f32_16x16x32_bf16 a[4:7], v[168:171], v[160:163], a[4:7]
    v_max3_f32 v36, v36, v123, v132
    v_mfma_f32_16x16x32_bf16 a[8:11], v[168:171], v[164:167], a[8:11]
    ds_read_b64_tr_b16 v[196:197], v29 offset:12416
    ds_read_b64_tr_b16 v[198:199], v29 offset:18560
    v_mfma_f32_16x16x32_bf16 a[12:15], v[172:175], v[156:159], a[12:15]
    v_max3_f32 v37, v37, v127, v136
    v_mfma_f32_16x16x32_bf16 a[16:19], v[172:175], v[160:163], a[16:19]
    v_mfma_f32_16x16x32_bf16 a[20:23], v[172:175], v[164:167], a[20:23]
    ds_read_b64_tr_b16 v[200:201], v26 offset:12544
    ds_read_b64_tr_b16 v[202:203], v26 offset:18688
    s_waitcnt lgkmcnt(10)
    v_mfma_f32_16x16x32_bf16 a[24:27], v[176:179], v[156:159], a[24:27]
    v_max3_f32 v38, v38, v131, v140
    v_mfma_f32_16x16x32_bf16 a[28:31], v[176:179], v[160:163], a[28:31]
    v_mfma_f32_16x16x32_bf16 a[32:35], v[176:179], v[164:167], a[32:35]
    v_max3_f32 v36, v36, v133, v134
    ds_read_b64_tr_b16 v[204:205], v27 offset:12544
    ds_read_b64_tr_b16 v[206:207], v27 offset:18688
    v_mfma_f32_16x16x32_bf16 a[36:39], v[180:183], v[156:159], a[36:39]
    v_mfma_f32_16x16x32_bf16 a[40:43], v[180:183], v[160:163], a[40:43]
    v_mfma_f32_16x16x32_bf16 a[44:47], v[180:183], v[164:167], a[44:47]
    v_max3_f32 v37, v37, v137, v138
    ds_read_b64_tr_b16 v[208:209], v28 offset:12544
    ds_read_b64_tr_b16 v[210:211], v28 offset:18688
    s_waitcnt lgkmcnt(10)
    v_mfma_f32_16x16x32_bf16 a[48:51], v[184:187], v[156:159], a[48:51]
    v_mfma_f32_16x16x32_bf16 a[52:55], v[184:187], v[160:163], a[52:55]
    v_max3_f32 v38, v38, v141, v142
    v_mfma_f32_16x16x32_bf16 a[56:59], v[184:187], v[164:167], a[56:59]
    ds_read_b64_tr_b16 v[212:213], v29 offset:12544
    ds_read_b64_tr_b16 v[214:215], v29 offset:18688
    v_mfma_f32_16x16x32_bf16 a[60:63], v[188:191], v[156:159], a[60:63]
    v_mfma_f32_16x16x32_bf16 a[64:67], v[188:191], v[160:163], a[64:67]
    v_max_f32 v36, v36, v135
    v_mfma_f32_16x16x32_bf16 a[68:71], v[188:191], v[164:167], a[68:71]
    s_waitcnt vmcnt(18)
    s_barrier
    v_add_u32 v24, s61, v14
    v_add_u32 v25, s61, v15
    ds_read_b128 v[168:171], v24 offset:0
    s_waitcnt lgkmcnt(9)
    v_mfma_f32_16x16x32_bf16 a[72:75], v[192:195], v[156:159], a[72:75]
    v_max_f32 v37, v37, v139
    v_mfma_f32_16x16x32_bf16 a[76:79], v[192:195], v[160:163], a[76:79]
    s_add_u32 m0, s65, s66
    s_add_u32 s67, s56, 98304
    buffer_load_dwordx4 v4, s[40:43], s67 offen offset:0 nt lds
    v_mfma_f32_16x16x32_bf16 a[80:83], v[192:195], v[164:167], a[80:83]
    ds_read_b128 v[172:175], v25 offset:0
    v_mfma_f32_16x16x32_bf16 a[84:87], v[196:199], v[156:159], a[84:87]
    v_max_f32 v38, v38, v143
    v_mfma_f32_16x16x32_bf16 a[88:91], v[196:199], v[160:163], a[88:91]
    v_mfma_f32_16x16x32_bf16 a[92:95], v[196:199], v[164:167], a[92:95]
    v_fma_f32 v39, v36, s70, -v30
    ds_read_b128 v[176:179], v24 offset:128
    s_waitcnt lgkmcnt(7)
    v_mfma_f32_16x16x32_bf16 a[96:99], v[200:203], v[156:159], a[96:99]
    buffer_load_dwordx4 v5, s[40:43], s67 offen offset:1024 nt lds
    v_mfma_f32_16x16x32_bf16 a[100:103], v[200:203], v[160:163], a[100:103]
    v_mfma_f32_16x16x32_bf16 a[104:107], v[200:203], v[164:167], a[104:107]
    v_fma_f32 v40, v37, s70, -v31
    ds_read_b128 v[180:183], v25 offset:128
    v_mfma_f32_16x16x32_bf16 a[108:111], v[204:207], v[156:159], a[108:111]
    v_mfma_f32_16x16x32_bf16 a[112:115], v[204:207], v[160:163], a[112:115]
    v_fma_f32 v41, v38, s70, -v32
    v_mfma_f32_16x16x32_bf16 a[116:119], v[204:207], v[164:167], a[116:119]
    buffer_load_dwordx4 v6, s[40:43], s67 offen offset:2048 nt lds
    ds_read_b128 v[184:187], v24 offset:256
    s_waitcnt lgkmcnt(5)
    v_mfma_f32_16x16x32_bf16 a[120:123], v[208:211], v[156:159], a[120:123]
    v_mfma_f32_16x16x32_bf16 a[124:127], v[208:211], v[160:163], a[124:127]
    v_max3_f32 v39, v39, v40, v41
    v_mfma_f32_16x16x32_bf16 a[128:131], v[208:211], v[164:167], a[128:131]
    ds_read_b128 v[188:191], v25 offset:256
    v_mfma_f32_16x16x32_bf16 a[132:135], v[212:215], v[156:159], a[132:135]
    v_cmp_lt_f32 s[78:79], s71, v39
    v_mfma_f32_16x16x32_bf16 a[136:139], v[212:215], v[160:163], a[136:139]
    s_add_u32 m0, m0, 3072
    s_add_u32 s67, s67, 3072
    buffer_load_dwordx4 v4, s[40:43], s67 offen offset:0 nt lds
    v_mfma_f32_16x16x32_bf16 a[140:143], v[212:215], v[164:167], a[140:143]
    s_cmp_lg_u64 s[78:79], 0
    s_cbranch_scc0 L1_skip0
    s_swappc_b64 s[72:73], s[74:75]
L1_skip0:
    ds_read_b128 v[192:195], v24 offset:6144
    s_waitcnt lgkmcnt(5)
    v_mfma_f32_16x16x32_bf16 v[48:51], v[168:171], a[144:147], 0
    v_fma_f32 v96, v96, s70, -v30
    v_fma_f32 v97, v97, s70, -v30
    v_mfma_f32_16x16x32_bf16 v[52:55], v[168:171], a[148:151], 0
    v_fma_f32 v98, v98, s70, -v30
    v_fma_f32 v99, v99, s70, -v30
    v_mfma_f32_16x16x32_bf16 v[56:59], v[168:171], a[152:155], 0
    v_exp_f32 v96, v96
    ds_read_b128 v[196:199], v25 offset:6144
    v_mfma_f32_16x16x32_bf16 v[48:51], v[172:175], a[156:159], v[48:51]
    buffer_load_dwordx4 v5, s[40:43], s67 offen offset:1024 nt lds
    v_exp_f32 v97, v97
    v_exp_f32 v98, v98
    v_mfma_f32_16x16x32_bf16 v[52:55], v[172:175], a[160:163], v[52:55]
    v_exp_f32 v99, v99
    v_fma_f32 v100, v100, s70, -v31
    v_mfma_f32_16x16x32_bf16 v[56:59], v[172:175], a[164:167], v[56:59]
    v_fma_f32 v101, v101, s70, -v31
    ds_read_b128 v[200:203], v24 offset:6272
    s_waitcnt lgkmcnt(5)
    v_mfma_f32_16x16x32_bf16 v[48:51], v[176:179], a[168:171], v[48:51]
    v_fma_f32 v102, v102, s70, -v31
    v_fma_f32 v103, v103, s70, -v31
    v_mfma_f32_16x16x32_bf16 v[52:55], v[176:179], a[172:175], v[52:55]
    v_exp_f32 v100, v100
    v_exp_f32 v101, v101
    v_mfma_f32_16x16x32_bf16 v[56:59], v[176:179], a[176:179], v[56:59]
    buffer_load_dwordx4 v6, s[40:43], s67 offen offset:2048 nt lds
    v_exp_f32 v102, v102
    ds_read_b128 v[204:207], v25 offset:6272
    v_mfma_f32_16x16x32_bf16 v[48:51], v[180:183], a[180:183], v[48:51]
    v_exp_f32 v103, v103
    v_fma_f32 v104, v104, s70, -v32
    v_mfma_f32_16x16x32_bf16 v[52:55], v[180:183], a[184:187], v[52:55]
    v_fma_f32 v105, v105, s70, -v32
    v_fma_f32 v106, v106, s70, -v32
    v_mfma_f32_16x16x32_bf16 v[56:59], v[180:183], a[188:191], v[56:59]
    v_fma_f32 v107, v107, s70, -v32
    ds_read_b128 v[208:211], v24 offset:6400
    s_waitcnt lgkmcnt(5)
    v_mfma_f32_16x16x32_bf16 v[48:51], v[184:187], a[192:195], v[48:51]
    v_exp_f32 v104, v104
    v_exp_f32 v105, v105
    v_mfma_f32_16x16x32_bf16 v[52:55], v[184:187], a[196:199], v[52:55]
    v_exp_f32 v106, v106
    v_exp_f32 v107, v107
    v_mfma_f32_16x16x32_bf16 v[56:59], v[184:187], a[200:203], v[56:59]
    v_fma_f32 v108, v108, s70, -v30
    ds_read_b128 v[212:215], v25 offset:6400
    v_mfma_f32_16x16x32_bf16 v[48:51], v[188:191], a[204:207], v[48:51]
    v_fma_f32 v109, v109, s70, -v30
    v_fma_f32 v110, v110, s70, -v30
    v_mfma_f32_16x16x32_bf16 v[52:55], v[188:191], a[208:211], v[52:55]
    v_fma_f32 v111, v111, s70, -v30
    v_exp_f32 v108, v108
    v_mfma_f32_16x16x32_bf16 v[56:59], v[188:191], a[212:215], v[56:59]
    v_exp_f32 v109, v109
    ds_read_b128 v[168:171], v24 offset:12288
    s_waitcnt lgkmcnt(5)
    v_mfma_f32_16x16x32_bf16 v[60:63], v[192:195], a[144:147], 0
    v_exp_f32 v110, v110
    v_exp_f32 v111, v111
    v_mfma_f32_16x16x32_bf16 v[64:67], v[192:195], a[148:151], 0
    v_fma_f32 v112, v112, s70, -v31
    v_fma_f32 v113, v113, s70, -v31
    v_mfma_f32_16x16x32_bf16 v[68:71], v[192:195], a[152:155], 0
    v_fma_f32 v114, v114, s70, -v31
    ds_read_b128 v[172:175], v25 offset:12288
    v_mfma_f32_16x16x32_bf16 v[60:63], v[196:199], a[156:159], v[60:63]
    v_fma_f32 v115, v115, s70, -v31
    v_exp_f32 v112, v112
    v_mfma_f32_16x16x32_bf16 v[64:67], v[196:199], a[160:163], v[64:67]
    v_exp_f32 v113, v113
    v_exp_f32 v114, v114
    v_mfma_f32_16x16x32_bf16 v[68:71], v[196:199], a[164:167], v[68:71]
    v_exp_f32 v115, v115
    ds_read_b128 v[176:179], v24 offset:12416
    s_waitcnt lgkmcnt(5)
    v_mfma_f32_16x16x32_bf16 v[60:63], v[200:203], a[168:171], v[60:63]
    v_fma_f32 v116, v116, s70, -v32
    v_fma_f32 v117, v117, s70, -v32
    v_mfma_f32_16x16x32_bf16 v[64:67], v[200:203], a[172:175], v[64:67]
    v_fma_f32 v118, v118, s70, -v32
    v_fma_f32 v119, v119, s70, -v32
    v_mfma_f32_16x16x32_bf16 v[68:71], v[200:203], a[176:179], v[68:71]
    v_exp_f32 v116, v116
    ds_read_b128 v[180:183], v25 offset:12416
    v_mfma_f32_16x16x32_bf16 v[60:63], v[204:207], a[180:183], v[60:63]
    v_exp_f32 v117, v117
    v_exp_f32 v118, v118
    v_mfma_f32_16x16x32_bf16 v[64:67], v[204:207], a[184:187], v[64:67]
    v_exp_f32 v119, v119
    v_cvt_pk_bf16_f32 v144, v96, v97
    v_mfma_f32_16x16x32_bf16 v[68:71], v[204:207], a[188:191], v[68:71]
    v_cvt_pk_bf16_f32 v145, v98, v99
    ds_read_b128 v[184:187], v24 offset:12544
    s_waitcnt lgkmcnt(5)
    v_mfma_f32_16x16x32_bf16 v[60:63], v[208:211], a[192:195], v[60:63]
    v_cvt_pk_bf16_f32 v148, v100, v101
    v_cvt_pk_bf16_f32 v149, v102, v103
    v_mfma_f32_16x16x32_bf16 v[64:67], v[208:211], a[196:199], v[64:67]
    v_cvt_pk_bf16_f32 v152, v104, v105
    v_cvt_pk_bf16_f32 v153, v106, v107
    v_mfma_f32_16x16x32_bf16 v[68:71], v[208:211], a[200:203], v[68:71]
    v_fma_f32 v120, v120, s70, -v30
    ds_read_b128 v[188:191], v25 offset:12544
    v_mfma_f32_16x16x32_bf16 v[60:63], v[212:215], a[204:207], v[60:63]
    v_fma_f32 v121, v121, s70, -v30
    v_fma_f32 v122, v122, s70, -v30
    v_mfma_f32_16x16x32_bf16 v[64:67], v[212:215], a[208:211], v[64:67]
    v_fma_f32 v123, v123, s70, -v30
    v_exp_f32 v120, v120
    v_mfma_f32_16x16x32_bf16 v[68:71], v[212:215], a[212:215], v[68:71]
    v_exp_f32 v121, v121
    ds_read_b128 v[192:195], v24 offset:18432
    s_waitcnt lgkmcnt(5)
    v_mfma_f32_16x16x32_bf16 v[72:75], v[168:171], a[144:147], 0
    v_exp_f32 v122, v122
    v_exp_f32 v123, v123
    v_mfma_f32_16x16x32_bf16 v[76:79], v[168:171], a[148:151], 0
    v_fma_f32 v124, v124, s70, -v31
    v_fma_f32 v125, v125, s70, -v31
    v_mfma_f32_16x16x32_bf16 v[80:83], v[168:171], a[152:155], 0
    v_fma_f32 v126, v126, s70, -v31
    ds_read_b128 v[196:199], v25 offset:18432
    v_mfma_f32_16x16x32_bf16 v[72:75], v[172:175], a[156:159], v[72:75]
    v_fma_f32 v127, v127, s70, -v31
    v_exp_f32 v124, v124
    v_mfma_f32_16x16x32_bf16 v[76:79], v[172:175], a[160:163], v[76:79]
    v_exp_f32 v125, v125
    v_exp_f32 v126, v126
    v_mfma_f32_16x16x32_bf16 v[80:83], v[172:175], a[164:167], v[80:83]
    v_exp_f32 v127, v127
    ds_read_b128 v[200:203], v24 offset:18560
    s_waitcnt lgkmcnt(5)
    v_mfma_f32_16x16x32_bf16 v[72:75], v[176:179], a[168:171], v[72:75]
    v_fma_f32 v128, v128, s70, -v32
    v_fma_f32 v129, v129, s70, -v32
    v_mfma_f32_16x16x32_bf16 v[76:79], v[176:179], a[172:175], v[76:79]
    v_fma_f32 v130, v130, s70, -v32
    v_fma_f32 v131, v131, s70, -v32
    v_mfma_f32_16x16x32_bf16 v[80:83], v[176:179], a[176:179], v[80:83]
    v_exp_f32 v128, v128
    ds_read_b128 v[204:207], v25 offset:18560
    v_mfma_f32_16x16x32_bf16 v[72:75], v[180:183], a[180:183], v[72:75]
    v_exp_f32 v129, v129
    v_exp_f32 v130, v130
    v_mfma_f32_16x16x32_bf16 v[76:79], v[180:183], a[184:187], v[76:79]
    v_exp_f32 v131, v131
    v_cvt_pk_bf16_f32 v146, v108, v109
    v_mfma_f32_16x16x32_bf16 v[80:83], v[180:183], a[188:191], v[80:83]
    v_cvt_pk_bf16_f32 v147, v110, v111
    ds_read_b128 v[208:211], v24 offset:18688
    s_waitcnt lgkmcnt(5)
    v_mfma_f32_16x16x32_bf16 v[72:75], v[184:187], a[192:195], v[72:75]
    v_cvt_pk_bf16_f32 v150, v112, v113
    v_cvt_pk_bf16_f32 v151, v114, v115
    v_mfma_f32_16x16x32_bf16 v[76:79], v[184:187], a[196:199], v[76:79]
    v_cvt_pk_bf16_f32 v154, v116, v117
    v_cvt_pk_bf16_f32 v155, v118, v119
    v_mfma_f32_16x16x32_bf16 v[80:83], v[184:187], a[200:203], v[80:83]
    v_fma_f32 v132, v132, s70, -v30
    ds_read_b128 v[212:215], v25 offset:18688
    v_mfma_f32_16x16x32_bf16 v[72:75], v[188:191], a[204:207], v[72:75]
    v_fma_f32 v133, v133, s70, -v30
    v_fma_f32 v134, v134, s70, -v30
    v_mfma_f32_16x16x32_bf16 v[76:79], v[188:191], a[208:211], v[76:79]
    v_fma_f32 v135, v135, s70, -v30
    v_exp_f32 v132, v132
    v_mfma_f32_16x16x32_bf16 v[80:83], v[188:191], a[212:215], v[80:83]
    v_exp_f32 v133, v133
    s_waitcnt vmcnt(18)
    s_barrier
    v_add_u32 v26, s62, v16
    v_add_u32 v27, s62, v17
    v_add_u32 v28, s62, v18
    v_add_u32 v29, s62, v19
    ds_read_b64_tr_b16 v[168:169], v26 offset:0
    ds_read_b64_tr_b16 v[170:171], v26 offset:6144
    s_waitcnt lgkmcnt(6)
    v_mfma_f32_16x16x32_bf16 v[84:87], v[192:195], a[144:147], 0
    v_exp_f32 v134, v134
    v_exp_f32 v135, v135
    v_mfma_f32_16x16x32_bf16 v[88:91], v[192:195], a[148:151], 0
    v_fma_f32 v136, v136, s70, -v31
    v_fma_f32 v137, v137, s70, -v31
    v_mfma_f32_16x16x32_bf16 v[92:95], v[192:195], a[152:155], 0
    v_fma_f32 v138, v138, s70, -v31
    ds_read_b64_tr_b16 v[172:173], v27 offset:0
    ds_read_b64_tr_b16 v[174:175], v27 offset:6144
    v_mfma_f32_16x16x32_bf16 v[84:87], v[196:199], a[156:159], v[84:87]
    v_fma_f32 v139, v139, s70, -v31
    v_exp_f32 v136, v136
    v_mfma_f32_16x16x32_bf16 v[88:91], v[196:199], a[160:163], v[88:91]
    s_add_u32 m0, s60, s66
    s_add_u32 s67, s56, 73728
    buffer_load_dwordx4 v4, s[44:47], s67 offen offset:0 nt lds
    v_exp_f32 v137, v137
    v_exp_f32 v138, v138
    v_mfma_f32_16x16x32_bf16 v[92:95], v[196:199], a[164:167], v[92:95]
    v_exp_f32 v139, v139
    ds_read_b64_tr_b16 v[176:177], v28 offset:0
    ds_read_b64_tr_b16 v[178:179], v28 offset:6144
    s_waitcnt lgkmcnt(8)
    v_mfma_f32_16x16x32_bf16 v[84:87], v[200:203], a[168:171], v[84:87]
    v_fma_f32 v140, v140, s70, -v32
    v_fma_f32 v141, v141, s70, -v32
    v_mfma_f32_16x16x32_bf16 v[88:91], v[200:203], a[172:175], v[88:91]
    v_fma_f32 v142, v142, s70, -v32
    v_fma_f32 v143, v143, s70, -v32
    v_mfma_f32_16x16x32_bf16 v[92:95], v[200:203], a[176:179], v[92:95]
    v_exp_f32 v140, v140
    ds_read_b64_tr_b16 v[180:181], v29 offset:0
    ds_read_b64_tr_b16 v[182:183], v29 offset:6144
    v_mfma_f32_16x16x32_bf16 v[84:87], v[204:207], a[180:183], v[84:87]
    buffer_load_dwordx4 v5, s[44:47], s67 offen offset:1024 nt lds
    v_exp_f32 v141, v141
    v_exp_f32 v142, v142
    v_mfma_f32_16x16x32_bf16 v[88:91], v[204:207], a[184:187], v[88:91]
    v_exp_f32 v143, v143
    v_cvt_pk_bf16_f32 v156, v120, v121
    v_mfma_f32_16x16x32_bf16 v[92:95], v[204:207], a[188:191], v[92:95]
    v_cvt_pk_bf16_f32 v157, v122, v123
    ds_read_b64_tr_b16 v[184:185], v26 offset:128
    ds_read_b64_tr_b16 v[186:187], v26 offset:6272
    s_waitcnt lgkmcnt(10)
    v_mfma_f32_16x16x32_bf16 v[84:87], v[208:211], a[192:195], v[84:87]
    v_cvt_pk_bf16_f32 v160, v124, v125
    v_cvt_pk_bf16_f32 v161, v126, v127
    v_mfma_f32_16x16x32_bf16 v[88:91], v[208:211], a[196:199], v[88:91]
    v_cvt_pk_bf16_f32 v164, v128, v129
    v_cvt_pk_bf16_f32 v165, v130, v131
    v_mfma_f32_16x16x32_bf16 v[92:95], v[208:211], a[200:203], v[92:95]
    buffer_load_dwordx4 v6, s[44:47], s67 offen offset:2048 nt lds
    v_cvt_pk_bf16_f32 v158, v132, v133
    ds_read_b64_tr_b16 v[188:189], v27 offset:128
    ds_read_b64_tr_b16 v[190:191], v27 offset:6272
    v_mfma_f32_16x16x32_bf16 v[84:87], v[212:215], a[204:207], v[84:87]
    v_cvt_pk_bf16_f32 v159, v134, v135
    v_cvt_pk_bf16_f32 v162, v136, v137
    v_mfma_f32_16x16x32_bf16 v[88:91], v[212:215], a[208:211], v[88:91]
    v_cvt_pk_bf16_f32 v163, v138, v139
    v_cvt_pk_bf16_f32 v166, v140, v141
    v_mfma_f32_16x16x32_bf16 v[92:95], v[212:215], a[212:215], v[92:95]
    v_cvt_pk_bf16_f32 v167, v142, v143
    ds_read_b64_tr_b16 v[192:193], v28 offset:128
    ds_read_b64_tr_b16 v[194:195], v28 offset:6272
    v_mfma_f32_16x16x32_bf16 a[216:219], v[252:255], v[144:147], a[216:219]
    v_mfma_f32_16x16x32_bf16 a[220:223], v[252:255], v[148:151], a[220:223]
    v_mfma_f32_16x16x32_bf16 a[224:227], v[252:255], v[152:155], a[224:227]
    s_waitcnt lgkmcnt(10)
    v_mfma_f32_16x16x32_bf16 a[0:3], v[168:171], v[144:147], a[0:3]
    v_max3_f32 v36, v48, v49, v50
    v_mfma_f32_16x16x32_bf16 a[4:7], v[168:171], v[148:151], a[4:7]
    s_add_u32 m0, m0, 3072
    s_add_u32 s67, s67, 3072
    buffer_load_dwordx4 v4, s[44:47], s67 offen offset:0 nt lds
    v_mfma_f32_16x16x32_bf16 a[8:11], v[168:171], v[152:155], a[8:11]
    v_max3_f32 v37, v52, v53, v54
    ds_read_b64_tr_b16 v[196:197], v29 offset:128
    ds_read_b64_tr_b16 v[198:199], v29 offset:6272
    v_mfma_f32_16x16x32_bf16 a[12:15], v[172:175], v[144:147], a[12:15]
    v_mfma_f32_16x16x32_bf16 a[16:19], v[172:175], v[148:151], a[16:19]
    v_max3_f32 v38, v56, v57, v58
    v_mfma_f32_16x16x32_bf16 a[20:23], v[172:175], v[152:155], a[20:23]
    ds_read_b64_tr_b16 v[200:201], v26 offset:256
    ds_read_b64_tr_b16 v[202:203], v26 offset:6400
    s_waitcnt lgkmcnt(10)
    v_mfma_f32_16x16x32_bf16 a[24:27], v[176:179], v[144:147], a[24:27]
    buffer_load_dwordx4 v5, s[44:47], s67 offen offset:1024 nt lds
    v_mfma_f32_16x16x32_bf16 a[28:31], v[176:179], v[148:151], a[28:31]
    v_max3_f32 v36, v36, v51, v60
    v_mfma_f32_16x16x32_bf16 a[32:35], v[176:179], v[152:155], a[32:35]
    ds_read_b64_tr_b16 v[204:205], v27 offset:256
    ds_read_b64_tr_b16 v[206:207], v27 offset:6400
    v_mfma_f32_16x16x32_bf16 a[36:39], v[180:183], v[144:147], a[36:39]
    v_max3_f32 v37, v37, v55, v64
    v_mfma_f32_16x16x32_bf16 a[40:43], v[180:183], v[148:151], a[40:43]
    v_mfma_f32_16x16x32_bf16 a[44:47], v[180:183], v[152:155], a[44:47]
    buffer_load_dwordx4 v6, s[44:47], s67 offen offset:2048 nt lds
    ds_read_b64_tr_b16 v[208:209], v28 offset:256
    ds_read_b64_tr_b16 v[210:211], v28 offset:6400
    s_waitcnt lgkmcnt(10)
    v_mfma_f32_16x16x32_bf16 a[48:51], v[184:187], v[144:147], a[48:51]
    v_max3_f32 v38, v38, v59, v68
    v_mfma_f32_16x16x32_bf16 a[52:55], v[184:187], v[148:151], a[52:55]
    v_mfma_f32_16x16x32_bf16 a[56:59], v[184:187], v[152:155], a[56:59]
    v_max3_f32 v36, v36, v61, v62
    ds_read_b64_tr_b16 v[212:213], v29 offset:256
    ds_read_b64_tr_b16 v[214:215], v29 offset:6400
    v_mfma_f32_16x16x32_bf16 a[60:63], v[188:191], v[144:147], a[60:63]
    v_mfma_f32_16x16x32_bf16 a[64:67], v[188:191], v[148:151], a[64:67]
    v_mfma_f32_16x16x32_bf16 a[68:71], v[188:191], v[152:155], a[68:71]
    v_max3_f32 v37, v37, v65, v66
    ds_read_b64_tr_b16 v[168:169], v26 offset:12288
    ds_read_b64_tr_b16 v[170:171], v26 offset:18432
    s_waitcnt lgkmcnt(10)
    v_mfma_f32_16x16x32_bf16 a[72:75], v[192:195], v[144:147], a[72:75]
    v_mfma_f32_16x16x32_bf16 a[76:79], v[192:195], v[148:151], a[76:79]
    v_max3_f32 v38, v38, v69, v70
    v_mfma_f32_16x16x32_bf16 a[80:83], v[192:195], v[152:155], a[80:83]
    ds_read_b64_tr_b16 v[172:173], v27 offset:12288
    ds_read_b64_tr_b16 v[174:175], v27 offset:18432
    v_mfma_f32_16x16x32_bf16 a[84:87], v[196:199], v[144:147], a[84:87]
    v_mfma_f32_16x16x32_bf16 a[88:91], v[196:199], v[148:151], a[88:91]
    v_max3_f32 v36, v36, v63, v72
    v_mfma_f32_16x16x32_bf16 a[92:95], v[196:199], v[152:155], a[92:95]
    ds_read_b64_tr_b16 v[176:177], v28 offset:12288
    ds_read_b64_tr_b16 v[178:179], v28 offset:18432
    s_waitcnt lgkmcnt(10)
    v_mfma_f32_16x16x32_bf16 a[96:99], v[200:203], v[144:147], a[96:99]
    v_max3_f32 v37, v37, v67, v76
    v_mfma_f32_16x16x32_bf16 a[100:103], v[200:203], v[148:151], a[100:103]
    v_mfma_f32_16x16x32_bf16 a[104:107], v[200:203], v[152:155], a[104:107]
    ds_read_b64_tr_b16 v[180:181], v29 offset:12288
    ds_read_b64_tr_b16 v[182:183], v29 offset:18432
    v_mfma_f32_16x16x32_bf16 a[108:111], v[204:207], v[144:147], a[108:111]
    v_max3_f32 v38, v38, v71, v80
    v_mfma_f32_16x16x32_bf16 a[112:115], v[204:207], v[148:151], a[112:115]
    v_mfma_f32_16x16x32_bf16 a[116:119], v[204:207], v[152:155], a[116:119]
    v_max3_f32 v36, v36, v73, v74
    ds_read_b64_tr_b16 v[184:185], v26 offset:12416
    ds_read_b64_tr_b16 v[186:187], v26 offset:18560
    s_waitcnt lgkmcnt(10)
    v_mfma_f32_16x16x32_bf16 a[120:123], v[208:211], v[144:147], a[120:123]
    v_mfma_f32_16x16x32_bf16 a[124:127], v[208:211], v[148:151], a[124:127]
    v_mfma_f32_16x16x32_bf16 a[128:131], v[208:211], v[152:155], a[128:131]
    v_max3_f32 v37, v37, v77, v78
    ds_read_b64_tr_b16 v[188:189], v27 offset:12416
    ds_read_b64_tr_b16 v[190:191], v27 offset:18560
    v_mfma_f32_16x16x32_bf16 a[132:135], v[212:215], v[144:147], a[132:135]
    v_mfma_f32_16x16x32_bf16 a[136:139], v[212:215], v[148:151], a[136:139]
    v_max3_f32 v38, v38, v81, v82
    v_mfma_f32_16x16x32_bf16 a[140:143], v[212:215], v[152:155], a[140:143]
    ds_read_b64_tr_b16 v[192:193], v28 offset:12416
    ds_read_b64_tr_b16 v[194:195], v28 offset:18560
    v_mfma_f32_16x16x32_bf16 a[216:219], v[252:255], v[156:159], a[216:219]
    v_mfma_f32_16x16x32_bf16 a[220:223], v[252:255], v[160:163], a[220:223]
    v_mfma_f32_16x16x32_bf16 a[224:227], v[252:255], v[164:167], a[224:227]
    s_waitcnt lgkmcnt(10)
    v_mfma_f32_16x16x32_bf16 a[0:3], v[168:171], v[156:159], a[0:3]
    v_mfma_f32_16x16x32_bf16 a[4:7], v[168:171], v[160:163], a[4:7]
    v_max3_f32 v36, v36, v75, v84
    v_mfma_f32_16x16x32_bf16 a[8:11], v[168:171], v[164:167], a[8:11]
    ds_read_b64_tr_b16 v[196:197], v29 offset:12416
    ds_read_b64_tr_b16 v[198:199], v29 offset:18560
    v_mfma_f32_16x16x32_bf16 a[12:15], v[172:175], v[156:159], a[12:15]
    v_max3_f32 v37, v37, v79, v88
    v_mfma_f32_16x16x32_bf16 a[16:19], v[172:175], v[160:163], a[16:19]
    v_mfma_f32_16x16x32_bf16 a[20:23], v[172:175], v[164:167], a[20:23]
    ds_read_b64_tr_b16 v[200:201], v26 offset:12544
    ds_read_b64_tr_b16 v[202:203], v26 offset:18688
    s_waitcnt lgkmcnt(10)
    v_mfma_f32_16x16x32_bf16 a[24:27], v[176:179], v[156:159], a[24:27]
    v_max3_f32 v38, v38, v83, v92
    v_mfma_f32_16x16x32_bf16 a[28:31], v[176:179], v[160:163], a[28:31]
    v_mfma_f32_16x16x32_bf16 a[32:35], v[176:179], v[164:167], a[32:35]
    v_max3_f32 v36, v36, v85, v86
    ds_read_b64_tr_b16 v[204:205], v27 offset:12544
    ds_read_b64_tr_b16 v[206:207], v27 offset:18688
    v_mfma_f32_16x16x32_bf16 a[36:39], v[180:183], v[156:159], a[36:39]
    v_mfma_f32_16x16x32_bf16 a[40:43], v[180:183], v[160:163], a[40:43]
    v_mfma_f32_16x16x32_bf16 a[44:47], v[180:183], v[164:167], a[44:47]
    v_max3_f32 v37, v37, v89, v90
    ds_read_b64_tr_b16 v[208:209], v28 offset:12544
    ds_read_b64_tr_b16 v[210:211], v28 offset:18688
    s_waitcnt lgkmcnt(10)
    v_mfma_f32_16x16x32_bf16 a[48:51], v[184:187], v[156:159], a[48:51]
    v_mfma_f32_16x16x32_bf16 a[52:55], v[184:187], v[160:163], a[52:55]
    v_max3_f32 v38, v38, v93, v94
    v_mfma_f32_16x16x32_bf16 a[56:59], v[184:187], v[164:167], a[56:59]
    ds_read_b64_tr_b16 v[212:213], v29 offset:12544
    ds_read_b64_tr_b16 v[214:215], v29 offset:18688
    v_mfma_f32_16x16x32_bf16 a[60:63], v[188:191], v[156:159], a[60:63]
    v_mfma_f32_16x16x32_bf16 a[64:67], v[188:191], v[160:163], a[64:67]
    v_max_f32 v36, v36, v87
    v_mfma_f32_16x16x32_bf16 a[68:71], v[188:191], v[164:167], a[68:71]
    s_waitcnt vmcnt(18)
    s_barrier
    v_add_u32 v24, s63, v14
    v_add_u32 v25, s63, v15
    ds_read_b128 v[168:171], v24 offset:0
    s_waitcnt lgkmcnt(9)
    v_mfma_f32_16x16x32_bf16 a[72:75], v[192:195], v[156:159], a[72:75]
    v_max_f32 v37, v37, v91
    v_mfma_f32_16x16x32_bf16 a[76:79], v[192:195], v[160:163], a[76:79]
    v_mfma_f32_16x16x32_bf16 a[80:83], v[192:195], v[164:167], a[80:83]
    s_add_u32 m0, s61, s66
    s_add_u32 s67, s56, 122880
    buffer_load_dwordx4 v4, s[40:43], s67 offen offset:0 nt lds
    ds_read_b128 v[172:175], v25 offset:0
    v_mfma_f32_16x16x32_bf16 a[84:87], v[196:199], v[156:159], a[84:87]
    v_max_f32 v38, v38, v95
    v_mfma_f32_16x16x32_bf16 a[88:91], v[196:199], v[160:163], a[88:91]
    v_mfma_f32_16x16x32_bf16 a[92:95], v[196:199], v[164:167], a[92:95]
    v_fma_f32 v39, v36, s70, -v30
    ds_read_b128 v[176:179], v24 offset:128
    s_waitcnt lgkmcnt(7)
    v_mfma_f32_16x16x32_bf16 a[96:99], v[200:203], v[156:159], a[96:99]
    v_mfma_f32_16x16x32_bf16 a[100:103], v[200:203], v[160:163], a[100:103]
    buffer_load_dwordx4 v5, s[40:43], s67 offen offset:1024 nt lds
    v_mfma_f32_16x16x32_bf16 a[104:107], v[200:203], v[164:167], a[104:107]
    v_fma_f32 v40, v37, s70, -v31
    ds_read_b128 v[180:183], v25 offset:128
    v_mfma_f32_16x16x32_bf16 a[108:111], v[204:207], v[156:159], a[108:111]
    v_mfma_f32_16x16x32_bf16 a[112:115], v[204:207], v[160:163], a[112:115]
    v_fma_f32 v41, v38, s70, -v32
    v_mfma_f32_16x16x32_bf16 a[116:119], v[204:207], v[164:167], a[116:119]
    ds_read_b128 v[184:187], v24 offset:256
    s_waitcnt lgkmcnt(5)
    v_mfma_f32_16x16x32_bf16 a[120:123], v[208:211], v[156:159], a[120:123]
    buffer_load_dwordx4 v6, s[40:43], s67 offen offset:2048 nt lds
    v_mfma_f32_16x16x32_bf16 a[124:127], v[208:211], v[160:163], a[124:127]
    v_max3_f32 v39, v39, v40, v41
    v_mfma_f32_16x16x32_bf16 a[128:131], v[208:211], v[164:167], a[128:131]
    ds_read_b128 v[188:191], v25 offset:256
    v_mfma_f32_16x16x32_bf16 a[132:135], v[212:215], v[156:159], a[132:135]
    v_cmp_lt_f32 s[78:79], s71, v39
    v_mfma_f32_16x16x32_bf16 a[136:139], v[212:215], v[160:163], a[136:139]
    v_mfma_f32_16x16x32_bf16 a[140:143], v[212:215], v[164:167], a[140:143]
    s_add_u32 m0, m0, 3072
    s_add_u32 s67, s67, 3072
    buffer_load_dwordx4 v4, s[40:43], s67 offen offset:0 nt lds
    s_cmp_lg_u64 s[78:79], 0
    s_cbranch_scc0 L1_skip1
    s_swappc_b64 s[72:73], s[74:75]
L1_skip1:
    ds_read_b128 v[192:195], v24 offset:6144
    s_waitcnt lgkmcnt(5)
    v_mfma_f32_16x16x32_bf16 v[96:99], v[168:171], a[144:147], 0
    v_fma_f32 v48, v48, s70, -v30
    v_fma_f32 v49, v49, s70, -v30
    v_mfma_f32_16x16x32_bf16 v[100:103], v[168:171], a[148:151], 0
    v_fma_f32 v50, v50, s70, -v30
    v_fma_f32 v51, v51, s70, -v30
    v_mfma_f32_16x16x32_bf16 v[104:107], v[168:171], a[152:155], 0
    v_exp_f32 v48, v48
    ds_read_b128 v[196:199], v25 offset:6144
    v_mfma_f32_16x16x32_bf16 v[96:99], v[172:175], a[156:159], v[96:99]
    v_exp_f32 v49, v49
    v_exp_f32 v50, v50
    v_mfma_f32_16x16x32_bf16 v[100:103], v[172:175], a[160:163], v[100:103]
    buffer_load_dwordx4 v5, s[40:43], s67 offen offset:1024 nt lds
    v_exp_f32 v51, v51
    v_fma_f32 v52, v52, s70, -v31
    v_mfma_f32_16x16x32_bf16 v[104:107], v[172:175], a[164:167], v[104:107]
    v_fma_f32 v53, v53, s70, -v31
    ds_read_b128 v[200:203], v24 offset:6272
    s_waitcnt lgkmcnt(5)
    v_mfma_f32_16x16x32_bf16 v[96:99], v[176:179], a[168:171], v[96:99]
    v_fma_f32 v54, v54, s70, -v31
    v_fma_f32 v55, v55, s70, -v31
    v_mfma_f32_16x16x32_bf16 v[100:103], v[176:179], a[172:175], v[100:103]
    v_exp_f32 v52, v52
    v_exp_f32 v53, v53
    v_mfma_f32_16x16x32_bf16 v[104:107], v[176:179], a[176:179], v[104:107]
    v_exp_f32 v54, v54
    ds_read_b128 v[204:207], v25 offset:6272
    v_mfma_f32_16x16x32_bf16 v[96:99], v[180:183], a[180:183], v[96:99]
    buffer_load_dwordx4 v6, s[40:43], s67 offen offset:2048 nt lds
    v_exp_f32 v55, v55
    v_fma_f32 v56, v56, s70, -v32
    v_mfma_f32_16x16x32_bf16 v[100:103], v[180:183], a[184:187], v[100:103]
    v_fma_f32 v57, v57, s70, -v32
    v_fma_f32 v58, v58, s70, -v32
    v_mfma_f32_16x16x32_bf16 v[104:107], v[180:183], a[188:191], v[104:107]
    v_fma_f32 v59, v59, s70, -v32
    ds_read_b128 v[208:211], v24 offset:6400
    s_waitcnt lgkmcnt(5)
    v_mfma_f32_16x16x32_bf16 v[96:99], v[184:187], a[192:195], v[96:99]
    v_exp_f32 v56, v56
    v_exp_f32 v57, v57
    v_mfma_f32_16x16x32_bf16 v[100:103], v[184:187], a[196:199], v[100:103]
    v_exp_f32 v58, v58
    v_exp_f32 v59, v59
    v_mfma_f32_16x16x32_bf16 v[104:107], v[184:187], a[200:203], v[104:107]
    v_fma_f32 v60, v60, s70, -v30
    ds_read_b128 v[212:215], v25 offset:6400
    v_mfma_f32_16x16x32_bf16 v[96:99], v[188:191], a[204:207], v[96:99]
    v_fma_f32 v61, v61, s70, -v30
    v_fma_f32 v62, v62, s70, -v30
    v_mfma_f32_16x16x32_bf16 v[100:103], v[188:191], a[208:211], v[100:103]
    v_fma_f32 v63, v63, s70, -v30
    v_exp_f32 v60, v60
    v_mfma_f32_16x16x32_bf16 v[104:107], v[188:191], a[212:215], v[104:107]
    v_exp_f32 v61, v61
    ds_read_b128 v[168:171], v24 offset:12288
    s_waitcnt lgkmcnt(5)
    v_mfma_f32_16x16x32_bf16 v[108:111], v[192:195], a[144:147], 0
    v_exp_f32 v62, v62
    v_exp_f32 v63, v63
    v_mfma_f32_16x16x32_bf16 v[112:115], v[192:195], a[148:151], 0
    v_fma_f32 v64, v64, s70, -v31
    v_fma_f32 v65, v65, s70, -v31
    v_mfma_f32_16x16x32_bf16 v[116:119], v[192:195], a[152:155], 0
    v_fma_f32 v66, v66, s70, -v31
    ds_read_b128 v[172:175], v25 offset:12288
    v_mfma_f32_16x16x32_bf16 v[108:111], v[196:199], a[156:159], v[108:111]
    v_fma_f32 v67, v67, s70, -v31
    v_exp_f32 v64, v64
    v_mfma_f32_16x16x32_bf16 v[112:115], v[196:199], a[160:163], v[112:115]
    v_exp_f32 v65, v65
    v_exp_f32 v66, v66
    v_mfma_f32_16x16x32_bf16 v[116:119], v[196:199], a[164:167], v[116:119]
    v_exp_f32 v67, v67
    ds_read_b128 v[176:179], v24 offset:12416
    s_waitcnt lgkmcnt(5)
    v_mfma_f32_16x16x32_bf16 v[108:111], v[200:203], a[168:171], v[108:111]
    v_fma_f32 v68, v68, s70, -v32
    v_fma_f32 v69, v69, s70, -v32
    v_mfma_f32_16x16x32_bf16 v[112:115], v[200:203], a[172:175], v[112:115]
    v_fma_f32 v70, v70, s70, -v32
    v_fma_f32 v71, v71, s70, -v32
    v_mfma_f32_16x16x32_bf16 v[116:119], v[200:203], a[176:179], v[116:119]
    v_exp_f32 v68, v68
    ds_read_b128 v[180:183], v25 offset:12416
    v_mfma_f32_16x16x32_bf16 v[108:111], v[204:207], a[180:183], v[108:111]
    v_exp_f32 v69, v69
    v_exp_f32 v70, v70
    v_mfma_f32_16x16x32_bf16 v[112:115], v[204:207], a[184:187], v[112:115]
    v_exp_f32 v71, v71
    v_cvt_pk_bf16_f32 v144, v48, v49
    v_mfma_f32_16x16x32_bf16 v[116:119], v[204:207], a[188:191], v[116:119]
    v_cvt_pk_bf16_f32 v145, v50, v51
    ds_read_b128 v[184:187], v24 offset:12544
    s_waitcnt lgkmcnt(5)
    v_mfma_f32_16x16x32_bf16 v[108:111], v[208:211], a[192:195], v[108:111]
    v_cvt_pk_bf16_f32 v148, v52, v53
    v_cvt_pk_bf16_f32 v149, v54, v55
    v_mfma_f32_16x16x32_bf16 v[112:115], v[208:211], a[196:199], v[112:115]
    v_cvt_pk_bf16_f32 v152, v56, v57
    v_cvt_pk_bf16_f32 v153, v58, v59
    v_mfma_f32_16x16x32_bf16 v[116:119], v[208:211], a[200:203], v[116:119]
    v_fma_f32 v72, v72, s70, -v30
    ds_read_b128 v[188:191], v25 offset:12544
    v_mfma_f32_16x16x32_bf16 v[108:111], v[212:215], a[204:207], v[108:111]
    v_fma_f32 v73, v73, s70, -v30
    v_fma_f32 v74, v74, s70, -v30
    v_mfma_f32_16x16x32_bf16 v[112:115], v[212:215], a[208:211], v[112:115]
    v_fma_f32 v75, v75, s70, -v30
    v_exp_f32 v72, v72
    v_mfma_f32_16x16x32_bf16 v[116:119], v[212:215], a[212:215], v[116:119]
    v_exp_f32 v73, v73
    ds_read_b128 v[192:195], v24 offset:18432
    s_waitcnt lgkmcnt(5)
    v_mfma_f32_16x16x32_bf16 v[120:123], v[168:171], a[144:147], 0
    v_exp_f32 v74, v74
    v_exp_f32 v75, v75
    v_mfma_f32_16x16x32_bf16 v[124:127], v[168:171], a[148:151], 0
    v_fma_f32 v76, v76, s70, -v31
    v_fma_f32 v77, v77, s70, -v31
    v_mfma_f32_16x16x32_bf16 v[128:131], v[168:171], a[152:155], 0
    v_fma_f32 v78, v78, s70, -v31
    ds_read_b128 v[196:199], v25 offset:18432
    v_mfma_f32_16x16x32_bf16 v[120:123], v[172:175], a[156:159], v[120:123]
    v_fma_f32 v79, v79, s70, -v31
    v_exp_f32 v76, v76
    v_mfma_f32_16x16x32_bf16 v[124:127], v[172:175], a[160:163], v[124:127]
    v_exp_f32 v77, v77
    v_exp_f32 v78, v78
    v_mfma_f32_16x16x32_bf16 v[128:131], v[172:175], a[164:167], v[128:131]
    v_exp_f32 v79, v79
    ds_read_b128 v[200:203], v24 offset:18560
    s_waitcnt lgkmcnt(5)
    v_mfma_f32_16x16x32_bf16 v[120:123], v[176:179], a[168:171], v[120:123]
    v_fma_f32 v80, v80, s70, -v32
    v_fma_f32 v81, v81, s70, -v32
    v_mfma_f32_16x16x32_bf16 v[124:127], v[176:179], a[172:175], v[124:127]
    v_fma_f32 v82, v82, s70, -v32
    v_fma_f32 v83, v83, s70, -v32
    v_mfma_f32_16x16x32_bf16 v[128:131], v[176:179], a[176:179], v[128:131]
    v_exp_f32 v80, v80
    ds_read_b128 v[204:207], v25 offset:18560
    v_mfma_f32_16x16x32_bf16 v[120:123], v[180:183], a[180:183], v[120:123]
    v_exp_f32 v81, v81
    v_exp_f32 v82, v82
    v_mfma_f32_16x16x32_bf16 v[124:127], v[180:183], a[184:187], v[124:127]
    v_exp_f32 v83, v83
    v_cvt_pk_bf16_f32 v146, v60, v61
    v_mfma_f32_16x16x32_bf16 v[128:131], v[180:183], a[188:191], v[128:131]
    v_cvt_pk_bf16_f32 v147, v62, v63
    ds_read_b128 v[208:211], v24 offset:18688
    s_waitcnt lgkmcnt(5)
    v_mfma_f32_16x16x32_bf16 v[120:123], v[184:187], a[192:195], v[120:123]
    v_cvt_pk_bf16_f32 v150, v64, v65
    v_cvt_pk_bf16_f32 v151, v66, v67
    v_mfma_f32_16x16x32_bf16 v[124:127], v[184:187], a[196:199], v[124:127]
    v_cvt_pk_bf16_f32 v154, v68, v69
    v_cvt_pk_bf16_f32 v155, v70, v71
    v_mfma_f32_16x16x32_bf16 v[128:131], v[184:187], a[200:203], v[128:131]
    v_fma_f32 v84, v84, s70, -v30
    ds_read_b128 v[212:215], v25 offset:18688
    v_mfma_f32_16x16x32_bf16 v[120:123], v[188:191], a[204:207], v[120:123]
    v_fma_f32 v85, v85, s70, -v30
    v_fma_f32 v86, v86, s70, -v30
    v_mfma_f32_16x16x32_bf16 v[124:127], v[188:191], a[208:211], v[124:127]
    v_fma_f32 v87, v87, s70, -v30
    v_exp_f32 v84, v84
    v_mfma_f32_16x16x32_bf16 v[128:131], v[188:191], a[212:215], v[128:131]
    v_exp_f32 v85, v85
    s_waitcnt vmcnt(18)
    s_barrier
    v_add_u32 v26, s64, v16
    v_add_u32 v27, s64, v17
    v_add_u32 v28, s64, v18
    v_add_u32 v29, s64, v19
    ds_read_b64_tr_b16 v[168:169], v26 offset:0
    ds_read_b64_tr_b16 v[170:171], v26 offset:6144
    s_waitcnt lgkmcnt(6)
    v_mfma_f32_16x16x32_bf16 v[132:135], v[192:195], a[144:147], 0
    s_add_u32 m0, s62, s66
    s_add_u32 s67, s56, 98304
    buffer_load_dwordx4 v4, s[44:47], s67 offen offset:0 nt lds
    v_exp_f32 v86, v86
    v_exp_f32 v87, v87
    v_mfma_f32_16x16x32_bf16 v[136:139], v[192:195], a[148:151], 0
    v_fma_f32 v88, v88, s70, -v31
    v_fma_f32 v89, v89, s70, -v31
    v_mfma_f32_16x16x32_bf16 v[140:143], v[192:195], a[152:155], 0
    v_fma_f32 v90, v90, s70, -v31
    ds_read_b64_tr_b16 v[172:173], v27 offset:0
    ds_read_b64_tr_b16 v[174:175], v27 offset:6144
    v_mfma_f32_16x16x32_bf16 v[132:135], v[196:199], a[156:159], v[132:135]
    v_fma_f32 v91, v91, s70, -v31
    v_exp_f32 v88, v88
    v_mfma_f32_16x16x32_bf16 v[136:139], v[196:199], a[160:163], v[136:139]
    v_exp_f32 v89, v89
    v_exp_f32 v90, v90
    v_mfma_f32_16x16x32_bf16 v[140:143], v[196:199], a[164:167], v[140:143]
    buffer_load_dwordx4 v5, s[44:47], s67 offen offset:1024 nt lds
    v_exp_f32 v91, v91
    ds_read_b64_tr_b16 v[176:177], v28 offset:0
    ds_read_b64_tr_b16 v[178:179], v28 offset:6144
    s_waitcnt lgkmcnt(8)
    v_mfma_f32_16x16x32_bf16 v[132:135], v[200:203], a[168:171], v[132:135]
    v_fma_f32 v92, v92, s70, -v32
    v_fma_f32 v93, v93, s70, -v32
    v_mfma_f32_16x16x32_bf16 v[136:139], v[200:203], a[172:175], v[136:139]
    v_fma_f32 v94, v94, s70, -v32
    v_fma_f32 v95, v95, s70, -v32
    v_mfma_f32_16x16x32_bf16 v[140:143], v[200:203], a[176:179], v[140:143]
    v_exp_f32 v92, v92
    ds_read_b64_tr_b16 v[180:181], v29 offset:0
    ds_read_b64_tr_b16 v[182:183], v29 offset:6144
    v_mfma_f32_16x16x32_bf16 v[132:135], v[204:207], a[180:183], v[132:135]
    v_exp_f32 v93, v93
    v_exp_f32 v94, v94
    v_mfma_f32_16x16x32_bf16 v[136:139], v[204:207], a[184:187], v[136:139]
    buffer_load_dwordx4 v6, s[44:47], s67 offen offset:2048 nt lds
    v_exp_f32 v95, v95
    v_cvt_pk_bf16_f32 v156, v72, v73
    v_mfma_f32_16x16x32_bf16 v[140:143], v[204:207], a[188:191], v[140:143]
    v_cvt_pk_bf16_f32 v157, v74, v75
    ds_read_b64_tr_b16 v[184:185], v26 offset:128
    ds_read_b64_tr_b16 v[186:187], v26 offset:6272
    s_waitcnt lgkmcnt(10)
    v_mfma_f32_16x16x32_bf16 v[132:135], v[208:211], a[192:195], v[132:135]
    v_cvt_pk_bf16_f32 v160, v76, v77
    v_cvt_pk_bf16_f32 v161, v78, v79
    v_mfma_f32_16x16x32_bf16 v[136:139], v[208:211], a[196:199], v[136:139]
    v_cvt_pk_bf16_f32 v164, v80, v81
    v_cvt_pk_bf16_f32 v165, v82, v83
    v_mfma_f32_16x16x32_bf16 v[140:143], v[208:211], a[200:203], v[140:143]
    v_cvt_pk_bf16_f32 v158, v84, v85
    ds_read_b64_tr_b16 v[188:189], v27 offset:128
    ds_read_b64_tr_b16 v[190:191], v27 offset:6272
    v_mfma_f32_16x16x32_bf16 v[132:135], v[212:215], a[204:207], v[132:135]
    s_add_u32 m0, m0, 3072
    s_add_u32 s67, s67, 3072
    buffer_load_dwordx4 v4, s[44:47], s67 offen offset:0 nt lds
    v_cvt_pk_bf16_f32 v159, v86, v87
    v_cvt_pk_bf16_f32 v162, v88, v89
    v_mfma_f32_16x16x32_bf16 v[136:139], v[212:215], a[208:211], v[136:139]
    v_cvt_pk_bf16_f32 v163, v90, v91
    v_cvt_pk_bf16_f32 v166, v92, v93
    v_mfma_f32_16x16x32_bf16 v[140:143], v[212:215], a[212:215], v[140:143]
    v_cvt_pk_bf16_f32 v167, v94, v95
    ds_read_b64_tr_b16 v[192:193], v28 offset:128
    ds_read_b64_tr_b16 v[194:195], v28 offset:6272
    v_mfma_f32_16x16x32_bf16 a[216:219], v[252:255], v[144:147], a[216:219]
    v_mfma_f32_16x16x32_bf16 a[220:223], v[252:255], v[148:151], a[220:223]
    v_mfma_f32_16x16x32_bf16 a[224:227], v[252:255], v[152:155], a[224:227]
    s_waitcnt lgkmcnt(10)
    v_mfma_f32_16x16x32_bf16 a[0:3], v[168:171], v[144:147], a[0:3]
    v_max3_f32 v36, v96, v97, v98
    v_mfma_f32_16x16x32_bf16 a[4:7], v[168:171], v[148:151], a[4:7]
    v_mfma_f32_16x16x32_bf16 a[8:11], v[168:171], v[152:155], a[8:11]
    buffer_load_dwordx4 v5, s[44:47], s67 offen offset:1024 nt lds
    v_max3_f32 v37, v100, v101, v102
    ds_read_b64_tr_b16 v[196:197], v29 offset:128
    ds_read_b64_tr_b16 v[198:199], v29 offset:6272
    v_mfma_f32_16x16x32_bf16 a[12:15], v[172:175], v[144:147], a[12:15]
    v_mfma_f32_16x16x32_bf16 a[16:19], v[172:175], v[148:151], a[16:19]
    v_max3_f32 v38, v104, v105, v106
    v_mfma_f32_16x16x32_bf16 a[20:23], v[172:175], v[152:155], a[20:23]
    ds_read_b64_tr_b16 v[200:201], v26 offset:256
    ds_read_b64_tr_b16 v[202:203], v26 offset:6400
    s_waitcnt lgkmcnt(10)
    v_mfma_f32_16x16x32_bf16 a[24:27], v[176:179], v[144:147], a[24:27]
    v_mfma_f32_16x16x32_bf16 a[28:31], v[176:179], v[148:151], a[28:31]
    buffer_load_dwordx4 v6, s[44:47], s67 offen offset:2048 nt lds
    v_max3_f32 v36, v36, v99, v108
    v_mfma_f32_16x16x32_bf16 a[32:35], v[176:179], v[152:155], a[32:35]
    ds_read_b64_tr_b16 v[204:205], v27 offset:256
    ds_read_b64_tr_b16 v[206:207], v27 offset:6400
    v_mfma_f32_16x16x32_bf16 a[36:39], v[180:183], v[144:147], a[36:39]
    v_max3_f32 v37, v37, v103, v112
    v_mfma_f32_16x16x32_bf16 a[40:43], v[180:183], v[148:151], a[40:43]
    v_mfma_f32_16x16x32_bf16 a[44:47], v[180:183], v[152:155], a[44:47]
    ds_read_b64_tr_b16 v[208:209], v28 offset:256
    ds_read_b64_tr_b16 v[210:211], v28 offset:6400
    s_waitcnt lgkmcnt(10)
    v_mfma_f32_16x16x32_bf16 a[48:51], v[184:187], v[144:147], a[48:51]
    v_max3_f32 v38, v38, v107, v116
    v_mfma_f32_16x16x32_bf16 a[52:55], v[184:187], v[148:151], a[52:55]
    v_mfma_f32_16x16x32_bf16 a[56:59], v[184:187], v[152:155], a[56:59]
    v_max3_f32 v36, v36, v109, v110
    ds_read_b64_tr_b16 v[212:213], v29 offset:256
    ds_read_b64_tr_b16 v[214:215], v29 offset:6400
    v_mfma_f32_16x16x32_bf16 a[60:63], v[188:191], v[144:147], a[60:63]
    v_mfma_f32_16x16x32_bf16 a[64:67], v[188:191], v[148:151], a[64:67]
    v_mfma_f32_16x16x32_bf16 a[68:71], v[188:191], v[152:155], a[68:71]
    v_max3_f32 v37, v37, v113, v114
    ds_read_b64_tr_b16 v[168:169], v26 offset:12288
    ds_read_b64_tr_b16 v[170:171], v26 offset:18432
    s_waitcnt lgkmcnt(10)
    v_mfma_f32_16x16x32_bf16 a[72:75], v[192:195], v[144:147], a[72:75]
    v_mfma_f32_16x16x32_bf16 a[76:79], v[192:195], v[148:151], a[76:79]
    v_max3_f32 v38, v38, v117, v118
    v_mfma_f32_16x16x32_bf16 a[80:83], v[192:195], v[152:155], a[80:83]
    ds_read_b64_tr_b16 v[172:173], v27 offset:12288
    ds_read_b64_tr_b16 v[174:175], v27 offset:18432
    v_mfma_f32_16x16x32_bf16 a[84:87], v[196:199], v[144:147], a[84:87]
    v_mfma_f32_16x16x32_bf16 a[88:91], v[196:199], v[148:151], a[88:91]
    v_max3_f32 v36, v36, v111, v120
    v_mfma_f32_16x16x32_bf16 a[92:95], v[196:199], v[152:155], a[92:95]
    ds_read_b64_tr_b16 v[176:177], v28 offset:12288
    ds_read_b64_tr_b16 v[178:179], v28 offset:18432
    s_waitcnt lgkmcnt(10)
    v_mfma_f32_16x16x32_bf16 a[96:99], v[200:203], v[144:147], a[96:99]
    v_max3_f32 v37, v37, v115, v124
    v_mfma_f32_16x16x32_bf16 a[100:103], v[200:203], v[148:151], a[100:103]
    v_mfma_f32_16x16x32_bf16 a[104:107], v[200:203], v[152:155], a[104:107]
    ds_read_b64_tr_b16 v[180:181], v29 offset:12288
    ds_read_b64_tr_b16 v[182:183], v29 offset:18432
    v_mfma_f32_16x16x32_bf16 a[108:111], v[204:207], v[144:147], a[108:111]
    v_max3_f32 v38, v38, v119, v128
    v_mfma_f32_16x16x32_bf16 a[112:115], v[204:207], v[148:151], a[112:115]
    v_mfma_f32_16x16x32_bf16 a[116:119], v[204:207], v[152:155], a[116:119]
    v_max3_f32 v36, v36, v121, v122
    ds_read_b64_tr_b16 v[184:185], v26 offset:12416
    ds_read_b64_tr_b16 v[186:187], v26 offset:18560
    s_waitcnt lgkmcnt(10)
    v_mfma_f32_16x16x32_bf16 a[120:123], v[208:211], v[144:147], a[120:123]
    v_mfma_f32_16x16x32_bf16 a[124:127], v[208:211], v[148:151], a[124:127]
    v_mfma_f32_16x16x32_bf16 a[128:131], v[208:211], v[152:155], a[128:131]
    v_max3_f32 v37, v37, v125, v126
    ds_read_b64_tr_b16 v[188:189], v27 offset:12416
    ds_read_b64_tr_b16 v[190:191], v27 offset:18560
    v_mfma_f32_16x16x32_bf16 a[132:135], v[212:215], v[144:147], a[132:135]
    v_mfma_f32_16x16x32_bf16 a[136:139], v[212:215], v[148:151], a[136:139]
    v_max3_f32 v38, v38, v129, v130
    v_mfma_f32_16x16x32_bf16 a[140:143], v[212:215], v[152:155], a[140:143]
    ds_read_b64_tr_b16 v[192:193], v28 offset:12416
    ds_read_b64_tr_b16 v[194:195], v28 offset:18560
    v_mfma_f32_16x16x32_bf16 a[216:219], v[252:255], v[156:159], a[216:219]
    v_mfma_f32_16x16x32_bf16 a[220:223], v[252:255], v[160:163], a[220:223]
    v_mfma_f32_16x16x32_bf16 a[224:227], v[252:255], v[164:167], a[224:227]
    s_waitcnt lgkmcnt(10)
    v_mfma_f32_16x16x32_bf16 a[0:3], v[168:171], v[156:159], a[0:3]
    v_mfma_f32_16x16x32_bf16 a[4:7], v[168:171], v[160:163], a[4:7]
    v_max3_f32 v36, v36, v123, v132
    v_mfma_f32_16x16x32_bf16 a[8:11], v[168:171], v[164:167], a[8:11]
    ds_read_b64_tr_b16 v[196:197], v29 offset:12416
    ds_read_b64_tr_b16 v[198:199], v29 offset:18560
    v_mfma_f32_16x16x32_bf16 a[12:15], v[172:175], v[156:159], a[12:15]
    v_max3_f32 v37, v37, v127, v136
    v_mfma_f32_16x16x32_bf16 a[16:19], v[172:175], v[160:163], a[16:19]
    v_mfma_f32_16x16x32_bf16 a[20:23], v[172:175], v[164:167], a[20:23]
    ds_read_b64_tr_b16 v[200:201], v26 offset:12544
    ds_read_b64_tr_b16 v[202:203], v26 offset:18688
    s_waitcnt lgkmcnt(10)
    v_mfma_f32_16x16x32_bf16 a[24:27], v[176:179], v[156:159], a[24:27]
    v_max3_f32 v38, v38, v131, v140
    v_mfma_f32_16x16x32_bf16 a[28:31], v[176:179], v[160:163], a[28:31]
    v_mfma_f32_16x16x32_bf16 a[32:35], v[176:179], v[164:167], a[32:35]
    v_max3_f32 v36, v36, v133, v134
    ds_read_b64_tr_b16 v[204:205], v27 offset:12544
    ds_read_b64_tr_b16 v[206:207], v27 offset:18688
    v_mfma_f32_16x16x32_bf16 a[36:39], v[180:183], v[156:159], a[36:39]
    v_mfma_f32_16x16x32_bf16 a[40:43], v[180:183], v[160:163], a[40:43]
    v_mfma_f32_16x16x32_bf16 a[44:47], v[180:183], v[164:167], a[44:47]
    v_max3_f32 v37, v37, v137, v138
    ds_read_b64_tr_b16 v[208:209], v28 offset:12544
    ds_read_b64_tr_b16 v[210:211], v28 offset:18688
    s_waitcnt lgkmcnt(10)
    v_mfma_f32_16x16x32_bf16 a[48:51], v[184:187], v[156:159], a[48:51]
    v_mfma_f32_16x16x32_bf16 a[52:55], v[184:187], v[160:163], a[52:55]
    v_max3_f32 v38, v38, v141, v142
    v_mfma_f32_16x16x32_bf16 a[56:59], v[184:187], v[164:167], a[56:59]
    ds_read_b64_tr_b16 v[212:213], v29 offset:12544
    ds_read_b64_tr_b16 v[214:215], v29 offset:18688
    v_mfma_f32_16x16x32_bf16 a[60:63], v[188:191], v[156:159], a[60:63]
    v_mfma_f32_16x16x32_bf16 a[64:67], v[188:191], v[160:163], a[64:67]
    v_max_f32 v36, v36, v135
    v_mfma_f32_16x16x32_bf16 a[68:71], v[188:191], v[164:167], a[68:71]
    s_waitcnt vmcnt(18)
    s_barrier
    v_add_u32 v24, s65, v14
    v_add_u32 v25, s65, v15
    ds_read_b128 v[168:171], v24 offset:0
    s_waitcnt lgkmcnt(9)
    v_mfma_f32_16x16x32_bf16 a[72:75], v[192:195], v[156:159], a[72:75]
    v_max_f32 v37, v37, v139
    v_mfma_f32_16x16x32_bf16 a[76:79], v[192:195], v[160:163], a[76:79]
    v_mfma_f32_16x16x32_bf16 a[80:83], v[192:195], v[164:167], a[80:83]
    ds_read_b128 v[172:175], v25 offset:0
    v_mfma_f32_16x16x32_bf16 a[84:87], v[196:199], v[156:159], a[84:87]
    s_add_u32 m0, s63, s66
    s_add_u32 s67, s56, 147456
    buffer_load_dwordx4 v4, s[40:43], s67 offen offset:0 nt lds
    v_max_f32 v38, v38, v143
    v_mfma_f32_16x16x32_bf16 a[88:91], v[196:199], v[160:163], a[88:91]
    v_mfma_f32_16x16x32_bf16 a[92:95], v[196:199], v[164:167], a[92:95]
    v_fma_f32 v39, v36, s70, -v30
    ds_read_b128 v[176:179], v24 offset:128
    s_waitcnt lgkmcnt(7)
    v_mfma_f32_16x16x32_bf16 a[96:99], v[200:203], v[156:159], a[96:99]
    v_mfma_f32_16x16x32_bf16 a[100:103], v[200:203], v[160:163], a[100:103]
    v_mfma_f32_16x16x32_bf16 a[104:107], v[200:203], v[164:167], a[104:107]
    buffer_load_dwordx4 v5, s[40:43], s67 offen offset:1024 nt lds
    v_fma_f32 v40, v37, s70, -v31
    ds_read_b128 v[180:183], v25 offset:128
    v_mfma_f32_16x16x32_bf16 a[108:111], v[204:207], v[156:159], a[108:111]
    v_mfma_f32_16x16x32_bf16 a[112:115], v[204:207], v[160:163], a[112:115]
    v_fma_f32 v41, v38, s70, -v32
    v_mfma_f32_16x16x32_bf16 a[116:119], v[204:207], v[164:167], a[116:119]
    ds_read_b128 v[184:187], v24 offset:256
    s_waitcnt lgkmcnt(5)
    v_mfma_f32_16x16x32_bf16 a[120:123], v[208:211], v[156:159], a[120:123]
    v_mfma_f32_16x16x32_bf16 a[124:127], v[208:211], v[160:163], a[124:127]
    buffer_load_dwordx4 v6, s[40:43], s67 offen offset:2048 nt lds
    v_max3_f32 v39, v39, v40, v41
    v_mfma_f32_16x16x32_bf16 a[128:131], v[208:211], v[164:167], a[128:131]
    ds_read_b128 v[188:191], v25 offset:256
    v_mfma_f32_16x16x32_bf16 a[132:135], v[212:215], v[156:159], a[132:135]
    v_cmp_lt_f32 s[78:79], s71, v39
    v_mfma_f32_16x16x32_bf16 a[136:139], v[212:215], v[160:163], a[136:139]
    v_mfma_f32_16x16x32_bf16 a[140:143], v[212:215], v[164:167], a[140:143]
    s_nop 1
    s_cmp_lg_u64 s[78:79], 0
    s_cbranch_scc0 L1_skip2
    s_swappc_b64 s[72:73], s[74:75]
L1_skip2:
    ds_read_b128 v[192:195], v24 offset:6144
    s_waitcnt lgkmcnt(5)
    v_mfma_f32_16x16x32_bf16 v[48:51], v[168:171], a[144:147], 0
    s_add_u32 m0, m0, 3072
    s_add_u32 s67, s67, 3072
    buffer_load_dwordx4 v4, s[40:43], s67 offen offset:0 nt lds
    v_fma_f32 v96, v96, s70, -v30
    v_fma_f32 v97, v97, s70, -v30
    v_mfma_f32_16x16x32_bf16 v[52:55], v[168:171], a[148:151], 0
    v_fma_f32 v98, v98, s70, -v30
    v_fma_f32 v99, v99, s70, -v30
    v_mfma_f32_16x16x32_bf16 v[56:59], v[168:171], a[152:155], 0
    v_exp_f32 v96, v96
    ds_read_b128 v[196:199], v25 offset:6144
    v_mfma_f32_16x16x32_bf16 v[48:51], v[172:175], a[156:159], v[48:51]
    v_exp_f32 v97, v97
    v_exp_f32 v98, v98
    v_mfma_f32_16x16x32_bf16 v[52:55], v[172:175], a[160:163], v[52:55]
    v_exp_f32 v99, v99
    v_fma_f32 v100, v100, s70, -v31
    v_mfma_f32_16x16x32_bf16 v[56:59], v[172:175], a[164:167], v[56:59]
    buffer_load_dwordx4 v5, s[40:43], s67 offen offset:1024 nt lds
    v_fma_f32 v101, v101, s70, -v31
    ds_read_b128 v[200:203], v24 offset:6272
    s_waitcnt lgkmcnt(5)
    v_mfma_f32_16x16x32_bf16 v[48:51], v[176:179], a[168:171], v[48:51]
    v_fma_f32 v102, v102, s70, -v31
    v_fma_f32 v103, v103, s70, -v31
    v_mfma_f32_16x16x32_bf16 v[52:55], v[176:179], a[172:175], v[52:55]
    v_exp_f32 v100, v100
    v_exp_f32 v101, v101
    v_mfma_f32_16x16x32_bf16 v[56:59], v[176:179], a[176:179], v[56:59]
    v_exp_f32 v102, v102
    ds_read_b128 v[204:207], v25 offset:6272
    v_mfma_f32_16x16x32_bf16 v[48:51], v[180:183], a[180:183], v[48:51]
    v_exp_f32 v103, v103
    v_fma_f32 v104, v104, s70, -v32
    v_mfma_f32_16x16x32_bf16 v[52:55], v[180:183], a[184:187], v[52:55]
    buffer_load_dwordx4 v6, s[40:43], s67 offen offset:2048 nt lds
    v_fma_f32 v105, v105, s70, -v32
    v_fma_f32 v106, v106, s70, -v32
    v_mfma_f32_16x16x32_bf16 v[56:59], v[180:183], a[188:191], v[56:59]
    v_fma_f32 v107, v107, s70, -v32
    ds_read_b128 v[208:211], v24 offset:6400
    s_waitcnt lgkmcnt(5)
    v_mfma_f32_16x16x32_bf16 v[48:51], v[184:187], a[192:195], v[48:51]
    v_exp_f32 v104, v104
    v_exp_f32 v105, v105
    v_mfma_f32_16x16x32_bf16 v[52:55], v[184:187], a[196:199], v[52:55]
    v_exp_f32 v106, v106
    v_exp_f32 v107, v107
    v_mfma_f32_16x16x32_bf16 v[56:59], v[184:187], a[200:203], v[56:59]
    v_fma_f32 v108, v108, s70, -v30
    ds_read_b128 v[212:215], v25 offset:6400
    v_mfma_f32_16x16x32_bf16 v[48:51], v[188:191], a[204:207], v[48:51]
    v_fma_f32 v109, v109, s70, -v30
    v_fma_f32 v110, v110, s70, -v30
    v_mfma_f32_16x16x32_bf16 v[52:55], v[188:191], a[208:211], v[52:55]
    v_fma_f32 v111, v111, s70, -v30
    v_exp_f32 v108, v108
    v_mfma_f32_16x16x32_bf16 v[56:59], v[188:191], a[212:215], v[56:59]
    v_exp_f32 v109, v109
    ds_read_b128 v[168:171], v24 offset:12288
    s_waitcnt lgkmcnt(5)
    v_mfma_f32_16x16x32_bf16 v[60:63], v[192:195], a[144:147], 0
    v_exp_f32 v110, v110
    v_exp_f32 v111, v111
    v_mfma_f32_16x16x32_bf16 v[64:67], v[192:195], a[148:151], 0
    v_fma_f32 v112, v112, s70, -v31
    v_fma_f32 v113, v113, s70, -v31
    v_mfma_f32_16x16x32_bf16 v[68:71], v[192:195], a[152:155], 0
    v_fma_f32 v114, v114, s70, -v31
    ds_read_b128 v[172:175], v25 offset:12288
    v_mfma_f32_16x16x32_bf16 v[60:63], v[196:199], a[156:159], v[60:63]
    v_fma_f32 v115, v115, s70, -v31
    v_exp_f32 v112, v112
    v_mfma_f32_16x16x32_bf16 v[64:67], v[196:199], a[160:163], v[64:67]
    v_exp_f32 v113, v113
    v_exp_f32 v114, v114
    v_mfma_f32_16x16x32_bf16 v[68:71], v[196:199], a[164:167], v[68:71]
    v_exp_f32 v115, v115
    ds_read_b128 v[176:179], v24 offset:12416
    s_waitcnt lgkmcnt(5)
    v_mfma_f32_16x16x32_bf16 v[60:63], v[200:203], a[168:171], v[60:63]
    v_fma_f32 v116, v116, s70, -v32
    v_fma_f32 v117, v117, s70, -v32
    v_mfma_f32_16x16x32_bf16 v[64:67], v[200:203], a[172:175], v[64:67]
    v_fma_f32 v118, v118, s70, -v32
    v_fma_f32 v119, v119, s70, -v32
    v_mfma_f32_16x16x32_bf16 v[68:71], v[200:203], a[176:179], v[68:71]
    v_exp_f32 v116, v116
    ds_read_b128 v[180:183], v25 offset:12416
    v_mfma_f32_16x16x32_bf16 v[60:63], v[204:207], a[180:183], v[60:63]
    v_exp_f32 v117, v117
    v_exp_f32 v118, v118
    v_mfma_f32_16x16x32_bf16 v[64:67], v[204:207], a[184:187], v[64:67]
    v_exp_f32 v119, v119
    v_cvt_pk_bf16_f32 v144, v96, v97
    v_mfma_f32_16x16x32_bf16 v[68:71], v[204:207], a[188:191], v[68:71]
    v_cvt_pk_bf16_f32 v145, v98, v99
    ds_read_b128 v[184:187], v24 offset:12544
    s_waitcnt lgkmcnt(5)
    v_mfma_f32_16x16x32_bf16 v[60:63], v[208:211], a[192:195], v[60:63]
    v_cvt_pk_bf16_f32 v148, v100, v101
    v_cvt_pk_bf16_f32 v149, v102, v103
    v_mfma_f32_16x16x32_bf16 v[64:67], v[208:211], a[196:199], v[64:67]
    v_cvt_pk_bf16_f32 v152, v104, v105
    v_cvt_pk_bf16_f32 v153, v106, v107
    v_mfma_f32_16x16x32_bf16 v[68:71], v[208:211], a[200:203], v[68:71]
    v_fma_f32 v120, v120, s70, -v30
    ds_read_b128 v[188:191], v25 offset:12544
    v_mfma_f32_16x16x32_bf16 v[60:63], v[212:215], a[204:207], v[60:63]
    v_fma_f32 v121, v121, s70, -v30
    v_fma_f32 v122, v122, s70, -v30
    v_mfma_f32_16x16x32_bf16 v[64:67], v[212:215], a[208:211], v[64:67]
    v_fma_f32 v123, v123, s70, -v30
    v_exp_f32 v120, v120
    v_mfma_f32_16x16x32_bf16 v[68:71], v[212:215], a[212:215], v[68:71]
    v_exp_f32 v121, v121
    ds_read_b128 v[192:195], v24 offset:18432
    s_waitcnt lgkmcnt(5)
    v_mfma_f32_16x16x32_bf16 v[72:75], v[168:171], a[144:147], 0
    v_exp_f32 v122, v122
    v_exp_f32 v123, v123
    v_mfma_f32_16x16x32_bf16 v[76:79], v[168:171], a[148:151], 0
    v_fma_f32 v124, v124, s70, -v31
    v_fma_f32 v125, v125, s70, -v31
    v_mfma_f32_16x16x32_bf16 v[80:83], v[168:171], a[152:155], 0
    v_fma_f32 v126, v126, s70, -v31
    ds_read_b128 v[196:199], v25 offset:18432
    v_mfma_f32_16x16x32_bf16 v[72:75], v[172:175], a[156:159], v[72:75]
    v_fma_f32 v127, v127, s70, -v31
    v_exp_f32 v124, v124
    v_mfma_f32_16x16x32_bf16 v[76:79], v[172:175], a[160:163], v[76:79]
    v_exp_f32 v125, v125
    v_exp_f32 v126, v126
    v_mfma_f32_16x16x32_bf16 v[80:83], v[172:175], a[164:167], v[80:83]
    v_exp_f32 v127, v127
    ds_read_b128 v[200:203], v24 offset:18560
    s_waitcnt lgkmcnt(5)
    v_mfma_f32_16x16x32_bf16 v[72:75], v[176:179], a[168:171], v[72:75]
    v_fma_f32 v128, v128, s70, -v32
    v_fma_f32 v129, v129, s70, -v32
    v_mfma_f32_16x16x32_bf16 v[76:79], v[176:179], a[172:175], v[76:79]
    v_fma_f32 v130, v130, s70, -v32
    v_fma_f32 v131, v131, s70, -v32
    v_mfma_f32_16x16x32_bf16 v[80:83], v[176:179], a[176:179], v[80:83]
    v_exp_f32 v128, v128
    ds_read_b128 v[204:207], v25 offset:18560
    v_mfma_f32_16x16x32_bf16 v[72:75], v[180:183], a[180:183], v[72:75]
    v_exp_f32 v129, v129
    v_exp_f32 v130, v130
    v_mfma_f32_16x16x32_bf16 v[76:79], v[180:183], a[184:187], v[76:79]
    v_exp_f32 v131, v131
    v_cvt_pk_bf16_f32 v146, v108, v109
    v_mfma_f32_16x16x32_bf16 v[80:83], v[180:183], a[188:191], v[80:83]
    v_cvt_pk_bf16_f32 v147, v110, v111
    ds_read_b128 v[208:211], v24 offset:18688
    s_waitcnt lgkmcnt(5)
    v_mfma_f32_16x16x32_bf16 v[72:75], v[184:187], a[192:195], v[72:75]
    v_cvt_pk_bf16_f32 v150, v112, v113
    v_cvt_pk_bf16_f32 v151, v114, v115
    v_mfma_f32_16x16x32_bf16 v[76:79], v[184:187], a[196:199], v[76:79]
    v_cvt_pk_bf16_f32 v154, v116, v117
    v_cvt_pk_bf16_f32 v155, v118, v119
    v_mfma_f32_16x16x32_bf16 v[80:83], v[184:187], a[200:203], v[80:83]
    v_fma_f32 v132, v132, s70, -v30
    ds_read_b128 v[212:215], v25 offset:18688
    v_mfma_f32_16x16x32_bf16 v[72:75], v[188:191], a[204:207], v[72:75]
    v_fma_f32 v133, v133, s70, -v30
    v_fma_f32 v134, v134, s70, -v30
    v_mfma_f32_16x16x32_bf16 v[76:79], v[188:191], a[208:211], v[76:79]
    v_fma_f32 v135, v135, s70, -v30
    v_exp_f32 v132, v132
    v_mfma_f32_16x16x32_bf16 v[80:83], v[188:191], a[212:215], v[80:83]
    v_exp_f32 v133, v133
    s_waitcnt vmcnt(18)
    s_barrier
    v_add_u32 v26, s60, v16
    v_add_u32 v27, s60, v17
    v_add_u32 v28, s60, v18
    v_add_u32 v29, s60, v19
    ds_read_b64_tr_b16 v[168:169], v26 offset:0
    ds_read_b64_tr_b16 v[170:171], v26 offset:6144
    s_waitcnt lgkmcnt(6)
    v_mfma_f32_16x16x32_bf16 v[84:87], v[192:195], a[144:147], 0
    v_exp_f32 v134, v134
    v_exp_f32 v135, v135
    v_mfma_f32_16x16x32_bf16 v[88:91], v[192:195], a[148:151], 0
    s_add_u32 m0, s64, s66
    s_add_u32 s67, s56, 122880
    buffer_load_dwordx4 v4, s[44:47], s67 offen offset:0 nt lds
    v_fma_f32 v136, v136, s70, -v31
    v_fma_f32 v137, v137, s70, -v31
    v_mfma_f32_16x16x32_bf16 v[92:95], v[192:195], a[152:155], 0
    v_fma_f32 v138, v138, s70, -v31
    ds_read_b64_tr_b16 v[172:173], v27 offset:0
    ds_read_b64_tr_b16 v[174:175], v27 offset:6144
    v_mfma_f32_16x16x32_bf16 v[84:87], v[196:199], a[156:159], v[84:87]
    v_fma_f32 v139, v139, s70, -v31
    v_exp_f32 v136, v136
    v_mfma_f32_16x16x32_bf16 v[88:91], v[196:199], a[160:163], v[88:91]
    v_exp_f32 v137, v137
    v_exp_f32 v138, v138
    v_mfma_f32_16x16x32_bf16 v[92:95], v[196:199], a[164:167], v[92:95]
    v_exp_f32 v139, v139
    ds_read_b64_tr_b16 v[176:177], v28 offset:0
    ds_read_b64_tr_b16 v[178:179], v28 offset:6144
    s_waitcnt lgkmcnt(8)
    v_mfma_f32_16x16x32_bf16 v[84:87], v[200:203], a[168:171], v[84:87]
    buffer_load_dwordx4 v5, s[44:47], s67 offen offset:1024 nt lds
    v_fma_f32 v140, v140, s70, -v32
    v_fma_f32 v141, v141, s70, -v32
    v_mfma_f32_16x16x32_bf16 v[88:91], v[200:203], a[172:175], v[88:91]
    v_fma_f32 v142, v142, s70, -v32
    v_fma_f32 v143, v143, s70, -v32
    v_mfma_f32_16x16x32_bf16 v[92:95], v[200:203], a[176:179], v[92:95]
    v_exp_f32 v140, v140
    ds_read_b64_tr_b16 v[180:181], v29 offset:0
    ds_read_b64_tr_b16 v[182:183], v29 offset:6144
    v_mfma_f32_16x16x32_bf16 v[84:87], v[204:207], a[180:183], v[84:87]
    v_exp_f32 v141, v141
    v_exp_f32 v142, v142
    v_mfma_f32_16x16x32_bf16 v[88:91], v[204:207], a[184:187], v[88:91]
    v_exp_f32 v143, v143
    v_cvt_pk_bf16_f32 v156, v120, v121
    v_mfma_f32_16x16x32_bf16 v[92:95], v[204:207], a[188:191], v[92:95]
    buffer_load_dwordx4 v6, s[44:47], s67 offen offset:2048 nt lds
    v_cvt_pk_bf16_f32 v157, v122, v123
    ds_read_b64_tr_b16 v[184:185], v26 offset:128
    ds_read_b64_tr_b16 v[186:187], v26 offset:6272
    s_waitcnt lgkmcnt(10)
    v_mfma_f32_16x16x32_bf16 v[84:87], v[208:211], a[192:195], v[84:87]
    v_cvt_pk_bf16_f32 v160, v124, v125
    v_cvt_pk_bf16_f32 v161, v126, v127
    v_mfma_f32_16x16x32_bf16 v[88:91], v[208:211], a[196:199], v[88:91]
    v_cvt_pk_bf16_f32 v164, v128, v129
    v_cvt_pk_bf16_f32 v165, v130, v131
    v_mfma_f32_16x16x32_bf16 v[92:95], v[208:211], a[200:203], v[92:95]
    v_cvt_pk_bf16_f32 v158, v132, v133
    ds_read_b64_tr_b16 v[188:189], v27 offset:128
    ds_read_b64_tr_b16 v[190:191], v27 offset:6272
    v_mfma_f32_16x16x32_bf16 v[84:87], v[212:215], a[204:207], v[84:87]
    v_cvt_pk_bf16_f32 v159, v134, v135
    v_cvt_pk_bf16_f32 v162, v136, v137
    v_mfma_f32_16x16x32_bf16 v[88:91], v[212:215], a[208:211], v[88:91]
    s_add_u32 m0, m0, 3072
    s_add_u32 s67, s67, 3072
    buffer_load_dwordx4 v4, s[44:47], s67 offen offset:0 nt lds
    v_cvt_pk_bf16_f32 v163, v138, v139
    v_cvt_pk_bf16_f32 v166, v140, v141
    v_mfma_f32_16x16x32_bf16 v[92:95], v[212:215], a[212:215], v[92:95]
    v_cvt_pk_bf16_f32 v167, v142, v143
    ds_read_b64_tr_b16 v[192:193], v28 offset:128
    ds_read_b64_tr_b16 v[194:195], v28 offset:6272
    v_mfma_f32_16x16x32_bf16 a[216:219], v[252:255], v[144:147], a[216:219]
    v_mfma_f32_16x16x32_bf16 a[220:223], v[252:255], v[148:151], a[220:223]
    v_mfma_f32_16x16x32_bf16 a[224:227], v[252:255], v[152:155], a[224:227]
    s_waitcnt lgkmcnt(10)
    v_mfma_f32_16x16x32_bf16 a[0:3], v[168:171], v[144:147], a[0:3]
    v_max3_f32 v36, v48, v49, v50
    v_mfma_f32_16x16x32_bf16 a[4:7], v[168:171], v[148:151], a[4:7]
    v_mfma_f32_16x16x32_bf16 a[8:11], v[168:171], v[152:155], a[8:11]
    v_max3_f32 v37, v52, v53, v54
    ds_read_b64_tr_b16 v[196:197], v29 offset:128
    ds_read_b64_tr_b16 v[198:199], v29 offset:6272
    v_mfma_f32_16x16x32_bf16 a[12:15], v[172:175], v[144:147], a[12:15]
    buffer_load_dwordx4 v5, s[44:47], s67 offen offset:1024 nt lds
    v_mfma_f32_16x16x32_bf16 a[16:19], v[172:175], v[148:151], a[16:19]
    v_max3_f32 v38, v56, v57, v58
    v_mfma_f32_16x16x32_bf16 a[20:23], v[172:175], v[152:155], a[20:23]
    ds_read_b64_tr_b16 v[200:201], v26 offset:256
    ds_read_b64_tr_b16 v[202:203], v26 offset:6400
    s_waitcnt lgkmcnt(10)
    v_mfma_f32_16x16x32_bf16 a[24:27], v[176:179], v[144:147], a[24:27]
    v_mfma_f32_16x16x32_bf16 a[28:31], v[176:179], v[148:151], a[28:31]
    v_max3_f32 v36, v36, v51, v60
    v_mfma_f32_16x16x32_bf16 a[32:35], v[176:179], v[152:155], a[32:35]
    buffer_load_dwordx4 v6, s[44:47], s67 offen offset:2048 nt lds
    ds_read_b64_tr_b16 v[204:205], v27 offset:256
    ds_read_b64_tr_b16 v[206:207], v27 offset:6400
    v_mfma_f32_16x16x32_bf16 a[36:39], v[180:183], v[144:147], a[36:39]
    v_max3_f32 v37, v37, v55, v64
    v_mfma_f32_16x16x32_bf16 a[40:43], v[180:183], v[148:151], a[40:43]
    v_mfma_f32_16x16x32_bf16 a[44:47], v[180:183], v[152:155], a[44:47]
    ds_read_b64_tr_b16 v[208:209], v28 offset:256
    ds_read_b64_tr_b16 v[210:211], v28 offset:6400
    s_waitcnt lgkmcnt(10)
    v_mfma_f32_16x16x32_bf16 a[48:51], v[184:187], v[144:147], a[48:51]
    v_max3_f32 v38, v38, v59, v68
    v_mfma_f32_16x16x32_bf16 a[52:55], v[184:187], v[148:151], a[52:55]
    v_mfma_f32_16x16x32_bf16 a[56:59], v[184:187], v[152:155], a[56:59]
    v_max3_f32 v36, v36, v61, v62
    ds_read_b64_tr_b16 v[212:213], v29 offset:256
    ds_read_b64_tr_b16 v[214:215], v29 offset:6400
    v_mfma_f32_16x16x32_bf16 a[60:63], v[188:191], v[144:147], a[60:63]
    v_mfma_f32_16x16x32_bf16 a[64:67], v[188:191], v[148:151], a[64:67]
    v_mfma_f32_16x16x32_bf16 a[68:71], v[188:191], v[152:155], a[68:71]
    v_max3_f32 v37, v37, v65, v66
    ds_read_b64_tr_b16 v[168:169], v26 offset:12288
    ds_read_b64_tr_b16 v[170:171], v26 offset:18432
    s_waitcnt lgkmcnt(10)
    v_mfma_f32_16x16x32_bf16 a[72:75], v[192:195], v[144:147], a[72:75]
    v_mfma_f32_16x16x32_bf16 a[76:79], v[192:195], v[148:151], a[76:79]
    v_max3_f32 v38, v38, v69, v70
    v_mfma_f32_16x16x32_bf16 a[80:83], v[192:195], v[152:155], a[80:83]
    ds_read_b64_tr_b16 v[172:173], v27 offset:12288
    ds_read_b64_tr_b16 v[174:175], v27 offset:18432
    v_mfma_f32_16x16x32_bf16 a[84:87], v[196:199], v[144:147], a[84:87]
    v_mfma_f32_16x16x32_bf16 a[88:91], v[196:199], v[148:151], a[88:91]
    v_max3_f32 v36, v36, v63, v72
    v_mfma_f32_16x16x32_bf16 a[92:95], v[196:199], v[152:155], a[92:95]
    ds_read_b64_tr_b16 v[176:177], v28 offset:12288
    ds_read_b64_tr_b16 v[178:179], v28 offset:18432
    s_waitcnt lgkmcnt(10)
    v_mfma_f32_16x16x32_bf16 a[96:99], v[200:203], v[144:147], a[96:99]
    v_max3_f32 v37, v37, v67, v76
    v_mfma_f32_16x16x32_bf16 a[100:103], v[200:203], v[148:151], a[100:103]
    v_mfma_f32_16x16x32_bf16 a[104:107], v[200:203], v[152:155], a[104:107]
    ds_read_b64_tr_b16 v[180:181], v29 offset:12288
    ds_read_b64_tr_b16 v[182:183], v29 offset:18432
    v_mfma_f32_16x16x32_bf16 a[108:111], v[204:207], v[144:147], a[108:111]
    v_max3_f32 v38, v38, v71, v80
    v_mfma_f32_16x16x32_bf16 a[112:115], v[204:207], v[148:151], a[112:115]
    v_mfma_f32_16x16x32_bf16 a[116:119], v[204:207], v[152:155], a[116:119]
    v_max3_f32 v36, v36, v73, v74
    ds_read_b64_tr_b16 v[184:185], v26 offset:12416
    ds_read_b64_tr_b16 v[186:187], v26 offset:18560
    s_waitcnt lgkmcnt(10)
    v_mfma_f32_16x16x32_bf16 a[120:123], v[208:211], v[144:147], a[120:123]
    v_mfma_f32_16x16x32_bf16 a[124:127], v[208:211], v[148:151], a[124:127]
    v_mfma_f32_16x16x32_bf16 a[128:131], v[208:211], v[152:155], a[128:131]
    v_max3_f32 v37, v37, v77, v78
    ds_read_b64_tr_b16 v[188:189], v27 offset:12416
    ds_read_b64_tr_b16 v[190:191], v27 offset:18560
    v_mfma_f32_16x16x32_bf16 a[132:135], v[212:215], v[144:147], a[132:135]
    v_mfma_f32_16x16x32_bf16 a[136:139], v[212:215], v[148:151], a[136:139]
    v_max3_f32 v38, v38, v81, v82
    v_mfma_f32_16x16x32_bf16 a[140:143], v[212:215], v[152:155], a[140:143]
    ds_read_b64_tr_b16 v[192:193], v28 offset:12416
    ds_read_b64_tr_b16 v[194:195], v28 offset:18560
    v_mfma_f32_16x16x32_bf16 a[216:219], v[252:255], v[156:159], a[216:219]
    v_mfma_f32_16x16x32_bf16 a[220:223], v[252:255], v[160:163], a[220:223]
    v_mfma_f32_16x16x32_bf16 a[224:227], v[252:255], v[164:167], a[224:227]
    s_waitcnt lgkmcnt(10)
    v_mfma_f32_16x16x32_bf16 a[0:3], v[168:171], v[156:159], a[0:3]
    v_mfma_f32_16x16x32_bf16 a[4:7], v[168:171], v[160:163], a[4:7]
    v_max3_f32 v36, v36, v75, v84
    v_mfma_f32_16x16x32_bf16 a[8:11], v[168:171], v[164:167], a[8:11]
    ds_read_b64_tr_b16 v[196:197], v29 offset:12416
    ds_read_b64_tr_b16 v[198:199], v29 offset:18560
    v_mfma_f32_16x16x32_bf16 a[12:15], v[172:175], v[156:159], a[12:15]
    v_max3_f32 v37, v37, v79, v88
    v_mfma_f32_16x16x32_bf16 a[16:19], v[172:175], v[160:163], a[16:19]
    v_mfma_f32_16x16x32_bf16 a[20:23], v[172:175], v[164:167], a[20:23]
    ds_read_b64_tr_b16 v[200:201], v26 offset:12544
    ds_read_b64_tr_b16 v[202:203], v26 offset:18688
    s_waitcnt lgkmcnt(10)
    v_mfma_f32_16x16x32_bf16 a[24:27], v[176:179], v[156:159], a[24:27]
    v_max3_f32 v38, v38, v83, v92
    v_mfma_f32_16x16x32_bf16 a[28:31], v[176:179], v[160:163], a[28:31]
    v_mfma_f32_16x16x32_bf16 a[32:35], v[176:179], v[164:167], a[32:35]
    v_max3_f32 v36, v36, v85, v86
    ds_read_b64_tr_b16 v[204:205], v27 offset:12544
    ds_read_b64_tr_b16 v[206:207], v27 offset:18688
    v_mfma_f32_16x16x32_bf16 a[36:39], v[180:183], v[156:159], a[36:39]
    v_mfma_f32_16x16x32_bf16 a[40:43], v[180:183], v[160:163], a[40:43]
    v_mfma_f32_16x16x32_bf16 a[44:47], v[180:183], v[164:167], a[44:47]
    v_max3_f32 v37, v37, v89, v90
    ds_read_b64_tr_b16 v[208:209], v28 offset:12544
    ds_read_b64_tr_b16 v[210:211], v28 offset:18688
    s_waitcnt lgkmcnt(10)
    v_mfma_f32_16x16x32_bf16 a[48:51], v[184:187], v[156:159], a[48:51]
    v_mfma_f32_16x16x32_bf16 a[52:55], v[184:187], v[160:163], a[52:55]
    v_max3_f32 v38, v38, v93, v94
    v_mfma_f32_16x16x32_bf16 a[56:59], v[184:187], v[164:167], a[56:59]
    ds_read_b64_tr_b16 v[212:213], v29 offset:12544
    ds_read_b64_tr_b16 v[214:215], v29 offset:18688
    v_mfma_f32_16x16x32_bf16 a[60:63], v[188:191], v[156:159], a[60:63]
    v_mfma_f32_16x16x32_bf16 a[64:67], v[188:191], v[160:163], a[64:67]
    v_max_f32 v36, v36, v87
    v_mfma_f32_16x16x32_bf16 a[68:71], v[188:191], v[164:167], a[68:71]
    s_waitcnt vmcnt(18)
    s_barrier
    v_add_u32 v24, s61, v14
    v_add_u32 v25, s61, v15
    ds_read_b128 v[168:171], v24 offset:0
    s_waitcnt lgkmcnt(9)
    v_mfma_f32_16x16x32_bf16 a[72:75], v[192:195], v[156:159], a[72:75]
    v_max_f32 v37, v37, v91
    v_mfma_f32_16x16x32_bf16 a[76:79], v[192:195], v[160:163], a[76:79]
    v_mfma_f32_16x16x32_bf16 a[80:83], v[192:195], v[164:167], a[80:83]
    ds_read_b128 v[172:175], v25 offset:0
    v_mfma_f32_16x16x32_bf16 a[84:87], v[196:199], v[156:159], a[84:87]
    v_max_f32 v38, v38, v95
    v_mfma_f32_16x16x32_bf16 a[88:91], v[196:199], v[160:163], a[88:91]
    s_add_u32 m0, s65, s66
    s_add_u32 s67, s56, 172032
    buffer_load_dwordx4 v4, s[40:43], s67 offen offset:0 nt lds
    v_mfma_f32_16x16x32_bf16 a[92:95], v[196:199], v[164:167], a[92:95]
    v_fma_f32 v39, v36, s70, -v30
    ds_read_b128 v[176:179], v24 offset:128
    s_waitcnt lgkmcnt(7)
    v_mfma_f32_16x16x32_bf16 a[96:99], v[200:203], v[156:159], a[96:99]
    v_mfma_f32_16x16x32_bf16 a[100:103], v[200:203], v[160:163], a[100:103]
    v_mfma_f32_16x16x32_bf16 a[104:107], v[200:203], v[164:167], a[104:107]
    v_fma_f32 v40, v37, s70, -v31
    ds_read_b128 v[180:183], v25 offset:128
    v_mfma_f32_16x16x32_bf16 a[108:111], v[204:207], v[156:159], a[108:111]
    buffer_load_dwordx4 v5, s[40:43], s67 offen offset:1024 nt lds
    v_mfma_f32_16x16x32_bf16 a[112:115], v[204:207], v[160:163], a[112:115]
    v_fma_f32 v41, v38, s70, -v32
    v_mfma_f32_16x16x32_bf16 a[116:119], v[204:207], v[164:167], a[116:119]
    ds_read_b128 v[184:187], v24 offset:256
    s_waitcnt lgkmcnt(5)
    v_mfma_f32_16x16x32_bf16 a[120:123], v[208:211], v[156:159], a[120:123]
    v_mfma_f32_16x16x32_bf16 a[124:127], v[208:211], v[160:163], a[124:127]
    v_max3_f32 v39, v39, v40, v41
    v_mfma_f32_16x16x32_bf16 a[128:131], v[208:211], v[164:167], a[128:131]
    buffer_load_dwordx4 v6, s[40:43], s67 offen offset:2048 nt lds
    ds_read_b128 v[188:191], v25 offset:256
    v_mfma_f32_16x16x32_bf16 a[132:135], v[212:215], v[156:159], a[132:135]
    v_cmp_lt_f32 s[78:79], s71, v39
    v_mfma_f32_16x16x32_bf16 a[136:139], v[212:215], v[160:163], a[136:139]
    v_mfma_f32_16x16x32_bf16 a[140:143], v[212:215], v[164:167], a[140:143]
    s_nop 1
    s_cmp_lg_u64 s[78:79], 0
    s_cbranch_scc0 L1_skip3
    s_swappc_b64 s[72:73], s[74:75]
L1_skip3:
    ds_read_b128 v[192:195], v24 offset:6144
    s_waitcnt lgkmcnt(5)
    v_mfma_f32_16x16x32_bf16 v[96:99], v[168:171], a[144:147], 0
    v_fma_f32 v48, v48, s70, -v30
    v_fma_f32 v49, v49, s70, -v30
    v_mfma_f32_16x16x32_bf16 v[100:103], v[168:171], a[148:151], 0
    s_add_u32 m0, m0, 3072
    s_add_u32 s67, s67, 3072
    buffer_load_dwordx4 v4, s[40:43], s67 offen offset:0 nt lds
    v_fma_f32 v50, v50, s70, -v30
    v_fma_f32 v51, v51, s70, -v30
    v_mfma_f32_16x16x32_bf16 v[104:107], v[168:171], a[152:155], 0
    v_exp_f32 v48, v48
    ds_read_b128 v[196:199], v25 offset:6144
    v_mfma_f32_16x16x32_bf16 v[96:99], v[172:175], a[156:159], v[96:99]
    v_exp_f32 v49, v49
    v_exp_f32 v50, v50
    v_mfma_f32_16x16x32_bf16 v[100:103], v[172:175], a[160:163], v[100:103]
    v_exp_f32 v51, v51
    v_fma_f32 v52, v52, s70, -v31
    v_mfma_f32_16x16x32_bf16 v[104:107], v[172:175], a[164:167], v[104:107]
    v_fma_f32 v53, v53, s70, -v31
    ds_read_b128 v[200:203], v24 offset:6272
    s_waitcnt lgkmcnt(5)
    v_mfma_f32_16x16x32_bf16 v[96:99], v[176:179], a[168:171], v[96:99]
    buffer_load_dwordx4 v5, s[40:43], s67 offen offset:1024 nt lds
    v_fma_f32 v54, v54, s70, -v31
    v_fma_f32 v55, v55, s70, -v31
    v_mfma_f32_16x16x32_bf16 v[100:103], v[176:179], a[172:175], v[100:103]
    v_exp_f32 v52, v52
    v_exp_f32 v53, v53
    v_mfma_f32_16x16x32_bf16 v[104:107], v[176:179], a[176:179], v[104:107]
    v_exp_f32 v54, v54
    ds_read_b128 v[204:207], v25 offset:6272
    v_mfma_f32_16x16x32_bf16 v[96:99], v[180:183], a[180:183], v[96:99]
    v_exp_f32 v55, v55
    v_fma_f32 v56, v56, s70, -v32
    v_mfma_f32_16x16x32_bf16 v[100:103], v[180:183], a[184:187], v[100:103]
    v_fma_f32 v57, v57, s70, -v32
    v_fma_f32 v58, v58, s70, -v32
    v_mfma_f32_16x16x32_bf16 v[104:107], v[180:183], a[188:191], v[104:107]
    buffer_load_dwordx4 v6, s[40:43], s67 offen offset:2048 nt lds
    v_fma_f32 v59, v59, s70, -v32
    ds_read_b128 v[208:211], v24 offset:6400
    s_waitcnt lgkmcnt(5)
    v_mfma_f32_16x16x32_bf16 v[96:99], v[184:187], a[192:195], v[96:99]
    v_exp_f32 v56, v56
    v_exp_f32 v57, v57
    v_mfma_f32_16x16x32_bf16 v[100:103], v[184:187], a[196:199], v[100:103]
    v_exp_f32 v58, v58
    v_exp_f32 v59, v59
    v_mfma_f32_16x16x32_bf16 v[104:107], v[184:187], a[200:203], v[104:107]
    v_fma_f32 v60, v60, s70, -v30
    ds_read_b128 v[212:215], v25 offset:6400
    v_mfma_f32_16x16x32_bf16 v[96:99], v[188:191], a[204:207], v[96:99]
    v_fma_f32 v61, v61, s70, -v30
    v_fma_f32 v62, v62, s70, -v30
    v_mfma_f32_16x16x32_bf16 v[100:103], v[188:191], a[208:211], v[100:103]
    v_fma_f32 v63, v63, s70, -v30
    v_exp_f32 v60, v60
    v_mfma_f32_16x16x32_bf16 v[104:107], v[188:191], a[212:215], v[104:107]
    v_exp_f32 v61, v61
    ds_read_b128 v[168:171], v24 offset:12288
    s_waitcnt lgkmcnt(5)
    v_mfma_f32_16x16x32_bf16 v[108:111], v[192:195], a[144:147], 0
    v_exp_f32 v62, v62
    v_exp_f32 v63, v63
    v_mfma_f32_16x16x32_bf16 v[112:115], v[192:195], a[148:151], 0
    v_fma_f32 v64, v64, s70, -v31
    v_fma_f32 v65, v65, s70, -v31
    v_mfma_f32_16x16x32_bf16 v[116:119], v[192:195], a[152:155], 0
    v_fma_f32 v66, v66, s70, -v31
    ds_read_b128 v[172:175], v25 offset:12288
    v_mfma_f32_16x16x32_bf16 v[108:111], v[196:199], a[156:159], v[108:111]
    v_fma_f32 v67, v67, s70, -v31
    v_exp_f32 v64, v64
    v_mfma_f32_16x16x32_bf16 v[112:115], v[196:199], a[160:163], v[112:115]
    v_exp_f32 v65, v65
    v_exp_f32 v66, v66
    v_mfma_f32_16x16x32_bf16 v[116:119], v[196:199], a[164:167], v[116:119]
    v_exp_f32 v67, v67
    ds_read_b128 v[176:179], v24 offset:12416
    s_waitcnt lgkmcnt(5)
    v_mfma_f32_16x16x32_bf16 v[108:111], v[200:203], a[168:171], v[108:111]
    v_fma_f32 v68, v68, s70, -v32
    v_fma_f32 v69, v69, s70, -v32
    v_mfma_f32_16x16x32_bf16 v[112:115], v[200:203], a[172:175], v[112:115]
    v_fma_f32 v70, v70, s70, -v32
    v_fma_f32 v71, v71, s70, -v32
    v_mfma_f32_16x16x32_bf16 v[116:119], v[200:203], a[176:179], v[116:119]
    v_exp_f32 v68, v68
    ds_read_b128 v[180:183], v25 offset:12416
    v_mfma_f32_16x16x32_bf16 v[108:111], v[204:207], a[180:183], v[108:111]
    v_exp_f32 v69, v69
    v_exp_f32 v70, v70
    v_mfma_f32_16x16x32_bf16 v[112:115], v[204:207], a[184:187], v[112:115]
    v_exp_f32 v71, v71
    v_cvt_pk_bf16_f32 v144, v48, v49
    v_mfma_f32_16x16x32_bf16 v[116:119], v[204:207], a[188:191], v[116:119]
    v_cvt_pk_bf16_f32 v145, v50, v51
    ds_read_b128 v[184:187], v24 offset:12544
    s_waitcnt lgkmcnt(5)
    v_mfma_f32_16x16x32_bf16 v[108:111], v[208:211], a[192:195], v[108:111]
    v_cvt_pk_bf16_f32 v148, v52, v53
    v_cvt_pk_bf16_f32 v149, v54, v55
    v_mfma_f32_16x16x32_bf16 v[112:115], v[208:211], a[196:199], v[112:115]
    v_cvt_pk_bf16_f32 v152, v56, v57
    v_cvt_pk_bf16_f32 v153, v58, v59
    v_mfma_f32_16x16x32_bf16 v[116:119], v[208:211], a[200:203], v[116:119]
    v_fma_f32 v72, v72, s70, -v30
    ds_read_b128 v[188:191], v25 offset:12544
    v_mfma_f32_16x16x32_bf16 v[108:111], v[212:215], a[204:207], v[108:111]
    v_fma_f32 v73, v73, s70, -v30
    v_fma_f32 v74, v74, s70, -v30
    v_mfma_f32_16x16x32_bf16 v[112:115], v[212:215], a[208:211], v[112:115]
    v_fma_f32 v75, v75, s70, -v30
    v_exp_f32 v72, v72
    v_mfma_f32_16x16x32_bf16 v[116:119], v[212:215], a[212:215], v[116:119]
    v_exp_f32 v73, v73
    ds_read_b128 v[192:195], v24 offset:18432
    s_waitcnt lgkmcnt(5)
    v_mfma_f32_16x16x32_bf16 v[120:123], v[168:171], a[144:147], 0
    v_exp_f32 v74, v74
    v_exp_f32 v75, v75
    v_mfma_f32_16x16x32_bf16 v[124:127], v[168:171], a[148:151], 0
    v_fma_f32 v76, v76, s70, -v31
    v_fma_f32 v77, v77, s70, -v31
    v_mfma_f32_16x16x32_bf16 v[128:131], v[168:171], a[152:155], 0
    v_fma_f32 v78, v78, s70, -v31
    ds_read_b128 v[196:199], v25 offset:18432
    v_mfma_f32_16x16x32_bf16 v[120:123], v[172:175], a[156:159], v[120:123]
    v_fma_f32 v79, v79, s70, -v31
    v_exp_f32 v76, v76
    v_mfma_f32_16x16x32_bf16 v[124:127], v[172:175], a[160:163], v[124:127]
    v_exp_f32 v77, v77
    v_exp_f32 v78, v78
    v_mfma_f32_16x16x32_bf16 v[128:131], v[172:175], a[164:167], v[128:131]
    v_exp_f32 v79, v79
    ds_read_b128 v[200:203], v24 offset:18560
    s_waitcnt lgkmcnt(5)
    v_mfma_f32_16x16x32_bf16 v[120:123], v[176:179], a[168:171], v[120:123]
    v_fma_f32 v80, v80, s70, -v32
    v_fma_f32 v81, v81, s70, -v32
    v_mfma_f32_16x16x32_bf16 v[124:127], v[176:179], a[172:175], v[124:127]
    v_fma_f32 v82, v82, s70, -v32
    v_fma_f32 v83, v83, s70, -v32
    v_mfma_f32_16x16x32_bf16 v[128:131], v[176:179], a[176:179], v[128:131]
    v_exp_f32 v80, v80
    ds_read_b128 v[204:207], v25 offset:18560
    v_mfma_f32_16x16x32_bf16 v[120:123], v[180:183], a[180:183], v[120:123]
    v_exp_f32 v81, v81
    v_exp_f32 v82, v82
    v_mfma_f32_16x16x32_bf16 v[124:127], v[180:183], a[184:187], v[124:127]
    v_exp_f32 v83, v83
    v_cvt_pk_bf16_f32 v146, v60, v61
    v_mfma_f32_16x16x32_bf16 v[128:131], v[180:183], a[188:191], v[128:131]
    v_cvt_pk_bf16_f32 v147, v62, v63
    ds_read_b128 v[208:211], v24 offset:18688
    s_waitcnt lgkmcnt(5)
    v_mfma_f32_16x16x32_bf16 v[120:123], v[184:187], a[192:195], v[120:123]
    v_cvt_pk_bf16_f32 v150, v64, v65
    v_cvt_pk_bf16_f32 v151, v66, v67
    v_mfma_f32_16x16x32_bf16 v[124:127], v[184:187], a[196:199], v[124:127]
    v_cvt_pk_bf16_f32 v154, v68, v69
    v_cvt_pk_bf16_f32 v155, v70, v71
    v_mfma_f32_16x16x32_bf16 v[128:131], v[184:187], a[200:203], v[128:131]
    v_fma_f32 v84, v84, s70, -v30
    ds_read_b128 v[212:215], v25 offset:18688
    v_mfma_f32_16x16x32_bf16 v[120:123], v[188:191], a[204:207], v[120:123]
    v_fma_f32 v85, v85, s70, -v30
    v_fma_f32 v86, v86, s70, -v30
    v_mfma_f32_16x16x32_bf16 v[124:127], v[188:191], a[208:211], v[124:127]
    v_fma_f32 v87, v87, s70, -v30
    v_exp_f32 v84, v84
    v_mfma_f32_16x16x32_bf16 v[128:131], v[188:191], a[212:215], v[128:131]
    v_exp_f32 v85, v85
    s_waitcnt vmcnt(18)
    s_barrier
    v_add_u32 v26, s62, v16
    v_add_u32 v27, s62, v17
    v_add_u32 v28, s62, v18
    v_add_u32 v29, s62, v19
    ds_read_b64_tr_b16 v[168:169], v26 offset:0
    ds_read_b64_tr_b16 v[170:171], v26 offset:6144
    s_waitcnt lgkmcnt(6)
    v_mfma_f32_16x16x32_bf16 v[132:135], v[192:195], a[144:147], 0
    v_exp_f32 v86, v86
    v_exp_f32 v87, v87
    v_mfma_f32_16x16x32_bf16 v[136:139], v[192:195], a[148:151], 0
    v_fma_f32 v88, v88, s70, -v31
    v_fma_f32 v89, v89, s70, -v31
    v_mfma_f32_16x16x32_bf16 v[140:143], v[192:195], a[152:155], 0
    s_add_u32 m0, s60, s66
    s_add_u32 s67, s56, 147456
    buffer_load_dwordx4 v4, s[44:47], s67 offen offset:0 nt lds
    v_fma_f32 v90, v90, s70, -v31
    ds_read_b64_tr_b16 v[172:173], v27 offset:0
    ds_read_b64_tr_b16 v[174:175], v27 offset:6144
    v_mfma_f32_16x16x32_bf16 v[132:135], v[196:199], a[156:159], v[132:135]
    v_fma_f32 v91, v91, s70, -v31
    v_exp_f32 v88, v88
    v_mfma_f32_16x16x32_bf16 v[136:139], v[196:199], a[160:163], v[136:139]
    v_exp_f32 v89, v89
    v_exp_f32 v90, v90
    v_mfma_f32_16x16x32_bf16 v[140:143], v[196:199], a[164:167], v[140:143]
    v_exp_f32 v91, v91
    ds_read_b64_tr_b16 v[176:177], v28 offset:0
    ds_read_b64_tr_b16 v[178:179], v28 offset:6144
    s_waitcnt lgkmcnt(8)
    v_mfma_f32_16x16x32_bf16 v[132:135], v[200:203], a[168:171], v[132:135]
    v_fma_f32 v92, v92, s70, -v32
    v_fma_f32 v93, v93, s70, -v32
    v_mfma_f32_16x16x32_bf16 v[136:139], v[200:203], a[172:175], v[136:139]
    buffer_load_dwordx4 v5, s[44:47], s67 offen offset:1024 nt lds
    v_fma_f32 v94, v94, s70, -v32
    v_fma_f32 v95, v95, s70, -v32
    v_mfma_f32_16x16x32_bf16 v[140:143], v[200:203], a[176:179], v[140:143]
    v_exp_f32 v92, v92
    ds_read_b64_tr_b16 v[180:181], v29 offset:0
    ds_read_b64_tr_b16 v[182:183], v29 offset:6144
    v_mfma_f32_16x16x32_bf16 v[132:135], v[204:207], a[180:183], v[132:135]
    v_exp_f32 v93, v93
    v_exp_f32 v94, v94
    v_mfma_f32_16x16x32_bf16 v[136:139], v[204:207], a[184:187], v[136:139]
    v_exp_f32 v95, v95
    v_cvt_pk_bf16_f32 v156, v72, v73
    v_mfma_f32_16x16x32_bf16 v[140:143], v[204:207], a[188:191], v[140:143]
    v_cvt_pk_bf16_f32 v157, v74, v75
    ds_read_b64_tr_b16 v[184:185], v26 offset:128
    ds_read_b64_tr_b16 v[186:187], v26 offset:6272
    s_waitcnt lgkmcnt(10)
    v_mfma_f32_16x16x32_bf16 v[132:135], v[208:211], a[192:195], v[132:135]
    buffer_load_dwordx4 v6, s[44:47], s67 offen offset:2048 nt lds
    v_cvt_pk_bf16_f32 v160, v76, v77
    v_cvt_pk_bf16_f32 v161, v78, v79
    v_mfma_f32_16x16x32_bf16 v[136:139], v[208:211], a[196:199], v[136:139]
    v_cvt_pk_bf16_f32 v164, v80, v81
    v_cvt_pk_bf16_f32 v165, v82, v83
    v_mfma_f32_16x16x32_bf16 v[140:143], v[208:211], a[200:203], v[140:143]
    v_cvt_pk_bf16_f32 v158, v84, v85
    ds_read_b64_tr_b16 v[188:189], v27 offset:128
    ds_read_b64_tr_b16 v[190:191], v27 offset:6272
    v_mfma_f32_16x16x32_bf16 v[132:135], v[212:215], a[204:207], v[132:135]
    v_cvt_pk_bf16_f32 v159, v86, v87
    v_cvt_pk_bf16_f32 v162, v88, v89
    v_mfma_f32_16x16x32_bf16 v[136:139], v[212:215], a[208:211], v[136:139]
    v_cvt_pk_bf16_f32 v163, v90, v91
    v_cvt_pk_bf16_f32 v166, v92, v93
    v_mfma_f32_16x16x32_bf16 v[140:143], v[212:215], a[212:215], v[140:143]
    s_add_u32 m0, m0, 3072
    s_add_u32 s67, s67, 3072
    buffer_load_dwordx4 v4, s[44:47], s67 offen offset:0 nt lds
    v_cvt_pk_bf16_f32 v167, v94, v95
    ds_read_b64_tr_b16 v[192:193], v28 offset:128
    ds_read_b64_tr_b16 v[194:195], v28 offset:6272
    v_mfma_f32_16x16x32_bf16 a[216:219], v[252:255], v[144:147], a[216:219]
    v_mfma_f32_16x16x32_bf16 a[220:223], v[252:255], v[148:151], a[220:223]
    v_mfma_f32_16x16x32_bf16 a[224:227], v[252:255], v[152:155], a[224:227]
    s_waitcnt lgkmcnt(10)
    v_mfma_f32_16x16x32_bf16 a[0:3], v[168:171], v[144:147], a[0:3]
    v_max3_f32 v36, v96, v97, v98
    v_mfma_f32_16x16x32_bf16 a[4:7], v[168:171], v[148:151], a[4:7]
    v_mfma_f32_16x16x32_bf16 a[8:11], v[168:171], v[152:155], a[8:11]
    v_max3_f32 v37, v100, v101, v102
    ds_read_b64_tr_b16 v[196:197], v29 offset:128
    ds_read_b64_tr_b16 v[198:199], v29 offset:6272
    v_mfma_f32_16x16x32_bf16 a[12:15], v[172:175], v[144:147], a[12:15]
    v_mfma_f32_16x16x32_bf16 a[16:19], v[172:175], v[148:151], a[16:19]
    buffer_load_dwordx4 v5, s[44:47], s67 offen offset:1024 nt lds
    v_max3_f32 v38, v104, v105, v106
    v_mfma_f32_16x16x32_bf16 a[20:23], v[172:175], v[152:155], a[20:23]
    ds_read_b64_tr_b16 v[200:201], v26 offset:256
    ds_read_b64_tr_b16 v[202:203], v26 offset:6400
    s_waitcnt lgkmcnt(10)
    v_mfma_f32_16x16x32_bf16 a[24:27], v[176:179], v[144:147], a[24:27]
    v_mfma_f32_16x16x32_bf16 a[28:31], v[176:179], v[148:151], a[28:31]
    v_max3_f32 v36, v36, v99, v108
    v_mfma_f32_16x16x32_bf16 a[32:35], v[176:179], v[152:155], a[32:35]
    ds_read_b64_tr_b16 v[204:205], v27 offset:256
    ds_read_b64_tr_b16 v[206:207], v27 offset:6400
    v_mfma_f32_16x16x32_bf16 a[36:39], v[180:183], v[144:147], a[36:39]
    buffer_load_dwordx4 v6, s[44:47], s67 offen offset:2048 nt lds
    v_max3_f32 v37, v37, v103, v112
    v_mfma_f32_16x16x32_bf16 a[40:43], v[180:183], v[148:151], a[40:43]
    v_mfma_f32_16x16x32_bf16 a[44:47], v[180:183], v[152:155], a[44:47]
    ds_read_b64_tr_b16 v[208:209], v28 offset:256
    ds_read_b64_tr_b16 v[210:211], v28 offset:6400
    s_waitcnt lgkmcnt(10)
    v_mfma_f32_16x16x32_bf16 a[48:51], v[184:187], v[144:147], a[48:51]
    v_max3_f32 v38, v38, v107, v116
    v_mfma_f32_16x16x32_bf16 a[52:55], v[184:187], v[148:151], a[52:55]
    v_mfma_f32_16x16x32_bf16 a[56:59], v[184:187], v[152:155], a[56:59]
    v_max3_f32 v36, v36, v109, v110
    ds_read_b64_tr_b16 v[212:213], v29 offset:256
    ds_read_b64_tr_b16 v[214:215], v29 offset:6400
    v_mfma_f32_16x16x32_bf16 a[60:63], v[188:191], v[144:147], a[60:63]
    v_mfma_f32_16x16x32_bf16 a[64:67], v[188:191], v[148:151], a[64:67]
    v_mfma_f32_16x16x32_bf16 a[68:71], v[188:191], v[152:155], a[68:71]
    v_max3_f32 v37, v37, v113, v114
    ds_read_b64_tr_b16 v[168:169], v26 offset:12288
    ds_read_b64_tr_b16 v[170:171], v26 offset:18432
    s_waitcnt lgkmcnt(10)
    v_mfma_f32_16x16x32_bf16 a[72:75], v[192:195], v[144:147], a[72:75]
    v_mfma_f32_16x16x32_bf16 a[76:79], v[192:195], v[148:151], a[76:79]
    v_max3_f32 v38, v38, v117, v118
    v_mfma_f32_16x16x32_bf16 a[80:83], v[192:195], v[152:155], a[80:83]
    ds_read_b64_tr_b16 v[172:173], v27 offset:12288
    ds_read_b64_tr_b16 v[174:175], v27 offset:18432
    v_mfma_f32_16x16x32_bf16 a[84:87], v[196:199], v[144:147], a[84:87]
    v_mfma_f32_16x16x32_bf16 a[88:91], v[196:199], v[148:151], a[88:91]
    v_max3_f32 v36, v36, v111, v120
    v_mfma_f32_16x16x32_bf16 a[92:95], v[196:199], v[152:155], a[92:95]
    ds_read_b64_tr_b16 v[176:177], v28 offset:12288
    ds_read_b64_tr_b16 v[178:179], v28 offset:18432
    s_waitcnt lgkmcnt(10)
    v_mfma_f32_16x16x32_bf16 a[96:99], v[200:203], v[144:147], a[96:99]
    v_max3_f32 v37, v37, v115, v124
    v_mfma_f32_16x16x32_bf16 a[100:103], v[200:203], v[148:151], a[100:103]
    v_mfma_f32_16x16x32_bf16 a[104:107], v[200:203], v[152:155], a[104:107]
    ds_read_b64_tr_b16 v[180:181], v29 offset:12288
    ds_read_b64_tr_b16 v[182:183], v29 offset:18432
    v_mfma_f32_16x16x32_bf16 a[108:111], v[204:207], v[144:147], a[108:111]
    v_max3_f32 v38, v38, v119, v128
    v_mfma_f32_16x16x32_bf16 a[112:115], v[204:207], v[148:151], a[112:115]
    v_mfma_f32_16x16x32_bf16 a[116:119], v[204:207], v[152:155], a[116:119]
    v_max3_f32 v36, v36, v121, v122
    ds_read_b64_tr_b16 v[184:185], v26 offset:12416
    ds_read_b64_tr_b16 v[186:187], v26 offset:18560
    s_waitcnt lgkmcnt(10)
    v_mfma_f32_16x16x32_bf16 a[120:123], v[208:211], v[144:147], a[120:123]
    v_mfma_f32_16x16x32_bf16 a[124:127], v[208:211], v[148:151], a[124:127]
    v_mfma_f32_16x16x32_bf16 a[128:131], v[208:211], v[152:155], a[128:131]
    v_max3_f32 v37, v37, v125, v126
    ds_read_b64_tr_b16 v[188:189], v27 offset:12416
    ds_read_b64_tr_b16 v[190:191], v27 offset:18560
    v_mfma_f32_16x16x32_bf16 a[132:135], v[212:215], v[144:147], a[132:135]
    v_mfma_f32_16x16x32_bf16 a[136:139], v[212:215], v[148:151], a[136:139]
    v_max3_f32 v38, v38, v129, v130
    v_mfma_f32_16x16x32_bf16 a[140:143], v[212:215], v[152:155], a[140:143]
    ds_read_b64_tr_b16 v[192:193], v28 offset:12416
    ds_read_b64_tr_b16 v[194:195], v28 offset:18560
    v_mfma_f32_16x16x32_bf16 a[216:219], v[252:255], v[156:159], a[216:219]
    v_mfma_f32_16x16x32_bf16 a[220:223], v[252:255], v[160:163], a[220:223]
    v_mfma_f32_16x16x32_bf16 a[224:227], v[252:255], v[164:167], a[224:227]
    s_waitcnt lgkmcnt(10)
    v_mfma_f32_16x16x32_bf16 a[0:3], v[168:171], v[156:159], a[0:3]
    v_mfma_f32_16x16x32_bf16 a[4:7], v[168:171], v[160:163], a[4:7]
    v_max3_f32 v36, v36, v123, v132
    v_mfma_f32_16x16x32_bf16 a[8:11], v[168:171], v[164:167], a[8:11]
    ds_read_b64_tr_b16 v[196:197], v29 offset:12416
    ds_read_b64_tr_b16 v[198:199], v29 offset:18560
    v_mfma_f32_16x16x32_bf16 a[12:15], v[172:175], v[156:159], a[12:15]
    v_max3_f32 v37, v37, v127, v136
    v_mfma_f32_16x16x32_bf16 a[16:19], v[172:175], v[160:163], a[16:19]
    v_mfma_f32_16x16x32_bf16 a[20:23], v[172:175], v[164:167], a[20:23]
    ds_read_b64_tr_b16 v[200:201], v26 offset:12544
    ds_read_b64_tr_b16 v[202:203], v26 offset:18688
    s_waitcnt lgkmcnt(10)
    v_mfma_f32_16x16x32_bf16 a[24:27], v[176:179], v[156:159], a[24:27]
    v_max3_f32 v38, v38, v131, v140
    v_mfma_f32_16x16x32_bf16 a[28:31], v[176:179], v[160:163], a[28:31]
    v_mfma_f32_16x16x32_bf16 a[32:35], v[176:179], v[164:167], a[32:35]
    v_max3_f32 v36, v36, v133, v134
    ds_read_b64_tr_b16 v[204:205], v27 offset:12544
    ds_read_b64_tr_b16 v[206:207], v27 offset:18688
    v_mfma_f32_16x16x32_bf16 a[36:39], v[180:183], v[156:159], a[36:39]
    v_mfma_f32_16x16x32_bf16 a[40:43], v[180:183], v[160:163], a[40:43]
    v_mfma_f32_16x16x32_bf16 a[44:47], v[180:183], v[164:167], a[44:47]
    v_max3_f32 v37, v37, v137, v138
    ds_read_b64_tr_b16 v[208:209], v28 offset:12544
    ds_read_b64_tr_b16 v[210:211], v28 offset:18688
    s_waitcnt lgkmcnt(10)
    v_mfma_f32_16x16x32_bf16 a[48:51], v[184:187], v[156:159], a[48:51]
    v_mfma_f32_16x16x32_bf16 a[52:55], v[184:187], v[160:163], a[52:55]
    v_max3_f32 v38, v38, v141, v142
    v_mfma_f32_16x16x32_bf16 a[56:59], v[184:187], v[164:167], a[56:59]
    ds_read_b64_tr_b16 v[212:213], v29 offset:12544
    ds_read_b64_tr_b16 v[214:215], v29 offset:18688
    v_mfma_f32_16x16x32_bf16 a[60:63], v[188:191], v[156:159], a[60:63]
    v_mfma_f32_16x16x32_bf16 a[64:67], v[188:191], v[160:163], a[64:67]
    v_max_f32 v36, v36, v135
    v_mfma_f32_16x16x32_bf16 a[68:71], v[188:191], v[164:167], a[68:71]
    s_waitcnt vmcnt(18)
    s_barrier
    v_add_u32 v24, s63, v14
    v_add_u32 v25, s63, v15
    ds_read_b128 v[168:171], v24 offset:0
    s_waitcnt lgkmcnt(9)
    v_mfma_f32_16x16x32_bf16 a[72:75], v[192:195], v[156:159], a[72:75]
    s_add_u32 m0, s61, s66
    s_add_u32 s67, s56, 172032
    buffer_load_dwordx4 v4, s[44:47], s67 offen offset:0 nt lds
    v_max_f32 v37, v37, v139
    v_mfma_f32_16x16x32_bf16 a[76:79], v[192:195], v[160:163], a[76:79]
    v_mfma_f32_16x16x32_bf16 a[80:83], v[192:195], v[164:167], a[80:83]
    ds_read_b128 v[172:175], v25 offset:0
    v_mfma_f32_16x16x32_bf16 a[84:87], v[196:199], v[156:159], a[84:87]
    v_max_f32 v38, v38, v143
    v_mfma_f32_16x16x32_bf16 a[88:91], v[196:199], v[160:163], a[88:91]
    v_mfma_f32_16x16x32_bf16 a[92:95], v[196:199], v[164:167], a[92:95]
    buffer_load_dwordx4 v5, s[44:47], s67 offen offset:1024 nt lds
    v_fma_f32 v39, v36, s70, -v30
    ds_read_b128 v[176:179], v24 offset:128
    s_waitcnt lgkmcnt(7)
    v_mfma_f32_16x16x32_bf16 a[96:99], v[200:203], v[156:159], a[96:99]
    v_mfma_f32_16x16x32_bf16 a[100:103], v[200:203], v[160:163], a[100:103]
    v_mfma_f32_16x16x32_bf16 a[104:107], v[200:203], v[164:167], a[104:107]
    v_fma_f32 v40, v37, s70, -v31
    ds_read_b128 v[180:183], v25 offset:128
    v_mfma_f32_16x16x32_bf16 a[108:111], v[204:207], v[156:159], a[108:111]
    v_mfma_f32_16x16x32_bf16 a[112:115], v[204:207], v[160:163], a[112:115]
    buffer_load_dwordx4 v6, s[44:47], s67 offen offset:2048 nt lds
    v_fma_f32 v41, v38, s70, -v32
    v_mfma_f32_16x16x32_bf16 a[116:119], v[204:207], v[164:167], a[116:119]
    ds_read_b128 v[184:187], v24 offset:256
    s_waitcnt lgkmcnt(5)
    v_mfma_f32_16x16x32_bf16 a[120:123], v[208:211], v[156:159], a[120:123]
    v_mfma_f32_16x16x32_bf16 a[124:127], v[208:211], v[160:163], a[124:127]
    v_max3_f32 v39, v39, v40, v41
    v_mfma_f32_16x16x32_bf16 a[128:131], v[208:211], v[164:167], a[128:131]
    ds_read_b128 v[188:191], v25 offset:256
    v_mfma_f32_16x16x32_bf16 a[132:135], v[212:215], v[156:159], a[132:135]
    s_add_u32 m0, m0, 3072
    s_add_u32 s67, s67, 3072
    buffer_load_dwordx4 v4, s[44:47], s67 offen offset:0 nt lds
    v_cmp_lt_f32 s[78:79], s71, v39
    v_mfma_f32_16x16x32_bf16 a[136:139], v[212:215], v[160:163], a[136:139]
    v_mfma_f32_16x16x32_bf16 a[140:143], v[212:215], v[164:167], a[140:143]
    s_nop 1
    s_cmp_lg_u64 s[78:79], 0
    s_cbranch_scc0 L1_skip4
    s_swappc_b64 s[72:73], s[74:75]
L1_skip4:
    ds_read_b128 v[192:195], v24 offset:6144
    s_waitcnt lgkmcnt(5)
    v_mfma_f32_16x16x32_bf16 v[48:51], v[168:171], a[144:147], 0
    v_fma_f32 v96, v96, s70, -v30
    v_fma_f32 v97, v97, s70, -v30
    v_mfma_f32_16x16x32_bf16 v[52:55], v[168:171], a[148:151], 0
    v_fma_f32 v98, v98, s70, -v30
    v_fma_f32 v99, v99, s70, -v30
    v_mfma_f32_16x16x32_bf16 v[56:59], v[168:171], a[152:155], 0
    buffer_load_dwordx4 v5, s[44:47], s67 offen offset:1024 nt lds
    v_exp_f32 v96, v96
    ds_read_b128 v[196:199], v25 offset:6144
    v_mfma_f32_16x16x32_bf16 v[48:51], v[172:175], a[156:159], v[48:51]
    v_exp_f32 v97, v97
    v_exp_f32 v98, v98
    v_mfma_f32_16x16x32_bf16 v[52:55], v[172:175], a[160:163], v[52:55]
    v_exp_f32 v99, v99
    v_fma_f32 v100, v100, s70, -v31
    v_mfma_f32_16x16x32_bf16 v[56:59], v[172:175], a[164:167], v[56:59]
    v_fma_f32 v101, v101, s70, -v31
    ds_read_b128 v[200:203], v24 offset:6272
    s_waitcnt lgkmcnt(5)
    v_mfma_f32_16x16x32_bf16 v[48:51], v[176:179], a[168:171], v[48:51]
    v_fma_f32 v102, v102, s70, -v31
    v_fma_f32 v103, v103, s70, -v31
    v_mfma_f32_16x16x32_bf16 v[52:55], v[176:179], a[172:175], v[52:55]
    buffer_load_dwordx4 v6, s[44:47], s67 offen offset:2048 nt lds
    v_exp_f32 v100, v100
    v_exp_f32 v101, v101
    v_mfma_f32_16x16x32_bf16 v[56:59], v[176:179], a[176:179], v[56:59]
    v_exp_f32 v102, v102
    ds_read_b128 v[204:207], v25 offset:6272
    v_mfma_f32_16x16x32_bf16 v[48:51], v[180:183], a[180:183], v[48:51]
    v_exp_f32 v103, v103
    v_fma_f32 v104, v104, s70, -v32
    v_mfma_f32_16x16x32_bf16 v[52:55], v[180:183], a[184:187], v[52:55]
    v_fma_f32 v105, v105, s70, -v32
    v_fma_f32 v106, v106, s70, -v32
    v_mfma_f32_16x16x32_bf16 v[56:59], v[180:183], a[188:191], v[56:59]
    v_fma_f32 v107, v107, s70, -v32
    ds_read_b128 v[208:211], v24 offset:6400
    s_waitcnt lgkmcnt(5)
    v_mfma_f32_16x16x32_bf16 v[48:51], v[184:187], a[192:195], v[48:51]
    v_exp_f32 v104, v104
    v_exp_f32 v105, v105
    v_mfma_f32_16x16x32_bf16 v[52:55], v[184:187], a[196:199], v[52:55]
    v_exp_f32 v106, v106
    v_exp_f32 v107, v107
    v_mfma_f32_16x16x32_bf16 v[56:59], v[184:187], a[200:203], v[56:59]
    v_fma_f32 v108, v108, s70, -v30
    ds_read_b128 v[212:215], v25 offset:6400
    v_mfma_f32_16x16x32_bf16 v[48:51], v[188:191], a[204:207], v[48:51]
    v_fma_f32 v109, v109, s70, -v30
    v_fma_f32 v110, v110, s70, -v30
    v_mfma_f32_16x16x32_bf16 v[52:55], v[188:191], a[208:211], v[52:55]
    v_fma_f32 v111, v111, s70, -v30
    v_exp_f32 v108, v108
    v_mfma_f32_16x16x32_bf16 v[56:59], v[188:191], a[212:215], v[56:59]
    v_exp_f32 v109, v109
    ds_read_b128 v[168:171], v24 offset:12288
    s_waitcnt lgkmcnt(5)
    v_mfma_f32_16x16x32_bf16 v[60:63], v[192:195], a[144:147], 0
    v_exp_f32 v110, v110
    v_exp_f32 v111, v111
    v_mfma_f32_16x16x32_bf16 v[64:67], v[192:195], a[148:151], 0
    v_fma_f32 v112, v112, s70, -v31
    v_fma_f32 v113, v113, s70, -v31
    v_mfma_f32_16x16x32_bf16 v[68:71], v[192:195], a[152:155], 0
    v_fma_f32 v114, v114, s70, -v31
    ds_read_b128 v[172:175], v25 offset:12288
    v_mfma_f32_16x16x32_bf16 v[60:63], v[196:199], a[156:159], v[60:63]
    v_fma_f32 v115, v115, s70, -v31
    v_exp_f32 v112, v112
    v_mfma_f32_16x16x32_bf16 v[64:67], v[196:199], a[160:163], v[64:67]
    v_exp_f32 v113, v113
    v_exp_f32 v114, v114
    v_mfma_f32_16x16x32_bf16 v[68:71], v[196:199], a[164:167], v[68:71]
    v_exp_f32 v115, v115
    ds_read_b128 v[176:179], v24 offset:12416
    s_waitcnt lgkmcnt(5)
    v_mfma_f32_16x16x32_bf16 v[60:63], v[200:203], a[168:171], v[60:63]
    v_fma_f32 v116, v116, s70, -v32
    v_fma_f32 v117, v117, s70, -v32
    v_mfma_f32_16x16x32_bf16 v[64:67], v[200:203], a[172:175], v[64:67]
    v_fma_f32 v118, v118, s70, -v32
    v_fma_f32 v119, v119, s70, -v32
    v_mfma_f32_16x16x32_bf16 v[68:71], v[200:203], a[176:179], v[68:71]
    v_exp_f32 v116, v116
    ds_read_b128 v[180:183], v25 offset:12416
    v_mfma_f32_16x16x32_bf16 v[60:63], v[204:207], a[180:183], v[60:63]
    v_exp_f32 v117, v117
    v_exp_f32 v118, v118
    v_mfma_f32_16x16x32_bf16 v[64:67], v[204:207], a[184:187], v[64:67]
    v_exp_f32 v119, v119
    v_cvt_pk_bf16_f32 v144, v96, v97
    v_mfma_f32_16x16x32_bf16 v[68:71], v[204:207], a[188:191], v[68:71]
    v_cvt_pk_bf16_f32 v145, v98, v99
    ds_read_b128 v[184:187], v24 offset:12544
    s_waitcnt lgkmcnt(5)
    v_mfma_f32_16x16x32_bf16 v[60:63], v[208:211], a[192:195], v[60:63]
    v_cvt_pk_bf16_f32 v148, v100, v101
    v_cvt_pk_bf16_f32 v149, v102, v103
    v_mfma_f32_16x16x32_bf16 v[64:67], v[208:211], a[196:199], v[64:67]
    v_cvt_pk_bf16_f32 v152, v104, v105
    v_cvt_pk_bf16_f32 v153, v106, v107
    v_mfma_f32_16x16x32_bf16 v[68:71], v[208:211], a[200:203], v[68:71]
    v_fma_f32 v120, v120, s70, -v30
    ds_read_b128 v[188:191], v25 offset:12544
    v_mfma_f32_16x16x32_bf16 v[60:63], v[212:215], a[204:207], v[60:63]
    v_fma_f32 v121, v121, s70, -v30
    v_fma_f32 v122, v122, s70, -v30
    v_mfma_f32_16x16x32_bf16 v[64:67], v[212:215], a[208:211], v[64:67]
    v_fma_f32 v123, v123, s70, -v30
    v_exp_f32 v120, v120
    v_mfma_f32_16x16x32_bf16 v[68:71], v[212:215], a[212:215], v[68:71]
    v_exp_f32 v121, v121
    ds_read_b128 v[192:195], v24 offset:18432
    s_waitcnt lgkmcnt(5)
    v_mfma_f32_16x16x32_bf16 v[72:75], v[168:171], a[144:147], 0
    v_exp_f32 v122, v122
    v_exp_f32 v123, v123
    v_mfma_f32_16x16x32_bf16 v[76:79], v[168:171], a[148:151], 0
    v_fma_f32 v124, v124, s70, -v31
    v_fma_f32 v125, v125, s70, -v31
    v_mfma_f32_16x16x32_bf16 v[80:83], v[168:171], a[152:155], 0
    v_fma_f32 v126, v126, s70, -v31
    ds_read_b128 v[196:199], v25 offset:18432
    v_mfma_f32_16x16x32_bf16 v[72:75], v[172:175], a[156:159], v[72:75]
    v_fma_f32 v127, v127, s70, -v31
    v_exp_f32 v124, v124
    v_mfma_f32_16x16x32_bf16 v[76:79], v[172:175], a[160:163], v[76:79]
    v_exp_f32 v125, v125
    v_exp_f32 v126, v126
    v_mfma_f32_16x16x32_bf16 v[80:83], v[172:175], a[164:167], v[80:83]
    v_exp_f32 v127, v127
    ds_read_b128 v[200:203], v24 offset:18560
    s_waitcnt lgkmcnt(5)
    v_mfma_f32_16x16x32_bf16 v[72:75], v[176:179], a[168:171], v[72:75]
    v_fma_f32 v128, v128, s70, -v32
    v_fma_f32 v129, v129, s70, -v32
    v_mfma_f32_16x16x32_bf16 v[76:79], v[176:179], a[172:175], v[76:79]
    v_fma_f32 v130, v130, s70, -v32
    v_fma_f32 v131, v131, s70, -v32
    v_mfma_f32_16x16x32_bf16 v[80:83], v[176:179], a[176:179], v[80:83]
    v_exp_f32 v128, v128
    ds_read_b128 v[204:207], v25 offset:18560
    v_mfma_f32_16x16x32_bf16 v[72:75], v[180:183], a[180:183], v[72:75]
    v_exp_f32 v129, v129
    v_exp_f32 v130, v130
    v_mfma_f32_16x16x32_bf16 v[76:79], v[180:183], a[184:187], v[76:79]
    v_exp_f32 v131, v131
    v_cvt_pk_bf16_f32 v146, v108, v109
    v_mfma_f32_16x16x32_bf16 v[80:83], v[180:183], a[188:191], v[80:83]
    v_cvt_pk_bf16_f32 v147, v110, v111
    ds_read_b128 v[208:211], v24 offset:18688
    s_waitcnt lgkmcnt(5)
    v_mfma_f32_16x16x32_bf16 v[72:75], v[184:187], a[192:195], v[72:75]
    v_cvt_pk_bf16_f32 v150, v112, v113
    v_cvt_pk_bf16_f32 v151, v114, v115
    v_mfma_f32_16x16x32_bf16 v[76:79], v[184:187], a[196:199], v[76:79]
    v_cvt_pk_bf16_f32 v154, v116, v117
    v_cvt_pk_bf16_f32 v155, v118, v119
    v_mfma_f32_16x16x32_bf16 v[80:83], v[184:187], a[200:203], v[80:83]
    v_fma_f32 v132, v132, s70, -v30
    ds_read_b128 v[212:215], v25 offset:18688
    v_mfma_f32_16x16x32_bf16 v[72:75], v[188:191], a[204:207], v[72:75]
    v_fma_f32 v133, v133, s70, -v30
    v_fma_f32 v134, v134, s70, -v30
    v_mfma_f32_16x16x32_bf16 v[76:79], v[188:191], a[208:211], v[76:79]
    v_fma_f32 v135, v135, s70, -v30
    v_exp_f32 v132, v132
    v_mfma_f32_16x16x32_bf16 v[80:83], v[188:191], a[212:215], v[80:83]
    v_exp_f32 v133, v133
    s_waitcnt vmcnt(18)
    s_barrier
    v_add_u32 v26, s64, v16
    v_add_u32 v27, s64, v17
    v_add_u32 v28, s64, v18
    v_add_u32 v29, s64, v19
    ds_read_b64_tr_b16 v[168:169], v26 offset:0
    ds_read_b64_tr_b16 v[170:171], v26 offset:6144
    s_waitcnt lgkmcnt(6)
    v_mfma_f32_16x16x32_bf16 v[84:87], v[192:195], a[144:147], 0
    v_exp_f32 v134, v134
    v_exp_f32 v135, v135
    v_mfma_f32_16x16x32_bf16 v[88:91], v[192:195], a[148:151], 0
    v_fma_f32 v136, v136, s70, -v31
    v_fma_f32 v137, v137, s70, -v31
    v_mfma_f32_16x16x32_bf16 v[92:95], v[192:195], a[152:155], 0
    v_fma_f32 v138, v138, s70, -v31
    ds_read_b64_tr_b16 v[172:173], v27 offset:0
    ds_read_b64_tr_b16 v[174:175], v27 offset:6144
    v_mfma_f32_16x16x32_bf16 v[84:87], v[196:199], a[156:159], v[84:87]
    s_add_u32 m0, s62, s66
    s_add_u32 s67, s57, 384
    buffer_load_dwordx4 v216, s[36:39], s67 offen offset:0 lds
    v_fma_f32 v139, v139, s70, -v31
    v_exp_f32 v136, v136
    v_mfma_f32_16x16x32_bf16 v[88:91], v[196:199], a[160:163], v[88:91]
    v_exp_f32 v137, v137
    v_exp_f32 v138, v138
    v_mfma_f32_16x16x32_bf16 v[92:95], v[196:199], a[164:167], v[92:95]
    v_exp_f32 v139, v139
    ds_read_b64_tr_b16 v[176:177], v28 offset:0
    ds_read_b64_tr_b16 v[178:179], v28 offset:6144
    s_waitcnt lgkmcnt(8)
    v_mfma_f32_16x16x32_bf16 v[84:87], v[200:203], a[168:171], v[84:87]
    v_fma_f32 v140, v140, s70, -v32
    v_fma_f32 v141, v141, s70, -v32
    v_mfma_f32_16x16x32_bf16 v[88:91], v[200:203], a[172:175], v[88:91]
    v_fma_f32 v142, v142, s70, -v32
    v_fma_f32 v143, v143, s70, -v32
    v_mfma_f32_16x16x32_bf16 v[92:95], v[200:203], a[176:179], v[92:95]
    buffer_load_dwordx4 v217, s[36:39], s67 offen offset:1024 lds
    v_exp_f32 v140, v140
    ds_read_b64_tr_b16 v[180:181], v29 offset:0
    ds_read_b64_tr_b16 v[182:183], v29 offset:6144
    v_mfma_f32_16x16x32_bf16 v[84:87], v[204:207], a[180:183], v[84:87]
    v_exp_f32 v141, v141
    v_exp_f32 v142, v142
    v_mfma_f32_16x16x32_bf16 v[88:91], v[204:207], a[184:187], v[88:91]
    v_exp_f32 v143, v143
    v_cvt_pk_bf16_f32 v156, v120, v121
    v_mfma_f32_16x16x32_bf16 v[92:95], v[204:207], a[188:191], v[92:95]
    v_cvt_pk_bf16_f32 v157, v122, v123
    ds_read_b64_tr_b16 v[184:185], v26 offset:128
    ds_read_b64_tr_b16 v[186:187], v26 offset:6272
    s_waitcnt lgkmcnt(10)
    v_mfma_f32_16x16x32_bf16 v[84:87], v[208:211], a[192:195], v[84:87]
    v_cvt_pk_bf16_f32 v160, v124, v125
    v_cvt_pk_bf16_f32 v161, v126, v127
    v_mfma_f32_16x16x32_bf16 v[88:91], v[208:211], a[196:199], v[88:91]
    buffer_load_dwordx4 v218, s[36:39], s67 offen offset:2048 lds
    v_cvt_pk_bf16_f32 v164, v128, v129
    v_cvt_pk_bf16_f32 v165, v130, v131
    v_mfma_f32_16x16x32_bf16 v[92:95], v[208:211], a[200:203], v[92:95]
    v_cvt_pk_bf16_f32 v158, v132, v133
    ds_read_b64_tr_b16 v[188:189], v27 offset:128
    ds_read_b64_tr_b16 v[190:191], v27 offset:6272
    v_mfma_f32_16x16x32_bf16 v[84:87], v[212:215], a[204:207], v[84:87]
    v_cvt_pk_bf16_f32 v159, v134, v135
    v_cvt_pk_bf16_f32 v162, v136, v137
    v_mfma_f32_16x16x32_bf16 v[88:91], v[212:215], a[208:211], v[88:91]
    v_cvt_pk_bf16_f32 v163, v138, v139
    v_cvt_pk_bf16_f32 v166, v140, v141
    v_mfma_f32_16x16x32_bf16 v[92:95], v[212:215], a[212:215], v[92:95]
    v_cvt_pk_bf16_f32 v167, v142, v143
    ds_read_b64_tr_b16 v[192:193], v28 offset:128
    ds_read_b64_tr_b16 v[194:195], v28 offset:6272
    v_mfma_f32_16x16x32_bf16 a[216:219], v[252:255], v[144:147], a[216:219]
    v_mfma_f32_16x16x32_bf16 a[220:223], v[252:255], v[148:151], a[220:223]
    v_mfma_f32_16x16x32_bf16 a[224:227], v[252:255], v[152:155], a[224:227]
    s_waitcnt lgkmcnt(10)
    v_mfma_f32_16x16x32_bf16 a[0:3], v[168:171], v[144:147], a[0:3]
    s_add_u32 m0, m0, 3072
    s_nop 0
    buffer_load_dwordx4 v219, s[36:39], s67 offen offset:0 lds
    v_max3_f32 v36, v48, v49, v50
    v_mfma_f32_16x16x32_bf16 a[4:7], v[168:171], v[148:151], a[4:7]
    v_mfma_f32_16x16x32_bf16 a[8:11], v[168:171], v[152:155], a[8:11]
    v_max3_f32 v37, v52, v53, v54
    ds_read_b64_tr_b16 v[196:197], v29 offset:128
    ds_read_b64_tr_b16 v[198:199], v29 offset:6272
    v_mfma_f32_16x16x32_bf16 a[12:15], v[172:175], v[144:147], a[12:15]
    v_mfma_f32_16x16x32_bf16 a[16:19], v[172:175], v[148:151], a[16:19]
    v_max3_f32 v38, v56, v57, v58
    v_mfma_f32_16x16x32_bf16 a[20:23], v[172:175], v[152:155], a[20:23]
    buffer_load_dwordx4 v220, s[36:39], s67 offen offset:1024 lds
    ds_read_b64_tr_b16 v[200:201], v26 offset:256
    ds_read_b64_tr_b16 v[202:203], v26 offset:6400
    s_waitcnt lgkmcnt(10)
    v_mfma_f32_16x16x32_bf16 a[24:27], v[176:179], v[144:147], a[24:27]
    v_mfma_f32_16x16x32_bf16 a[28:31], v[176:179], v[148:151], a[28:31]
    v_max3_f32 v36, v36, v51, v60
    v_mfma_f32_16x16x32_bf16 a[32:35], v[176:179], v[152:155], a[32:35]
    ds_read_b64_tr_b16 v[204:205], v27 offset:256
    ds_read_b64_tr_b16 v[206:207], v27 offset:6400
    v_mfma_f32_16x16x32_bf16 a[36:39], v[180:183], v[144:147], a[36:39]
    v_max3_f32 v37, v37, v55, v64
    v_mfma_f32_16x16x32_bf16 a[40:43], v[180:183], v[148:151], a[40:43]
    buffer_load_dwordx4 v221, s[36:39], s67 offen offset:2048 lds
    v_mfma_f32_16x16x32_bf16 a[44:47], v[180:183], v[152:155], a[44:47]
    ds_read_b64_tr_b16 v[208:209], v28 offset:256
    ds_read_b64_tr_b16 v[210:211], v28 offset:6400
    s_waitcnt lgkmcnt(10)
    v_mfma_f32_16x16x32_bf16 a[48:51], v[184:187], v[144:147], a[48:51]
    v_max3_f32 v38, v38, v59, v68
    v_mfma_f32_16x16x32_bf16 a[52:55], v[184:187], v[148:151], a[52:55]
    v_mfma_f32_16x16x32_bf16 a[56:59], v[184:187], v[152:155], a[56:59]
    v_max3_f32 v36, v36, v61, v62
    ds_read_b64_tr_b16 v[212:213], v29 offset:256
    ds_read_b64_tr_b16 v[214:215], v29 offset:6400
    v_mfma_f32_16x16x32_bf16 a[60:63], v[188:191], v[144:147], a[60:63]
    v_mfma_f32_16x16x32_bf16 a[64:67], v[188:191], v[148:151], a[64:67]
    v_mfma_f32_16x16x32_bf16 a[68:71], v[188:191], v[152:155], a[68:71]
    v_max3_f32 v37, v37, v65, v66
    ds_read_b64_tr_b16 v[168:169], v26 offset:12288
    ds_read_b64_tr_b16 v[170:171], v26 offset:18432
    s_waitcnt lgkmcnt(10)
    v_mfma_f32_16x16x32_bf16 a[72:75], v[192:195], v[144:147], a[72:75]
    v_mfma_f32_16x16x32_bf16 a[76:79], v[192:195], v[148:151], a[76:79]
    v_max3_f32 v38, v38, v69, v70
    v_mfma_f32_16x16x32_bf16 a[80:83], v[192:195], v[152:155], a[80:83]
    ds_read_b64_tr_b16 v[172:173], v27 offset:12288
    ds_read_b64_tr_b16 v[174:175], v27 offset:18432
    v_mfma_f32_16x16x32_bf16 a[84:87], v[196:199], v[144:147], a[84:87]
    v_mfma_f32_16x16x32_bf16 a[88:91], v[196:199], v[148:151], a[88:91]
    v_max3_f32 v36, v36, v63, v72
    v_mfma_f32_16x16x32_bf16 a[92:95], v[196:199], v[152:155], a[92:95]
    ds_read_b64_tr_b16 v[176:177], v28 offset:12288
    ds_read_b64_tr_b16 v[178:179], v28 offset:18432
    s_waitcnt lgkmcnt(10)
    v_mfma_f32_16x16x32_bf16 a[96:99], v[200:203], v[144:147], a[96:99]
    v_max3_f32 v37, v37, v67, v76
    v_mfma_f32_16x16x32_bf16 a[100:103], v[200:203], v[148:151], a[100:103]
    v_mfma_f32_16x16x32_bf16 a[104:107], v[200:203], v[152:155], a[104:107]
    ds_read_b64_tr_b16 v[180:181], v29 offset:12288
    ds_read_b64_tr_b16 v[182:183], v29 offset:18432
    v_mfma_f32_16x16x32_bf16 a[108:111], v[204:207], v[144:147], a[108:111]
    v_max3_f32 v38, v38, v71, v80
    v_mfma_f32_16x16x32_bf16 a[112:115], v[204:207], v[148:151], a[112:115]
    v_mfma_f32_16x16x32_bf16 a[116:119], v[204:207], v[152:155], a[116:119]
    v_max3_f32 v36, v36, v73, v74
    ds_read_b64_tr_b16 v[184:185], v26 offset:12416
    ds_read_b64_tr_b16 v[186:187], v26 offset:18560
    s_waitcnt lgkmcnt(10)
    v_mfma_f32_16x16x32_bf16 a[120:123], v[208:211], v[144:147], a[120:123]
    v_mfma_f32_16x16x32_bf16 a[124:127], v[208:211], v[148:151], a[124:127]
    v_mfma_f32_16x16x32_bf16 a[128:131], v[208:211], v[152:155], a[128:131]
    v_max3_f32 v37, v37, v77, v78
    ds_read_b64_tr_b16 v[188:189], v27 offset:12416
    ds_read_b64_tr_b16 v[190:191], v27 offset:18560
    v_mfma_f32_16x16x32_bf16 a[132:135], v[212:215], v[144:147], a[132:135]
    v_mfma_f32_16x16x32_bf16 a[136:139], v[212:215], v[148:151], a[136:139]
    v_max3_f32 v38, v38, v81, v82
    v_mfma_f32_16x16x32_bf16 a[140:143], v[212:215], v[152:155], a[140:143]
    ds_read_b64_tr_b16 v[192:193], v28 offset:12416
    ds_read_b64_tr_b16 v[194:195], v28 offset:18560
    v_mfma_f32_16x16x32_bf16 a[216:219], v[252:255], v[156:159], a[216:219]
    v_mfma_f32_16x16x32_bf16 a[220:223], v[252:255], v[160:163], a[220:223]
    v_mfma_f32_16x16x32_bf16 a[224:227], v[252:255], v[164:167], a[224:227]
    s_waitcnt lgkmcnt(10)
    v_mfma_f32_16x16x32_bf16 a[0:3], v[168:171], v[156:159], a[0:3]
    v_mfma_f32_16x16x32_bf16 a[4:7], v[168:171], v[160:163], a[4:7]
    v_max3_f32 v36, v36, v75, v84
    v_mfma_f32_16x16x32_bf16 a[8:11], v[168:171], v[164:167], a[8:11]
    ds_read_b64_tr_b16 v[196:197], v29 offset:12416
    ds_read_b64_tr_b16 v[198:199], v29 offset:18560
    v_mfma_f32_16x16x32_bf16 a[12:15], v[172:175], v[156:159], a[12:15]
    v_max3_f32 v37, v37, v79, v88
    v_mfma_f32_16x16x32_bf16 a[16:19], v[172:175], v[160:163], a[16:19]
    v_mfma_f32_16x16x32_bf16 a[20:23], v[172:175], v[164:167], a[20:23]
    ds_read_b64_tr_b16 v[200:201], v26 offset:12544
    ds_read_b64_tr_b16 v[202:203], v26 offset:18688
    s_waitcnt lgkmcnt(10)
    v_mfma_f32_16x16x32_bf16 a[24:27], v[176:179], v[156:159], a[24:27]
    v_max3_f32 v38, v38, v83, v92
    v_mfma_f32_16x16x32_bf16 a[28:31], v[176:179], v[160:163], a[28:31]
    v_mfma_f32_16x16x32_bf16 a[32:35], v[176:179], v[164:167], a[32:35]
    v_max3_f32 v36, v36, v85, v86
    ds_read_b64_tr_b16 v[204:205], v27 offset:12544
    ds_read_b64_tr_b16 v[206:207], v27 offset:18688
    v_mfma_f32_16x16x32_bf16 a[36:39], v[180:183], v[156:159], a[36:39]
    v_mfma_f32_16x16x32_bf16 a[40:43], v[180:183], v[160:163], a[40:43]
    v_mfma_f32_16x16x32_bf16 a[44:47], v[180:183], v[164:167], a[44:47]
    v_max3_f32 v37, v37, v89, v90
    ds_read_b64_tr_b16 v[208:209], v28 offset:12544
    ds_read_b64_tr_b16 v[210:211], v28 offset:18688
    s_waitcnt lgkmcnt(10)
    v_mfma_f32_16x16x32_bf16 a[48:51], v[184:187], v[156:159], a[48:51]
    v_mfma_f32_16x16x32_bf16 a[52:55], v[184:187], v[160:163], a[52:55]
    v_max3_f32 v38, v38, v93, v94
    v_mfma_f32_16x16x32_bf16 a[56:59], v[184:187], v[164:167], a[56:59]
    ds_read_b64_tr_b16 v[212:213], v29 offset:12544
    ds_read_b64_tr_b16 v[214:215], v29 offset:18688
    v_mfma_f32_16x16x32_bf16 a[60:63], v[188:191], v[156:159], a[60:63]
    v_mfma_f32_16x16x32_bf16 a[64:67], v[188:191], v[160:163], a[64:67]
    v_max_f32 v36, v36, v87
    v_mfma_f32_16x16x32_bf16 a[68:71], v[188:191], v[164:167], a[68:71]
    s_waitcnt vmcnt(18)
    s_barrier
    v_add_u32 v24, s65, v14
    v_add_u32 v25, s65, v15
    ds_read_b128 v[168:171], v24 offset:0
    s_waitcnt lgkmcnt(9)
    v_mfma_f32_16x16x32_bf16 a[72:75], v[192:195], v[156:159], a[72:75]
    v_max_f32 v37, v37, v91
    v_mfma_f32_16x16x32_bf16 a[76:79], v[192:195], v[160:163], a[76:79]
    s_add_u32 m0, s63, s66
    s_add_u32 s67, s57, 786816
    buffer_load_dwordx4 v216, s[36:39], s67 offen offset:0 lds
    v_mfma_f32_16x16x32_bf16 a[80:83], v[192:195], v[164:167], a[80:83]
    ds_read_b128 v[172:175], v25 offset:0
    v_mfma_f32_16x16x32_bf16 a[84:87], v[196:199], v[156:159], a[84:87]
    v_max_f32 v38, v38, v95
    v_mfma_f32_16x16x32_bf16 a[88:91], v[196:199], v[160:163], a[88:91]
    v_mfma_f32_16x16x32_bf16 a[92:95], v[196:199], v[164:167], a[92:95]
    v_fma_f32 v39, v36, s70, -v30
    ds_read_b128 v[176:179], v24 offset:128
    s_waitcnt lgkmcnt(7)
    v_mfma_f32_16x16x32_bf16 a[96:99], v[200:203], v[156:159], a[96:99]
    buffer_load_dwordx4 v217, s[36:39], s67 offen offset:1024 lds
    v_mfma_f32_16x16x32_bf16 a[100:103], v[200:203], v[160:163], a[100:103]
    v_mfma_f32_16x16x32_bf16 a[104:107], v[200:203], v[164:167], a[104:107]
    v_fma_f32 v40, v37, s70, -v31
    ds_read_b128 v[180:183], v25 offset:128
    v_mfma_f32_16x16x32_bf16 a[108:111], v[204:207], v[156:159], a[108:111]
    v_mfma_f32_16x16x32_bf16 a[112:115], v[204:207], v[160:163], a[112:115]
    v_fma_f32 v41, v38, s70, -v32
    v_mfma_f32_16x16x32_bf16 a[116:119], v[204:207], v[164:167], a[116:119]
    buffer_load_dwordx4 v218, s[36:39], s67 offen offset:2048 lds
    ds_read_b128 v[184:187], v24 offset:256
    s_waitcnt lgkmcnt(5)
    v_mfma_f32_16x16x32_bf16 a[120:123], v[208:211], v[156:159], a[120:123]
    v_mfma_f32_16x16x32_bf16 a[124:127], v[208:211], v[160:163], a[124:127]
    v_max3_f32 v39, v39, v40, v41
    v_mfma_f32_16x16x32_bf16 a[128:131], v[208:211], v[164:167], a[128:131]
    ds_read_b128 v[188:191], v25 offset:256
    v_mfma_f32_16x16x32_bf16 a[132:135], v[212:215], v[156:159], a[132:135]
    v_cmp_lt_f32 s[78:79], s71, v39
    v_mfma_f32_16x16x32_bf16 a[136:139], v[212:215], v[160:163], a[136:139]
    s_add_u32 m0, m0, 3072
    s_nop 0
    buffer_load_dwordx4 v219, s[36:39], s67 offen offset:0 lds
    v_mfma_f32_16x16x32_bf16 a[140:143], v[212:215], v[164:167], a[140:143]
    s_cmp_lg_u64 s[78:79], 0
    s_cbranch_scc0 L1_skip5
    s_swappc_b64 s[72:73], s[74:75]
L1_skip5:
    ds_read_b128 v[192:195], v24 offset:6144
    s_waitcnt lgkmcnt(5)
    v_mfma_f32_16x16x32_bf16 v[96:99], v[168:171], a[144:147], 0
    v_fma_f32 v48, v48, s70, -v30
    v_fma_f32 v49, v49, s70, -v30
    v_mfma_f32_16x16x32_bf16 v[100:103], v[168:171], a[148:151], 0
    v_fma_f32 v50, v50, s70, -v30
    v_fma_f32 v51, v51, s70, -v30
    v_mfma_f32_16x16x32_bf16 v[104:107], v[168:171], a[152:155], 0
    v_exp_f32 v48, v48
    ds_read_b128 v[196:199], v25 offset:6144
    v_mfma_f32_16x16x32_bf16 v[96:99], v[172:175], a[156:159], v[96:99]
    buffer_load_dwordx4 v220, s[36:39], s67 offen offset:1024 lds
    v_exp_f32 v49, v49
    v_exp_f32 v50, v50
    v_mfma_f32_16x16x32_bf16 v[100:103], v[172:175], a[160:163], v[100:103]
    v_exp_f32 v51, v51
    v_fma_f32 v52, v52, s70, -v31
    v_mfma_f32_16x16x32_bf16 v[104:107], v[172:175], a[164:167], v[104:107]
    v_fma_f32 v53, v53, s70, -v31
    ds_read_b128 v[200:203], v24 offset:6272
    s_waitcnt lgkmcnt(5)
    v_mfma_f32_16x16x32_bf16 v[96:99], v[176:179], a[168:171], v[96:99]
    v_fma_f32 v54, v54, s70, -v31
    v_fma_f32 v55, v55, s70, -v31
    v_mfma_f32_16x16x32_bf16 v[100:103], v[176:179], a[172:175], v[100:103]
    v_exp_f32 v52, v52
    v_exp_f32 v53, v53
    v_mfma_f32_16x16x32_bf16 v[104:107], v[176:179], a[176:179], v[104:107]
    buffer_load_dwordx4 v221, s[36:39], s67 offen offset:2048 lds
    v_exp_f32 v54, v54
    ds_read_b128 v[204:207], v25 offset:6272
    v_mfma_f32_16x16x32_bf16 v[96:99], v[180:183], a[180:183], v[96:99]
    v_exp_f32 v55, v55
    v_fma_f32 v56, v56, s70, -v32
    v_mfma_f32_16x16x32_bf16 v[100:103], v[180:183], a[184:187], v[100:103]
    v_fma_f32 v57, v57, s70, -v32
    v_fma_f32 v58, v58, s70, -v32
    v_mfma_f32_16x16x32_bf16 v[104:107], v[180:183], a[188:191], v[104:107]
    v_fma_f32 v59, v59, s70, -v32
    ds_read_b128 v[208:211], v24 offset:6400
    s_waitcnt lgkmcnt(5)
    v_mfma_f32_16x16x32_bf16 v[96:99], v[184:187], a[192:195], v[96:99]
    v_exp_f32 v56, v56
    v_exp_f32 v57, v57
    v_mfma_f32_16x16x32_bf16 v[100:103], v[184:187], a[196:199], v[100:103]
    buffer_load_dword v224, v240, s[24:27], s77 offen offset:0
    s_add_u32 s77, s77, 4096
    v_exp_f32 v58, v58
    v_exp_f32 v59, v59
    v_mfma_f32_16x16x32_bf16 v[104:107], v[184:187], a[200:203], v[104:107]
    v_fma_f32 v60, v60, s70, -v30
    ds_read_b128 v[212:215], v25 offset:6400
    v_mfma_f32_16x16x32_bf16 v[96:99], v[188:191], a[204:207], v[96:99]
    v_fma_f32 v61, v61, s70, -v30
    v_fma_f32 v62, v62, s70, -v30
    v_mfma_f32_16x16x32_bf16 v[100:103], v[188:191], a[208:211], v[100:103]
    v_fma_f32 v63, v63, s70, -v30
    v_exp_f32 v60, v60
    v_mfma_f32_16x16x32_bf16 v[104:107], v[188:191], a[212:215], v[104:107]
    v_exp_f32 v61, v61
    ds_read_b128 v[168:171], v24 offset:12288
    s_waitcnt lgkmcnt(5)
    v_mfma_f32_16x16x32_bf16 v[108:111], v[192:195], a[144:147], 0
    buffer_load_dword v225, v240, s[24:27], s77 offen offset:0
    s_add_u32 s77, s77, 4096
    v_exp_f32 v62, v62
    v_exp_f32 v63, v63
    v_mfma_f32_16x16x32_bf16 v[112:115], v[192:195], a[148:151], 0
    v_fma_f32 v64, v64, s70, -v31
    v_fma_f32 v65, v65, s70, -v31
    v_mfma_f32_16x16x32_bf16 v[116:119], v[192:195], a[152:155], 0
    v_fma_f32 v66, v66, s70, -v31
    ds_read_b128 v[172:175], v25 offset:12288
    v_mfma_f32_16x16x32_bf16 v[108:111], v[196:199], a[156:159], v[108:111]
    v_fma_f32 v67, v67, s70, -v31
    v_exp_f32 v64, v64
    v_mfma_f32_16x16x32_bf16 v[112:115], v[196:199], a[160:163], v[112:115]
    v_exp_f32 v65, v65
    v_exp_f32 v66, v66
    v_mfma_f32_16x16x32_bf16 v[116:119], v[196:199], a[164:167], v[116:119]
    buffer_load_dword v226, v240, s[24:27], s77 offen offset:0
    s_add_u32 s77, s77, 4096
    v_exp_f32 v67, v67
    ds_read_b128 v[176:179], v24 offset:12416
    s_waitcnt lgkmcnt(5)
    v_mfma_f32_16x16x32_bf16 v[108:111], v[200:203], a[168:171], v[108:111]
    v_fma_f32 v68, v68, s70, -v32
    v_fma_f32 v69, v69, s70, -v32
    v_mfma_f32_16x16x32_bf16 v[112:115], v[200:203], a[172:175], v[112:115]
    v_fma_f32 v70, v70, s70, -v32
    v_fma_f32 v71, v71, s70, -v32
    v_mfma_f32_16x16x32_bf16 v[116:119], v[200:203], a[176:179], v[116:119]
    v_exp_f32 v68, v68
    ds_read_b128 v[180:183], v25 offset:12416
    v_mfma_f32_16x16x32_bf16 v[108:111], v[204:207], a[180:183], v[108:111]
    v_exp_f32 v69, v69
    v_exp_f32 v70, v70
    v_mfma_f32_16x16x32_bf16 v[112:115], v[204:207], a[184:187], v[112:115]
    buffer_load_dword v227, v240, s[24:27], s77 offen offset:0
    s_add_u32 s77, s77, 4096
    v_exp_f32 v71, v71
    v_cvt_pk_bf16_f32 v144, v48, v49
    v_mfma_f32_16x16x32_bf16 v[116:119], v[204:207], a[188:191], v[116:119]
    v_cvt_pk_bf16_f32 v145, v50, v51
    ds_read_b128 v[184:187], v24 offset:12544
    s_waitcnt lgkmcnt(5)
    v_mfma_f32_16x16x32_bf16 v[108:111], v[208:211], a[192:195], v[108:111]
    v_cvt_pk_bf16_f32 v148, v52, v53
    v_cvt_pk_bf16_f32 v149, v54, v55
    v_mfma_f32_16x16x32_bf16 v[112:115], v[208:211], a[196:199], v[112:115]
    v_cvt_pk_bf16_f32 v152, v56, v57
    v_cvt_pk_bf16_f32 v153, v58, v59
    v_mfma_f32_16x16x32_bf16 v[116:119], v[208:211], a[200:203], v[116:119]
    v_fma_f32 v72, v72, s70, -v30
    ds_read_b128 v[188:191], v25 offset:12544
    v_mfma_f32_16x16x32_bf16 v[108:111], v[212:215], a[204:207], v[108:111]
    v_fma_f32 v73, v73, s70, -v30
    v_fma_f32 v74, v74, s70, -v30
    v_mfma_f32_16x16x32_bf16 v[112:115], v[212:215], a[208:211], v[112:115]
    v_fma_f32 v75, v75, s70, -v30
    v_exp_f32 v72, v72
    v_mfma_f32_16x16x32_bf16 v[116:119], v[212:215], a[212:215], v[116:119]
    v_exp_f32 v73, v73
    ds_read_b128 v[192:195], v24 offset:18432
    s_waitcnt lgkmcnt(5)
    v_mfma_f32_16x16x32_bf16 v[120:123], v[168:171], a[144:147], 0
    v_exp_f32 v74, v74
    v_exp_f32 v75, v75
    v_mfma_f32_16x16x32_bf16 v[124:127], v[168:171], a[148:151], 0
    v_fma_f32 v76, v76, s70, -v31
    v_fma_f32 v77, v77, s70, -v31
    v_mfma_f32_16x16x32_bf16 v[128:131], v[168:171], a[152:155], 0
    v_fma_f32 v78, v78, s70, -v31
    ds_read_b128 v[196:199], v25 offset:18432
    v_mfma_f32_16x16x32_bf16 v[120:123], v[172:175], a[156:159], v[120:123]
    v_fma_f32 v79, v79, s70, -v31
    v_exp_f32 v76, v76
    v_mfma_f32_16x16x32_bf16 v[124:127], v[172:175], a[160:163], v[124:127]
    v_exp_f32 v77, v77
    v_exp_f32 v78, v78
    v_mfma_f32_16x16x32_bf16 v[128:131], v[172:175], a[164:167], v[128:131]
    v_exp_f32 v79, v79
    ds_read_b128 v[200:203], v24 offset:18560
    s_waitcnt lgkmcnt(5)
    v_mfma_f32_16x16x32_bf16 v[120:123], v[176:179], a[168:171], v[120:123]
    v_fma_f32 v80, v80, s70, -v32
    v_fma_f32 v81, v81, s70, -v32
    v_mfma_f32_16x16x32_bf16 v[124:127], v[176:179], a[172:175], v[124:127]
    v_fma_f32 v82, v82, s70, -v32
    v_fma_f32 v83, v83, s70, -v32
    v_mfma_f32_16x16x32_bf16 v[128:131], v[176:179], a[176:179], v[128:131]
    v_exp_f32 v80, v80
    ds_read_b128 v[204:207], v25 offset:18560
    v_mfma_f32_16x16x32_bf16 v[120:123], v[180:183], a[180:183], v[120:123]
    v_exp_f32 v81, v81
    v_exp_f32 v82, v82
    v_mfma_f32_16x16x32_bf16 v[124:127], v[180:183], a[184:187], v[124:127]
    v_exp_f32 v83, v83
    v_cvt_pk_bf16_f32 v146, v60, v61
    v_mfma_f32_16x16x32_bf16 v[128:131], v[180:183], a[188:191], v[128:131]
    v_cvt_pk_bf16_f32 v147, v62, v63
    ds_read_b128 v[208:211], v24 offset:18688
    s_waitcnt lgkmcnt(5)
    v_mfma_f32_16x16x32_bf16 v[120:123], v[184:187], a[192:195], v[120:123]
    v_cvt_pk_bf16_f32 v150, v64, v65
    v_cvt_pk_bf16_f32 v151, v66, v67
    v_mfma_f32_16x16x32_bf16 v[124:127], v[184:187], a[196:199], v[124:127]
    v_cvt_pk_bf16_f32 v154, v68, v69
    v_cvt_pk_bf16_f32 v155, v70, v71
    v_mfma_f32_16x16x32_bf16 v[128:131], v[184:187], a[200:203], v[128:131]
    v_fma_f32 v84, v84, s70, -v30
    ds_read_b128 v[212:215], v25 offset:18688
    v_mfma_f32_16x16x32_bf16 v[120:123], v[188:191], a[204:207], v[120:123]
    v_fma_f32 v85, v85, s70, -v30
    v_fma_f32 v86, v86, s70, -v30
    v_mfma_f32_16x16x32_bf16 v[124:127], v[188:191], a[208:211], v[124:127]
    v_fma_f32 v87, v87, s70, -v30
    v_exp_f32 v84, v84
    v_mfma_f32_16x16x32_bf16 v[128:131], v[188:191], a[212:215], v[128:131]
    v_exp_f32 v85, v85
    s_waitcnt vmcnt(22)
    s_barrier
    v_add_u32 v26, s60, v16
    v_add_u32 v27, s60, v17
    v_add_u32 v28, s60, v18
    v_add_u32 v29, s60, v19
    ds_read_b64_tr_b16 v[168:169], v26 offset:0
    ds_read_b64_tr_b16 v[170:171], v26 offset:6144
    s_waitcnt lgkmcnt(6)
    v_mfma_f32_16x16x32_bf16 v[132:135], v[192:195], a[144:147], 0
    v_exp_f32 v86, v86
    v_exp_f32 v87, v87
    v_mfma_f32_16x16x32_bf16 v[136:139], v[192:195], a[148:151], 0
    v_fma_f32 v88, v88, s70, -v31
    v_fma_f32 v89, v89, s70, -v31
    v_mfma_f32_16x16x32_bf16 v[140:143], v[192:195], a[152:155], 0
    v_fma_f32 v90, v90, s70, -v31
    ds_read_b64_tr_b16 v[172:173], v27 offset:0
    ds_read_b64_tr_b16 v[174:175], v27 offset:6144
    v_mfma_f32_16x16x32_bf16 v[132:135], v[196:199], a[156:159], v[132:135]
    v_fma_f32 v91, v91, s70, -v31
    v_exp_f32 v88, v88
    v_mfma_f32_16x16x32_bf16 v[136:139], v[196:199], a[160:163], v[136:139]
    s_add_u32 m0, s64, s66
    s_add_u32 s67, s57, 1573248
    buffer_load_dwordx4 v216, s[36:39], s67 offen offset:0 lds
    v_exp_f32 v89, v89
    v_exp_f32 v90, v90
    v_mfma_f32_16x16x32_bf16 v[140:143], v[196:199], a[164:167], v[140:143]
    v_exp_f32 v91, v91
    ds_read_b64_tr_b16 v[176:177], v28 offset:0
    ds_read_b64_tr_b16 v[178:179], v28 offset:6144
    s_waitcnt lgkmcnt(8)
    v_mfma_f32_16x16x32_bf16 v[132:135], v[200:203], a[168:171], v[132:135]
    v_fma_f32 v92, v92, s70, -v32
    v_fma_f32 v93, v93, s70, -v32
    v_mfma_f32_16x16x32_bf16 v[136:139], v[200:203], a[172:175], v[136:139]
    v_fma_f32 v94, v94, s70, -v32
    v_fma_f32 v95, v95, s70, -v32
    v_mfma_f32_16x16x32_bf16 v[140:143], v[200:203], a[176:179], v[140:143]
    v_exp_f32 v92, v92
    ds_read_b64_tr_b16 v[180:181], v29 offset:0
    ds_read_b64_tr_b16 v[182:183], v29 offset:6144
    v_mfma_f32_16x16x32_bf16 v[132:135], v[204:207], a[180:183], v[132:135]
    buffer_load_dwordx4 v217, s[36:39], s67 offen offset:1024 lds
    v_exp_f32 v93, v93
    v_exp_f32 v94, v94
    v_mfma_f32_16x16x32_bf16 v[136:139], v[204:207], a[184:187], v[136:139]
    v_exp_f32 v95, v95
    v_cvt_pk_bf16_f32 v156, v72, v73
    v_mfma_f32_16x16x32_bf16 v[140:143], v[204:207], a[188:191], v[140:143]
    v_cvt_pk_bf16_f32 v157, v74, v75
    ds_read_b64_tr_b16 v[184:185], v26 offset:128
    ds_read_b64_tr_b16 v[186:187], v26 offset:6272
    s_waitcnt lgkmcnt(10)
    v_mfma_f32_16x16x32_bf16 v[132:135], v[208:211], a[192:195], v[132:135]
    v_cvt_pk_bf16_f32 v160, v76, v77
    v_cvt_pk_bf16_f32 v161, v78, v79
    v_mfma_f32_16x16x32_bf16 v[136:139], v[208:211], a[196:199], v[136:139]
    v_cvt_pk_bf16_f32 v164, v80, v81
    v_cvt_pk_bf16_f32 v165, v82, v83
    v_mfma_f32_16x16x32_bf16 v[140:143], v[208:211], a[200:203], v[140:143]
    buffer_load_dwordx4 v218, s[36:39], s67 offen offset:2048 lds
    v_cvt_pk_bf16_f32 v158, v84, v85
    ds_read_b64_tr_b16 v[188:189], v27 offset:128
    ds_read_b64_tr_b16 v[190:191], v27 offset:6272
    v_mfma_f32_16x16x32_bf16 v[132:135], v[212:215], a[204:207], v[132:135]
    v_cvt_pk_bf16_f32 v159, v86, v87
    v_cvt_pk_bf16_f32 v162, v88, v89
    v_mfma_f32_16x16x32_bf16 v[136:139], v[212:215], a[208:211], v[136:139]
    v_cvt_pk_bf16_f32 v163, v90, v91
    v_cvt_pk_bf16_f32 v166, v92, v93
    v_mfma_f32_16x16x32_bf16 v[140:143], v[212:215], a[212:215], v[140:143]
    v_cvt_pk_bf16_f32 v167, v94, v95
    ds_read_b64_tr_b16 v[192:193], v28 offset:128
    ds_read_b64_tr_b16 v[194:195], v28 offset:6272
    v_mfma_f32_16x16x32_bf16 a[216:219], v[252:255], v[144:147], a[216:219]
    v_mfma_f32_16x16x32_bf16 a[220:223], v[252:255], v[148:151], a[220:223]
    v_mfma_f32_16x16x32_bf16 a[224:227], v[252:255], v[152:155], a[224:227]
    s_waitcnt lgkmcnt(10)
    v_mfma_f32_16x16x32_bf16 a[0:3], v[168:171], v[144:147], a[0:3]
    v_max3_f32 v36, v96, v97, v98
    v_mfma_f32_16x16x32_bf16 a[4:7], v[168:171], v[148:151], a[4:7]
    s_add_u32 m0, m0, 3072
    s_nop 0
    buffer_load_dwordx4 v219, s[36:39], s67 offen offset:0 lds
    v_mfma_f32_16x16x32_bf16 a[8:11], v[168:171], v[152:155], a[8:11]
    v_max3_f32 v37, v100, v101, v102
    ds_read_b64_tr_b16 v[196:197], v29 offset:128
    ds_read_b64_tr_b16 v[198:199], v29 offset:6272
    v_mfma_f32_16x16x32_bf16 a[12:15], v[172:175], v[144:147], a[12:15]
    v_mfma_f32_16x16x32_bf16 a[16:19], v[172:175], v[148:151], a[16:19]
    v_max3_f32 v38, v104, v105, v106
    v_mfma_f32_16x16x32_bf16 a[20:23], v[172:175], v[152:155], a[20:23]
    ds_read_b64_tr_b16 v[200:201], v26 offset:256
    ds_read_b64_tr_b16 v[202:203], v26 offset:6400
    s_waitcnt lgkmcnt(10)
    v_mfma_f32_16x16x32_bf16 a[24:27], v[176:179], v[144:147], a[24:27]
    buffer_load_dwordx4 v220, s[36:39], s67 offen offset:1024 lds
    v_mfma_f32_16x16x32_bf16 a[28:31], v[176:179], v[148:151], a[28:31]
    v_max3_f32 v36, v36, v99, v108
    v_mfma_f32_16x16x32_bf16 a[32:35], v[176:179], v[152:155], a[32:35]
    ds_read_b64_tr_b16 v[204:205], v27 offset:256
    ds_read_b64_tr_b16 v[206:207], v27 offset:6400
    v_mfma_f32_16x16x32_bf16 a[36:39], v[180:183], v[144:147], a[36:39]
    v_max3_f32 v37, v37, v103, v112
    v_mfma_f32_16x16x32_bf16 a[40:43], v[180:183], v[148:151], a[40:43]
    v_mfma_f32_16x16x32_bf16 a[44:47], v[180:183], v[152:155], a[44:47]
    buffer_load_dwordx4 v221, s[36:39], s67 offen offset:2048 lds
    ds_read_b64_tr_b16 v[208:209], v28 offset:256
    ds_read_b64_tr_b16 v[210:211], v28 offset:6400
    s_waitcnt lgkmcnt(10)
    v_mfma_f32_16x16x32_bf16 a[48:51], v[184:187], v[144:147], a[48:51]
    v_max3_f32 v38, v38, v107, v116
    v_mfma_f32_16x16x32_bf16 a[52:55], v[184:187], v[148:151], a[52:55]
    v_mfma_f32_16x16x32_bf16 a[56:59], v[184:187], v[152:155], a[56:59]
    v_max3_f32 v36, v36, v109, v110
    ds_read_b64_tr_b16 v[212:213], v29 offset:256
    ds_read_b64_tr_b16 v[214:215], v29 offset:6400
    v_mfma_f32_16x16x32_bf16 a[60:63], v[188:191], v[144:147], a[60:63]
    v_mfma_f32_16x16x32_bf16 a[64:67], v[188:191], v[148:151], a[64:67]
    v_mfma_f32_16x16x32_bf16 a[68:71], v[188:191], v[152:155], a[68:71]
    v_max3_f32 v37, v37, v113, v114
    ds_read_b64_tr_b16 v[168:169], v26 offset:12288
    ds_read_b64_tr_b16 v[170:171], v26 offset:18432
    s_waitcnt lgkmcnt(10)
    v_mfma_f32_16x16x32_bf16 a[72:75], v[192:195], v[144:147], a[72:75]
    v_mfma_f32_16x16x32_bf16 a[76:79], v[192:195], v[148:151], a[76:79]
    v_max3_f32 v38, v38, v117, v118
    v_mfma_f32_16x16x32_bf16 a[80:83], v[192:195], v[152:155], a[80:83]
    ds_read_b64_tr_b16 v[172:173], v27 offset:12288
    ds_read_b64_tr_b16 v[174:175], v27 offset:18432
    v_mfma_f32_16x16x32_bf16 a[84:87], v[196:199], v[144:147], a[84:87]
    v_mfma_f32_16x16x32_bf16 a[88:91], v[196:199], v[148:151], a[88:91]
    v_max3_f32 v36, v36, v111, v120
    v_mfma_f32_16x16x32_bf16 a[92:95], v[196:199], v[152:155], a[92:95]
    ds_read_b64_tr_b16 v[176:177], v28 offset:12288
    ds_read_b64_tr_b16 v[178:179], v28 offset:18432
    s_waitcnt lgkmcnt(10)
    v_mfma_f32_16x16x32_bf16 a[96:99], v[200:203], v[144:147], a[96:99]
    v_max3_f32 v37, v37, v115, v124
    v_mfma_f32_16x16x32_bf16 a[100:103], v[200:203], v[148:151], a[100:103]
    v_mfma_f32_16x16x32_bf16 a[104:107], v[200:203], v[152:155], a[104:107]
    ds_read_b64_tr_b16 v[180:181], v29 offset:12288
    ds_read_b64_tr_b16 v[182:183], v29 offset:18432
    v_mfma_f32_16x16x32_bf16 a[108:111], v[204:207], v[144:147], a[108:111]
    v_max3_f32 v38, v38, v119, v128
    v_mfma_f32_16x16x32_bf16 a[112:115], v[204:207], v[148:151], a[112:115]
    v_mfma_f32_16x16x32_bf16 a[116:119], v[204:207], v[152:155], a[116:119]
    v_max3_f32 v36, v36, v121, v122
    ds_read_b64_tr_b16 v[184:185], v26 offset:12416
    ds_read_b64_tr_b16 v[186:187], v26 offset:18560
    s_waitcnt lgkmcnt(10)
    v_mfma_f32_16x16x32_bf16 a[120:123], v[208:211], v[144:147], a[120:123]
    v_mfma_f32_16x16x32_bf16 a[124:127], v[208:211], v[148:151], a[124:127]
    v_mfma_f32_16x16x32_bf16 a[128:131], v[208:211], v[152:155], a[128:131]
    v_max3_f32 v37, v37, v125, v126
    ds_read_b64_tr_b16 v[188:189], v27 offset:12416
    ds_read_b64_tr_b16 v[190:191], v27 offset:18560
    v_mfma_f32_16x16x32_bf16 a[132:135], v[212:215], v[144:147], a[132:135]
    v_mfma_f32_16x16x32_bf16 a[136:139], v[212:215], v[148:151], a[136:139]
    v_max3_f32 v38, v38, v129, v130
    v_mfma_f32_16x16x32_bf16 a[140:143], v[212:215], v[152:155], a[140:143]
    ds_read_b64_tr_b16 v[192:193], v28 offset:12416
    ds_read_b64_tr_b16 v[194:195], v28 offset:18560
    v_mfma_f32_16x16x32_bf16 a[216:219], v[252:255], v[156:159], a[216:219]
    v_mfma_f32_16x16x32_bf16 a[220:223], v[252:255], v[160:163], a[220:223]
    v_mfma_f32_16x16x32_bf16 a[224:227], v[252:255], v[164:167], a[224:227]
    s_waitcnt lgkmcnt(10)
    v_mfma_f32_16x16x32_bf16 a[0:3], v[168:171], v[156:159], a[0:3]
    v_mfma_f32_16x16x32_bf16 a[4:7], v[168:171], v[160:163], a[4:7]
    v_max3_f32 v36, v36, v123, v132
    v_mfma_f32_16x16x32_bf16 a[8:11], v[168:171], v[164:167], a[8:11]
    ds_read_b64_tr_b16 v[196:197], v29 offset:12416
    ds_read_b64_tr_b16 v[198:199], v29 offset:18560
    v_mfma_f32_16x16x32_bf16 a[12:15], v[172:175], v[156:159], a[12:15]
    v_max3_f32 v37, v37, v127, v136
    v_mfma_f32_16x16x32_bf16 a[16:19], v[172:175], v[160:163], a[16:19]
    v_mfma_f32_16x16x32_bf16 a[20:23], v[172:175], v[164:167], a[20:23]
    ds_read_b64_tr_b16 v[200:201], v26 offset:12544
    ds_read_b64_tr_b16 v[202:203], v26 offset:18688
    s_waitcnt lgkmcnt(10)
    v_mfma_f32_16x16x32_bf16 a[24:27], v[176:179], v[156:159], a[24:27]
    v_max3_f32 v38, v38, v131, v140
    v_mfma_f32_16x16x32_bf16 a[28:31], v[176:179], v[160:163], a[28:31]
    v_mfma_f32_16x16x32_bf16 a[32:35], v[176:179], v[164:167], a[32:35]
    v_max3_f32 v36, v36, v133, v134
    ds_read_b64_tr_b16 v[204:205], v27 offset:12544
    ds_read_b64_tr_b16 v[206:207], v27 offset:18688
    v_mfma_f32_16x16x32_bf16 a[36:39], v[180:183], v[156:159], a[36:39]
    v_mfma_f32_16x16x32_bf16 a[40:43], v[180:183], v[160:163], a[40:43]
    v_mfma_f32_16x16x32_bf16 a[44:47], v[180:183], v[164:167], a[44:47]
    v_max3_f32 v37, v37, v137, v138
    ds_read_b64_tr_b16 v[208:209], v28 offset:12544
    ds_read_b64_tr_b16 v[210:211], v28 offset:18688
    s_waitcnt lgkmcnt(10)
    v_mfma_f32_16x16x32_bf16 a[48:51], v[184:187], v[156:159], a[48:51]
    v_mfma_f32_16x16x32_bf16 a[52:55], v[184:187], v[160:163], a[52:55]
    v_max3_f32 v38, v38, v141, v142
    v_mfma_f32_16x16x32_bf16 a[56:59], v[184:187], v[164:167], a[56:59]
    ds_read_b64_tr_b16 v[212:213], v29 offset:12544
    ds_read_b64_tr_b16 v[214:215], v29 offset:18688
    v_mfma_f32_16x16x32_bf16 a[60:63], v[188:191], v[156:159], a[60:63]
    v_mfma_f32_16x16x32_bf16 a[64:67], v[188:191], v[160:163], a[64:67]
    v_max_f32 v36, v36, v135
    v_mfma_f32_16x16x32_bf16 a[68:71], v[188:191], v[164:167], a[68:71]
    s_waitcnt vmcnt(22)
    s_barrier
    v_add_u32 v26, s61, v16
    v_add_u32 v27, s61, v17
    v_add_u32 v28, s61, v18
    v_add_u32 v29, s61, v19
    ds_read_b64_tr_b16 v[168:169], v26 offset:0
    ds_read_b64_tr_b16 v[170:171], v26 offset:6144
    s_waitcnt lgkmcnt(10)
    v_mfma_f32_16x16x32_bf16 a[72:75], v[192:195], v[156:159], a[72:75]
    v_max_f32 v37, v37, v139
    v_mfma_f32_16x16x32_bf16 a[76:79], v[192:195], v[160:163], a[76:79]
    v_mfma_f32_16x16x32_bf16 a[80:83], v[192:195], v[164:167], a[80:83]
    s_add_u32 m0, s65, s66
    s_add_u32 s67, s57, 2359680
    buffer_load_dwordx4 v216, s[36:39], s67 offen offset:0 lds
    ds_read_b64_tr_b16 v[172:173], v27 offset:0
    ds_read_b64_tr_b16 v[174:175], v27 offset:6144
    v_mfma_f32_16x16x32_bf16 a[84:87], v[196:199], v[156:159], a[84:87]
    v_max_f32 v38, v38, v143
    v_mfma_f32_16x16x32_bf16 a[88:91], v[196:199], v[160:163], a[88:91]
    v_mfma_f32_16x16x32_bf16 a[92:95], v[196:199], v[164:167], a[92:95]
    v_fma_f32 v39, v36, s70, -v30
    ds_read_b64_tr_b16 v[176:177], v28 offset:0
    ds_read_b64_tr_b16 v[178:179], v28 offset:6144
    s_waitcnt lgkmcnt(10)
    v_mfma_f32_16x16x32_bf16 a[96:99], v[200:203], v[156:159], a[96:99]
    v_mfma_f32_16x16x32_bf16 a[100:103], v[200:203], v[160:163], a[100:103]
    buffer_load_dwordx4 v217, s[36:39], s67 offen offset:1024 lds
    v_mfma_f32_16x16x32_bf16 a[104:107], v[200:203], v[164:167], a[104:107]
    v_fma_f32 v40, v37, s70, -v31
    ds_read_b64_tr_b16 v[180:181], v29 offset:0
    ds_read_b64_tr_b16 v[182:183], v29 offset:6144
    v_mfma_f32_16x16x32_bf16 a[108:111], v[204:207], v[156:159], a[108:111]
    v_mfma_f32_16x16x32_bf16 a[112:115], v[204:207], v[160:163], a[112:115]
    v_fma_f32 v41, v38, s70, -v32
    v_mfma_f32_16x16x32_bf16 a[116:119], v[204:207], v[164:167], a[116:119]
    ds_read_b64_tr_b16 v[184:185], v26 offset:128
    ds_read_b64_tr_b16 v[186:187], v26 offset:6272
    s_waitcnt lgkmcnt(10)
    v_mfma_f32_16x16x32_bf16 a[120:123], v[208:211], v[156:159], a[120:123]
    buffer_load_dwordx4 v218, s[36:39], s67 offen offset:2048 lds
    v_mfma_f32_16x16x32_bf16 a[124:127], v[208:211], v[160:163], a[124:127]
    v_max3_f32 v39, v39, v40, v41
    v_mfma_f32_16x16x32_bf16 a[128:131], v[208:211], v[164:167], a[128:131]
    ds_read_b64_tr_b16 v[188:189], v27 offset:128
    ds_read_b64_tr_b16 v[190:191], v27 offset:6272
    v_mfma_f32_16x16x32_bf16 a[132:135], v[212:215], v[156:159], a[132:135]
    v_cmp_lt_f32 s[78:79], s71, v39
    v_mfma_f32_16x16x32_bf16 a[136:139], v[212:215], v[160:163], a[136:139]
    v_mfma_f32_16x16x32_bf16 a[140:143], v[212:215], v[164:167], a[140:143]
    s_add_u32 m0, m0, 3072
    s_nop 0
    buffer_load_dwordx4 v219, s[36:39], s67 offen offset:0 lds
    s_cmp_lg_u64 s[78:79], 0
    s_cbranch_scc0 L1_skip6
    s_swappc_b64 s[72:73], s[74:75]
L1_skip6:
    v_fma_f32 v96, v96, s70, -v30
    v_fma_f32 v97, v97, s70, -v30
    v_fma_f32 v98, v98, s70, -v30
    v_fma_f32 v99, v99, s70, -v30
    v_exp_f32 v96, v96
    v_exp_f32 v97, v97
    v_exp_f32 v98, v98
    v_exp_f32 v99, v99
    v_fma_f32 v100, v100, s70, -v31
    v_fma_f32 v101, v101, s70, -v31
    v_fma_f32 v102, v102, s70, -v31
    v_fma_f32 v103, v103, s70, -v31
    v_exp_f32 v100, v100
    v_exp_f32 v101, v101
    v_exp_f32 v102, v102
    v_exp_f32 v103, v103
    v_fma_f32 v104, v104, s70, -v32
    v_fma_f32 v105, v105, s70, -v32
    v_fma_f32 v106, v106, s70, -v32
    v_fma_f32 v107, v107, s70, -v32
    v_exp_f32 v104, v104
    v_exp_f32 v105, v105
    v_exp_f32 v106, v106
    v_exp_f32 v107, v107
    v_fma_f32 v108, v108, s70, -v30
    v_fma_f32 v109, v109, s70, -v30
    v_fma_f32 v110, v110, s70, -v30
    v_fma_f32 v111, v111, s70, -v30
    v_exp_f32 v108, v108
    v_exp_f32 v109, v109
    v_exp_f32 v110, v110
    v_exp_f32 v111, v111
    v_fma_f32 v112, v112, s70, -v31
    v_fma_f32 v113, v113, s70, -v31
    v_fma_f32 v114, v114, s70, -v31
    v_fma_f32 v115, v115, s70, -v31
    v_exp_f32 v112, v112
    v_exp_f32 v113, v113
    v_exp_f32 v114, v114
    v_exp_f32 v115, v115
    v_fma_f32 v116, v116, s70, -v32
    v_fma_f32 v117, v117, s70, -v32
    v_fma_f32 v118, v118, s70, -v32
    v_fma_f32 v119, v119, s70, -v32
    v_exp_f32 v116, v116
    v_exp_f32 v117, v117
    v_exp_f32 v118, v118
    v_exp_f32 v119, v119
    v_cvt_pk_bf16_f32 v144, v96, v97
    v_cvt_pk_bf16_f32 v145, v98, v99
    v_cvt_pk_bf16_f32 v148, v100, v101
    v_cvt_pk_bf16_f32 v149, v102, v103
    v_cvt_pk_bf16_f32 v152, v104, v105
    v_cvt_pk_bf16_f32 v153, v106, v107
    v_fma_f32 v120, v120, s70, -v30
    v_fma_f32 v121, v121, s70, -v30
    v_fma_f32 v122, v122, s70, -v30
    v_fma_f32 v123, v123, s70, -v30
    v_exp_f32 v120, v120
    v_exp_f32 v121, v121
    v_exp_f32 v122, v122
    v_exp_f32 v123, v123
    v_fma_f32 v124, v124, s70, -v31
    v_fma_f32 v125, v125, s70, -v31
    v_fma_f32 v126, v126, s70, -v31
    v_fma_f32 v127, v127, s70, -v31
    v_exp_f32 v124, v124
    v_exp_f32 v125, v125
    v_exp_f32 v126, v126
    v_exp_f32 v127, v127
    v_fma_f32 v128, v128, s70, -v32
    v_fma_f32 v129, v129, s70, -v32
    v_fma_f32 v130, v130, s70, -v32
    v_fma_f32 v131, v131, s70, -v32
    v_exp_f32 v128, v128
    v_exp_f32 v129, v129
    v_exp_f32 v130, v130
    v_exp_f32 v131, v131
    v_cvt_pk_bf16_f32 v146, v108, v109
    v_cvt_pk_bf16_f32 v147, v110, v111
    v_cvt_pk_bf16_f32 v150, v112, v113
    v_cvt_pk_bf16_f32 v151, v114, v115
    v_cvt_pk_bf16_f32 v154, v116, v117
    v_cvt_pk_bf16_f32 v155, v118, v119
    v_fma_f32 v132, v132, s70, -v30
    v_fma_f32 v133, v133, s70, -v30
    v_fma_f32 v134, v134, s70, -v30
    v_fma_f32 v135, v135, s70, -v30
    v_exp_f32 v132, v132
    v_exp_f32 v133, v133
    v_exp_f32 v134, v134
    v_exp_f32 v135, v135
    v_fma_f32 v136, v136, s70, -v31
    v_fma_f32 v137, v137, s70, -v31
    v_fma_f32 v138, v138, s70, -v31
    v_fma_f32 v139, v139, s70, -v31
    v_exp_f32 v136, v136
    v_exp_f32 v137, v137
    v_exp_f32 v138, v138
    v_exp_f32 v139, v139
    v_fma_f32 v140, v140, s70, -v32
    v_fma_f32 v141, v141, s70, -v32
    v_fma_f32 v142, v142, s70, -v32
    v_fma_f32 v143, v143, s70, -v32
    v_exp_f32 v140, v140
    v_exp_f32 v141, v141
    v_exp_f32 v142, v142
    v_exp_f32 v143, v143
    v_cvt_pk_bf16_f32 v156, v120, v121
    v_cvt_pk_bf16_f32 v157, v122, v123
    v_cvt_pk_bf16_f32 v160, v124, v125
    v_cvt_pk_bf16_f32 v161, v126, v127
    v_cvt_pk_bf16_f32 v164, v128, v129
    v_cvt_pk_bf16_f32 v165, v130, v131
    v_cvt_pk_bf16_f32 v158, v132, v133
    v_cvt_pk_bf16_f32 v159, v134, v135
    v_cvt_pk_bf16_f32 v162, v136, v137
    v_cvt_pk_bf16_f32 v163, v138, v139
    v_cvt_pk_bf16_f32 v166, v140, v141
    v_cvt_pk_bf16_f32 v167, v142, v143
    ds_read_b64_tr_b16 v[192:193], v28 offset:128
    ds_read_b64_tr_b16 v[194:195], v28 offset:6272
    v_mfma_f32_16x16x32_bf16 a[216:219], v[252:255], v[144:147], a[216:219]
    v_mfma_f32_16x16x32_bf16 a[220:223], v[252:255], v[148:151], a[220:223]
    v_mfma_f32_16x16x32_bf16 a[224:227], v[252:255], v[152:155], a[224:227]
    s_waitcnt lgkmcnt(10)
    v_mfma_f32_16x16x32_bf16 a[0:3], v[168:171], v[144:147], a[0:3]
    v_mfma_f32_16x16x32_bf16 a[4:7], v[168:171], v[148:151], a[4:7]
    v_mfma_f32_16x16x32_bf16 a[8:11], v[168:171], v[152:155], a[8:11]
    ds_read_b64_tr_b16 v[196:197], v29 offset:128
    ds_read_b64_tr_b16 v[198:199], v29 offset:6272
    v_mfma_f32_16x16x32_bf16 a[12:15], v[172:175], v[144:147], a[12:15]
    v_mfma_f32_16x16x32_bf16 a[16:19], v[172:175], v[148:151], a[16:19]
    buffer_load_dwordx4 v220, s[36:39], s67 offen offset:1024 lds
    v_mfma_f32_16x16x32_bf16 a[20:23], v[172:175], v[152:155], a[20:23]
    ds_read_b64_tr_b16 v[200:201], v26 offset:256
    ds_read_b64_tr_b16 v[202:203], v26 offset:6400
    s_waitcnt lgkmcnt(10)
    v_mfma_f32_16x16x32_bf16 a[24:27], v[176:179], v[144:147], a[24:27]
    v_mfma_f32_16x16x32_bf16 a[28:31], v[176:179], v[148:151], a[28:31]
    v_mfma_f32_16x16x32_bf16 a[32:35], v[176:179], v[152:155], a[32:35]
    ds_read_b64_tr_b16 v[204:205], v27 offset:256
    ds_read_b64_tr_b16 v[206:207], v27 offset:6400
    v_mfma_f32_16x16x32_bf16 a[36:39], v[180:183], v[144:147], a[36:39]
    buffer_load_dwordx4 v221, s[36:39], s67 offen offset:2048 lds
    v_mfma_f32_16x16x32_bf16 a[40:43], v[180:183], v[148:151], a[40:43]
    v_mfma_f32_16x16x32_bf16 a[44:47], v[180:183], v[152:155], a[44:47]
    ds_read_b64_tr_b16 v[208:209], v28 offset:256
    ds_read_b64_tr_b16 v[210:211], v28 offset:6400
    s_waitcnt lgkmcnt(10)
    v_mfma_f32_16x16x32_bf16 a[48:51], v[184:187], v[144:147], a[48:51]
    v_mfma_f32_16x16x32_bf16 a[52:55], v[184:187], v[148:151], a[52:55]
    v_mfma_f32_16x16x32_bf16 a[56:59], v[184:187], v[152:155], a[56:59]
    ds_read_b64_tr_b16 v[212:213], v29 offset:256
    ds_read_b64_tr_b16 v[214:215], v29 offset:6400
    v_mfma_f32_16x16x32_bf16 a[60:63], v[188:191], v[144:147], a[60:63]
    v_mfma_f32_16x16x32_bf16 a[64:67], v[188:191], v[148:151], a[64:67]
    v_mfma_f32_16x16x32_bf16 a[68:71], v[188:191], v[152:155], a[68:71]
    ds_read_b64_tr_b16 v[168:169], v26 offset:12288
    ds_read_b64_tr_b16 v[170:171], v26 offset:18432
    s_waitcnt lgkmcnt(10)
    v_mfma_f32_16x16x32_bf16 a[72:75], v[192:195], v[144:147], a[72:75]
    v_mfma_f32_16x16x32_bf16 a[76:79], v[192:195], v[148:151], a[76:79]
    v_mfma_f32_16x16x32_bf16 a[80:83], v[192:195], v[152:155], a[80:83]
    ds_read_b64_tr_b16 v[172:173], v27 offset:12288
    ds_read_b64_tr_b16 v[174:175], v27 offset:18432
    v_mfma_f32_16x16x32_bf16 a[84:87], v[196:199], v[144:147], a[84:87]
    v_mfma_f32_16x16x32_bf16 a[88:91], v[196:199], v[148:151], a[88:91]
    v_mfma_f32_16x16x32_bf16 a[92:95], v[196:199], v[152:155], a[92:95]
    ds_read_b64_tr_b16 v[176:177], v28 offset:12288
    ds_read_b64_tr_b16 v[178:179], v28 offset:18432
    s_waitcnt lgkmcnt(10)
    v_mfma_f32_16x16x32_bf16 a[96:99], v[200:203], v[144:147], a[96:99]
    v_mfma_f32_16x16x32_bf16 a[100:103], v[200:203], v[148:151], a[100:103]
    v_mfma_f32_16x16x32_bf16 a[104:107], v[200:203], v[152:155], a[104:107]
    ds_read_b64_tr_b16 v[180:181], v29 offset:12288
    ds_read_b64_tr_b16 v[182:183], v29 offset:18432
    v_mfma_f32_16x16x32_bf16 a[108:111], v[204:207], v[144:147], a[108:111]
    v_mfma_f32_16x16x32_bf16 a[112:115], v[204:207], v[148:151], a[112:115]
    v_mfma_f32_16x16x32_bf16 a[116:119], v[204:207], v[152:155], a[116:119]
    ds_read_b64_tr_b16 v[184:185], v26 offset:12416
    ds_read_b64_tr_b16 v[186:187], v26 offset:18560
    s_waitcnt lgkmcnt(10)
    v_mfma_f32_16x16x32_bf16 a[120:123], v[208:211], v[144:147], a[120:123]
    v_mfma_f32_16x16x32_bf16 a[124:127], v[208:211], v[148:151], a[124:127]
    v_mfma_f32_16x16x32_bf16 a[128:131], v[208:211], v[152:155], a[128:131]
    ds_read_b64_tr_b16 v[188:189], v27 offset:12416
    ds_read_b64_tr_b16 v[190:191], v27 offset:18560
    v_mfma_f32_16x16x32_bf16 a[132:135], v[212:215], v[144:147], a[132:135]
    v_mfma_f32_16x16x32_bf16 a[136:139], v[212:215], v[148:151], a[136:139]
    v_mfma_f32_16x16x32_bf16 a[140:143], v[212:215], v[152:155], a[140:143]
    ds_read_b64_tr_b16 v[192:193], v28 offset:12416
    ds_read_b64_tr_b16 v[194:195], v28 offset:18560
    v_mfma_f32_16x16x32_bf16 a[216:219], v[252:255], v[156:159], a[216:219]
    v_mfma_f32_16x16x32_bf16 a[220:223], v[252:255], v[160:163], a[220:223]
    v_mfma_f32_16x16x32_bf16 a[224:227], v[252:255], v[164:167], a[224:227]
    s_waitcnt lgkmcnt(10)
    v_mfma_f32_16x16x32_bf16 a[0:3], v[168:171], v[156:159], a[0:3]
    v_mfma_f32_16x16x32_bf16 a[4:7], v[168:171], v[160:163], a[4:7]
    v_mfma_f32_16x16x32_bf16 a[8:11], v[168:171], v[164:167], a[8:11]
    ds_read_b64_tr_b16 v[196:197], v29 offset:12416
    ds_read_b64_tr_b16 v[198:199], v29 offset:18560
    v_mfma_f32_16x16x32_bf16 a[12:15], v[172:175], v[156:159], a[12:15]
    v_mfma_f32_16x16x32_bf16 a[16:19], v[172:175], v[160:163], a[16:19]
    v_mfma_f32_16x16x32_bf16 a[20:23], v[172:175], v[164:167], a[20:23]
    ds_read_b64_tr_b16 v[200:201], v26 offset:12544
    ds_read_b64_tr_b16 v[202:203], v26 offset:18688
    s_waitcnt lgkmcnt(10)
    v_mfma_f32_16x16x32_bf16 a[24:27], v[176:179], v[156:159], a[24:27]
    v_mfma_f32_16x16x32_bf16 a[28:31], v[176:179], v[160:163], a[28:31]
    v_mfma_f32_16x16x32_bf16 a[32:35], v[176:179], v[164:167], a[32:35]
    ds_read_b64_tr_b16 v[204:205], v27 offset:12544
    ds_read_b64_tr_b16 v[206:207], v27 offset:18688
    v_mfma_f32_16x16x32_bf16 a[36:39], v[180:183], v[156:159], a[36:39]
    v_mfma_f32_16x16x32_bf16 a[40:43], v[180:183], v[160:163], a[40:43]
    v_mfma_f32_16x16x32_bf16 a[44:47], v[180:183], v[164:167], a[44:47]
    ds_read_b64_tr_b16 v[208:209], v28 offset:12544
    ds_read_b64_tr_b16 v[210:211], v28 offset:18688
    s_waitcnt lgkmcnt(10)
    v_mfma_f32_16x16x32_bf16 a[48:51], v[184:187], v[156:159], a[48:51]
    v_mfma_f32_16x16x32_bf16 a[52:55], v[184:187], v[160:163], a[52:55]
    v_mfma_f32_16x16x32_bf16 a[56:59], v[184:187], v[164:167], a[56:59]
    ds_read_b64_tr_b16 v[212:213], v29 offset:12544
    ds_read_b64_tr_b16 v[214:215], v29 offset:18688
    v_mfma_f32_16x16x32_bf16 a[60:63], v[188:191], v[156:159], a[60:63]
    v_mfma_f32_16x16x32_bf16 a[64:67], v[188:191], v[160:163], a[64:67]
    v_mfma_f32_16x16x32_bf16 a[68:71], v[188:191], v[164:167], a[68:71]
    s_waitcnt vmcnt(22)
    s_barrier
    v_add_u32 v26, s62, v20
    v_add_u32 v27, s62, v21
    v_add_u32 v28, s62, v22
    v_add_u32 v29, s62, v23
    ds_read_b64_tr_b16 v[168:169], v26 offset:0
    ds_read_b64_tr_b16 v[170:171], v26 offset:1536
    s_waitcnt lgkmcnt(10)
    v_mfma_f32_16x16x32_bf16 a[72:75], v[192:195], v[156:159], a[72:75]
    s_add_u32 m0, s60, s66
    s_add_u32 s67, s57, 3146112
    buffer_load_dwordx4 v216, s[36:39], s67 offen offset:0 lds
    v_mfma_f32_16x16x32_bf16 a[76:79], v[192:195], v[160:163], a[76:79]
    v_mfma_f32_16x16x32_bf16 a[80:83], v[192:195], v[164:167], a[80:83]
    ds_read_b64_tr_b16 v[172:173], v27 offset:0
    ds_read_b64_tr_b16 v[174:175], v27 offset:1536
    v_mfma_f32_16x16x32_bf16 a[84:87], v[196:199], v[156:159], a[84:87]
    v_mfma_f32_16x16x32_bf16 a[88:91], v[196:199], v[160:163], a[88:91]
    v_mfma_f32_16x16x32_bf16 a[92:95], v[196:199], v[164:167], a[92:95]
    buffer_load_dwordx4 v217, s[36:39], s67 offen offset:1024 lds
    ds_read_b64_tr_b16 v[176:177], v28 offset:0
    ds_read_b64_tr_b16 v[178:179], v28 offset:1536
    s_waitcnt lgkmcnt(10)
    v_mfma_f32_16x16x32_bf16 a[96:99], v[200:203], v[156:159], a[96:99]
    v_mfma_f32_16x16x32_bf16 a[100:103], v[200:203], v[160:163], a[100:103]
    v_mfma_f32_16x16x32_bf16 a[104:107], v[200:203], v[164:167], a[104:107]
    ds_read_b64_tr_b16 v[180:181], v29 offset:0
    ds_read_b64_tr_b16 v[182:183], v29 offset:1536
    v_mfma_f32_16x16x32_bf16 a[108:111], v[204:207], v[156:159], a[108:111]
    v_mfma_f32_16x16x32_bf16 a[112:115], v[204:207], v[160:163], a[112:115]
    buffer_load_dwordx4 v218, s[36:39], s67 offen offset:2048 lds
    v_mfma_f32_16x16x32_bf16 a[116:119], v[204:207], v[164:167], a[116:119]
    ds_read_b64_tr_b16 v[184:185], v26 offset:128
    ds_read_b64_tr_b16 v[186:187], v26 offset:1664
    s_waitcnt lgkmcnt(10)
    v_mfma_f32_16x16x32_bf16 a[120:123], v[208:211], v[156:159], a[120:123]
    v_mfma_f32_16x16x32_bf16 a[124:127], v[208:211], v[160:163], a[124:127]
    v_mfma_f32_16x16x32_bf16 a[128:131], v[208:211], v[164:167], a[128:131]
    ds_read_b64_tr_b16 v[188:189], v27 offset:128
    ds_read_b64_tr_b16 v[190:191], v27 offset:1664
    v_mfma_f32_16x16x32_bf16 a[132:135], v[212:215], v[156:159], a[132:135]
    s_add_u32 m0, m0, 3072
    s_nop 0
    buffer_load_dwordx4 v219, s[36:39], s67 offen offset:0 lds
    v_mfma_f32_16x16x32_bf16 a[136:139], v[212:215], v[160:163], a[136:139]
    v_mfma_f32_16x16x32_bf16 a[140:143], v[212:215], v[164:167], a[140:143]
    buffer_load_dwordx4 v220, s[36:39], s67 offen offset:1024 lds
    buffer_load_dwordx4 v221, s[36:39], s67 offen offset:2048 lds
    buffer_load_dwordx4 v[48:51], v10, s[28:31], s58 offen offset:0
    buffer_load_dwordx4 v[52:55], v11, s[28:31], s58 offen offset:0
    buffer_load_dwordx4 v[56:59], v12, s[28:31], s58 offen offset:0
    buffer_load_dwordx4 v[60:63], v10, s[28:31], s58 offen offset:64
    buffer_load_dwordx4 v[64:67], v11, s[28:31], s58 offen offset:64
    buffer_load_dwordx4 v[68:71], v12, s[28:31], s58 offen offset:64
    buffer_load_dwordx4 v[72:75], v10, s[28:31], s58 offen offset:128
    buffer_load_dwordx4 v[76:79], v11, s[28:31], s58 offen offset:128
    buffer_load_dwordx4 v[80:83], v12, s[28:31], s58 offen offset:128
    buffer_load_dwordx4 v[84:87], v10, s[28:31], s58 offen offset:192
    buffer_load_dwordx4 v[88:91], v11, s[28:31], s58 offen offset:192
    buffer_load_dwordx4 v[92:95], v12, s[28:31], s58 offen offset:192
    buffer_load_dwordx4 v[96:99], v10, s[28:31], s58 offen offset:256
    buffer_load_dwordx4 v[100:103], v11, s[28:31], s58 offen offset:256
    buffer_load_dwordx4 v[104:107], v12, s[28:31], s58 offen offset:256
    buffer_load_dwordx4 v[108:111], v10, s[28:31], s58 offen offset:320
    buffer_load_dwordx4 v[112:115], v11, s[28:31], s58 offen offset:320
    buffer_load_dwordx4 v[116:119], v12, s[28:31], s58 offen offset:320
    buffer_load_dwordx4 v[120:123], v10, s[28:31], s58 offen offset:384
    buffer_load_dwordx4 v[124:127], v11, s[28:31], s58 offen offset:384
    buffer_load_dwordx4 v[128:131], v12, s[28:31], s58 offen offset:384
    buffer_load_dwordx4 v[132:135], v10, s[28:31], s58 offen offset:448
    buffer_load_dwordx4 v[136:139], v11, s[28:31], s58 offen offset:448
    buffer_load_dwordx4 v[140:143], v12, s[28:31], s58 offen offset:448
    v_accvgpr_read_b32 v33, a216
    v_accvgpr_read_b32 v34, a220
    v_accvgpr_read_b32 v35, a224
    v_rcp_f32 v42, v33
    v_rcp_f32 v43, v34
    v_rcp_f32 v44, v35
    v_accvgpr_read_b32 v144, a0
    v_accvgpr_read_b32 v145, a1
    v_accvgpr_read_b32 v146, a2
    v_accvgpr_read_b32 v147, a3
    v_accvgpr_read_b32 v148, a12
    v_accvgpr_read_b32 v149, a13
    v_accvgpr_read_b32 v150, a14
    v_accvgpr_read_b32 v151, a15
    v_mul_f32 v144, v144, v42
    v_mul_f32 v145, v145, v42
    v_mul_f32 v146, v146, v42
    v_mul_f32 v147, v147, v42
    v_mul_f32 v148, v148, v42
    v_mul_f32 v149, v149, v42
    v_mul_f32 v150, v150, v42
    v_mul_f32 v151, v151, v42
    v_cvt_pk_bf16_f32 v152, v144, v145
    v_cvt_pk_bf16_f32 v153, v146, v147
    v_cvt_pk_bf16_f32 v154, v148, v149
    v_cvt_pk_bf16_f32 v155, v150, v151
    s_nop 0
    v_permlane32_swap_b32 v152, v154
    v_permlane32_swap_b32 v153, v155
    s_nop 0
    v_permlane16_swap_b32 v152, v154
    v_permlane16_swap_b32 v153, v155
    s_add_u32 s67, s59, 0
    buffer_store_dwordx4 v[152:155], v13, s[48:51], s67 offen
    v_accvgpr_read_b32 v156, a4
    v_accvgpr_read_b32 v157, a5
    v_accvgpr_read_b32 v158, a6
    v_accvgpr_read_b32 v159, a7
    v_accvgpr_read_b32 v160, a16
    v_accvgpr_read_b32 v161, a17
    v_accvgpr_read_b32 v162, a18
    v_accvgpr_read_b32 v163, a19
    v_mul_f32 v156, v156, v43
    v_mul_f32 v157, v157, v43
    v_mul_f32 v158, v158, v43
    v_mul_f32 v159, v159, v43
    v_mul_f32 v160, v160, v43
    v_mul_f32 v161, v161, v43
    v_mul_f32 v162, v162, v43
    v_mul_f32 v163, v163, v43
    v_cvt_pk_bf16_f32 v164, v156, v157
    v_cvt_pk_bf16_f32 v165, v158, v159
    v_cvt_pk_bf16_f32 v166, v160, v161
    v_cvt_pk_bf16_f32 v167, v162, v163
    s_nop 0
    v_permlane32_swap_b32 v164, v166
    v_permlane32_swap_b32 v165, v167
    s_nop 0
    v_permlane16_swap_b32 v164, v166
    v_permlane16_swap_b32 v165, v167
    s_add_u32 s67, s59, 196608
    buffer_store_dwordx4 v[164:167], v13, s[48:51], s67 offen
    v_accvgpr_read_b32 v144, a8
    v_accvgpr_read_b32 v145, a9
    v_accvgpr_read_b32 v146, a10
    v_accvgpr_read_b32 v147, a11
    v_accvgpr_read_b32 v148, a20
    v_accvgpr_read_b32 v149, a21
    v_accvgpr_read_b32 v150, a22
    v_accvgpr_read_b32 v151, a23
    v_mul_f32 v144, v144, v44
    v_mul_f32 v145, v145, v44
    v_mul_f32 v146, v146, v44
    v_mul_f32 v147, v147, v44
    v_mul_f32 v148, v148, v44
    v_mul_f32 v149, v149, v44
    v_mul_f32 v150, v150, v44
    v_mul_f32 v151, v151, v44
    v_cvt_pk_bf16_f32 v152, v144, v145
    v_cvt_pk_bf16_f32 v153, v146, v147
    v_cvt_pk_bf16_f32 v154, v148, v149
    v_cvt_pk_bf16_f32 v155, v150, v151
    s_nop 0
    v_permlane32_swap_b32 v152, v154
    v_permlane32_swap_b32 v153, v155
    s_nop 0
    v_permlane16_swap_b32 v152, v154
    v_permlane16_swap_b32 v153, v155
    s_add_u32 s67, s59, 393216
    buffer_store_dwordx4 v[152:155], v13, s[48:51], s67 offen
    v_accvgpr_read_b32 v156, a24
    v_accvgpr_read_b32 v157, a25
    v_accvgpr_read_b32 v158, a26
    v_accvgpr_read_b32 v159, a27
    v_accvgpr_read_b32 v160, a36
    v_accvgpr_read_b32 v161, a37
    v_accvgpr_read_b32 v162, a38
    v_accvgpr_read_b32 v163, a39
    v_mul_f32 v156, v156, v42
    v_mul_f32 v157, v157, v42
    v_mul_f32 v158, v158, v42
    v_mul_f32 v159, v159, v42
    v_mul_f32 v160, v160, v42
    v_mul_f32 v161, v161, v42
    v_mul_f32 v162, v162, v42
    v_mul_f32 v163, v163, v42
    v_cvt_pk_bf16_f32 v164, v156, v157
    v_cvt_pk_bf16_f32 v165, v158, v159
    v_cvt_pk_bf16_f32 v166, v160, v161
    v_cvt_pk_bf16_f32 v167, v162, v163
    s_nop 0
    v_permlane32_swap_b32 v164, v166
    v_permlane32_swap_b32 v165, v167
    s_nop 0
    v_permlane16_swap_b32 v164, v166
    v_permlane16_swap_b32 v165, v167
    s_add_u32 s67, s59, 1024
    buffer_store_dwordx4 v[164:167], v13, s[48:51], s67 offen
    v_accvgpr_read_b32 v144, a28
    v_accvgpr_read_b32 v145, a29
    v_accvgpr_read_b32 v146, a30
    v_accvgpr_read_b32 v147, a31
    v_accvgpr_read_b32 v148, a40
    v_accvgpr_read_b32 v149, a41
    v_accvgpr_read_b32 v150, a42
    v_accvgpr_read_b32 v151, a43
    v_mul_f32 v144, v144, v43
    v_mul_f32 v145, v145, v43
    v_mul_f32 v146, v146, v43
    v_mul_f32 v147, v147, v43
    v_mul_f32 v148, v148, v43
    v_mul_f32 v149, v149, v43
    v_mul_f32 v150, v150, v43
    v_mul_f32 v151, v151, v43
    v_cvt_pk_bf16_f32 v152, v144, v145
    v_cvt_pk_bf16_f32 v153, v146, v147
    v_cvt_pk_bf16_f32 v154, v148, v149
    v_cvt_pk_bf16_f32 v155, v150, v151
    s_nop 0
    v_permlane32_swap_b32 v152, v154
    v_permlane32_swap_b32 v153, v155
    s_nop 0
    v_permlane16_swap_b32 v152, v154
    v_permlane16_swap_b32 v153, v155
    s_add_u32 s67, s59, 197632
    buffer_store_dwordx4 v[152:155], v13, s[48:51], s67 offen
    v_accvgpr_read_b32 v156, a32
    v_accvgpr_read_b32 v157, a33
    v_accvgpr_read_b32 v158, a34
    v_accvgpr_read_b32 v159, a35
    v_accvgpr_read_b32 v160, a44
    v_accvgpr_read_b32 v161, a45
    v_accvgpr_read_b32 v162, a46
    v_accvgpr_read_b32 v163, a47
    v_mul_f32 v156, v156, v44
    v_mul_f32 v157, v157, v44
    v_mul_f32 v158, v158, v44
    v_mul_f32 v159, v159, v44
    v_mul_f32 v160, v160, v44
    v_mul_f32 v161, v161, v44
    v_mul_f32 v162, v162, v44
    v_mul_f32 v163, v163, v44
    v_cvt_pk_bf16_f32 v164, v156, v157
    v_cvt_pk_bf16_f32 v165, v158, v159
    v_cvt_pk_bf16_f32 v166, v160, v161
    v_cvt_pk_bf16_f32 v167, v162, v163
    s_nop 0
    v_permlane32_swap_b32 v164, v166
    v_permlane32_swap_b32 v165, v167
    s_nop 0
    v_permlane16_swap_b32 v164, v166
    v_permlane16_swap_b32 v165, v167
    s_add_u32 s67, s59, 394240
    buffer_store_dwordx4 v[164:167], v13, s[48:51], s67 offen
    v_accvgpr_read_b32 v144, a48
    v_accvgpr_read_b32 v145, a49
    v_accvgpr_read_b32 v146, a50
    v_accvgpr_read_b32 v147, a51
    v_accvgpr_read_b32 v148, a60
    v_accvgpr_read_b32 v149, a61
    v_accvgpr_read_b32 v150, a62
    v_accvgpr_read_b32 v151, a63
    v_mul_f32 v144, v144, v42
    v_mul_f32 v145, v145, v42
    v_mul_f32 v146, v146, v42
    v_mul_f32 v147, v147, v42
    v_mul_f32 v148, v148, v42
    v_mul_f32 v149, v149, v42
    v_mul_f32 v150, v150, v42
    v_mul_f32 v151, v151, v42
    v_cvt_pk_bf16_f32 v152, v144, v145
    v_cvt_pk_bf16_f32 v153, v146, v147
    v_cvt_pk_bf16_f32 v154, v148, v149
    v_cvt_pk_bf16_f32 v155, v150, v151
    s_nop 0
    v_permlane32_swap_b32 v152, v154
    v_permlane32_swap_b32 v153, v155
    s_nop 0
    v_permlane16_swap_b32 v152, v154
    v_permlane16_swap_b32 v153, v155
    s_add_u32 s67, s59, 2048
    buffer_store_dwordx4 v[152:155], v13, s[48:51], s67 offen
    v_accvgpr_read_b32 v156, a52
    v_accvgpr_read_b32 v157, a53
    v_accvgpr_read_b32 v158, a54
    v_accvgpr_read_b32 v159, a55
    v_accvgpr_read_b32 v160, a64
    v_accvgpr_read_b32 v161, a65
    v_accvgpr_read_b32 v162, a66
    v_accvgpr_read_b32 v163, a67
    v_mul_f32 v156, v156, v43
    v_mul_f32 v157, v157, v43
    v_mul_f32 v158, v158, v43
    v_mul_f32 v159, v159, v43
    v_mul_f32 v160, v160, v43
    v_mul_f32 v161, v161, v43
    v_mul_f32 v162, v162, v43
    v_mul_f32 v163, v163, v43
    v_cvt_pk_bf16_f32 v164, v156, v157
    v_cvt_pk_bf16_f32 v165, v158, v159
    v_cvt_pk_bf16_f32 v166, v160, v161
    v_cvt_pk_bf16_f32 v167, v162, v163
    s_nop 0
    v_permlane32_swap_b32 v164, v166
    v_permlane32_swap_b32 v165, v167
    s_nop 0
    v_permlane16_swap_b32 v164, v166
    v_permlane16_swap_b32 v165, v167
    s_add_u32 s67, s59, 198656
    buffer_store_dwordx4 v[164:167], v13, s[48:51], s67 offen
    v_accvgpr_read_b32 v144, a56
    v_accvgpr_read_b32 v145, a57
    v_accvgpr_read_b32 v146, a58
    v_accvgpr_read_b32 v147, a59
    v_accvgpr_read_b32 v148, a68
    v_accvgpr_read_b32 v149, a69
    v_accvgpr_read_b32 v150, a70
    v_accvgpr_read_b32 v151, a71
    v_mul_f32 v144, v144, v44
    v_mul_f32 v145, v145, v44
    v_mul_f32 v146, v146, v44
    v_mul_f32 v147, v147, v44
    v_mul_f32 v148, v148, v44
    v_mul_f32 v149, v149, v44
    v_mul_f32 v150, v150, v44
    v_mul_f32 v151, v151, v44
    v_cvt_pk_bf16_f32 v152, v144, v145
    v_cvt_pk_bf16_f32 v153, v146, v147
    v_cvt_pk_bf16_f32 v154, v148, v149
    v_cvt_pk_bf16_f32 v155, v150, v151
    s_nop 0
    v_permlane32_swap_b32 v152, v154
    v_permlane32_swap_b32 v153, v155
    s_nop 0
    v_permlane16_swap_b32 v152, v154
    v_permlane16_swap_b32 v153, v155
    s_add_u32 s67, s59, 395264
    s_waitcnt vmcnt(56)
    buffer_store_dwordx4 v[152:155], v13, s[48:51], s67 offen
    v_accvgpr_read_b32 v156, a72
    v_accvgpr_read_b32 v157, a73
    v_accvgpr_read_b32 v158, a74
    v_accvgpr_read_b32 v159, a75
    v_accvgpr_read_b32 v160, a84
    v_accvgpr_read_b32 v161, a85
    v_accvgpr_read_b32 v162, a86
    v_accvgpr_read_b32 v163, a87
    v_mul_f32 v156, v156, v42
    v_mul_f32 v157, v157, v42
    v_mul_f32 v158, v158, v42
    v_mul_f32 v159, v159, v42
    v_mul_f32 v160, v160, v42
    v_mul_f32 v161, v161, v42
    v_mul_f32 v162, v162, v42
    v_mul_f32 v163, v163, v42
    v_cvt_pk_bf16_f32 v164, v156, v157
    v_cvt_pk_bf16_f32 v165, v158, v159
    v_cvt_pk_bf16_f32 v166, v160, v161
    v_cvt_pk_bf16_f32 v167, v162, v163
    s_nop 0
    v_permlane32_swap_b32 v164, v166
    v_permlane32_swap_b32 v165, v167
    s_nop 0
    v_permlane16_swap_b32 v164, v166
    v_permlane16_swap_b32 v165, v167
    s_add_u32 s67, s59, 3072
    buffer_store_dwordx4 v[164:167], v13, s[48:51], s67 offen
    v_accvgpr_read_b32 v144, a76
    v_accvgpr_read_b32 v145, a77
    v_accvgpr_read_b32 v146, a78
    v_accvgpr_read_b32 v147, a79
    v_accvgpr_read_b32 v148, a88
    v_accvgpr_read_b32 v149, a89
    v_accvgpr_read_b32 v150, a90
    v_accvgpr_read_b32 v151, a91
    v_mul_f32 v144, v144, v43
    v_mul_f32 v145, v145, v43
    v_mul_f32 v146, v146, v43
    v_mul_f32 v147, v147, v43
    v_mul_f32 v148, v148, v43
    v_mul_f32 v149, v149, v43
    v_mul_f32 v150, v150, v43
    v_mul_f32 v151, v151, v43
    v_cvt_pk_bf16_f32 v152, v144, v145
    v_cvt_pk_bf16_f32 v153, v146, v147
    v_cvt_pk_bf16_f32 v154, v148, v149
    v_cvt_pk_bf16_f32 v155, v150, v151
    s_nop 0
    v_permlane32_swap_b32 v152, v154
    v_permlane32_swap_b32 v153, v155
    s_nop 0
    v_permlane16_swap_b32 v152, v154
    v_permlane16_swap_b32 v153, v155
    s_add_u32 s67, s59, 199680
    buffer_store_dwordx4 v[152:155], v13, s[48:51], s67 offen
    v_accvgpr_read_b32 v156, a80
    v_accvgpr_read_b32 v157, a81
    v_accvgpr_read_b32 v158, a82
    v_accvgpr_read_b32 v159, a83
    v_accvgpr_read_b32 v160, a92
    v_accvgpr_read_b32 v161, a93
    v_accvgpr_read_b32 v162, a94
    v_accvgpr_read_b32 v163, a95
    v_mul_f32 v156, v156, v44
    v_mul_f32 v157, v157, v44
    v_mul_f32 v158, v158, v44
    v_mul_f32 v159, v159, v44
    v_mul_f32 v160, v160, v44
    v_mul_f32 v161, v161, v44
    v_mul_f32 v162, v162, v44
    v_mul_f32 v163, v163, v44
    v_cvt_pk_bf16_f32 v164, v156, v157
    v_cvt_pk_bf16_f32 v165, v158, v159
    v_cvt_pk_bf16_f32 v166, v160, v161
    v_cvt_pk_bf16_f32 v167, v162, v163
    s_nop 0
    v_permlane32_swap_b32 v164, v166
    v_permlane32_swap_b32 v165, v167
    s_nop 0
    v_permlane16_swap_b32 v164, v166
    v_permlane16_swap_b32 v165, v167
    s_add_u32 s67, s59, 396288
    buffer_store_dwordx4 v[164:167], v13, s[48:51], s67 offen
    v_accvgpr_read_b32 v144, a96
    v_accvgpr_read_b32 v145, a97
    v_accvgpr_read_b32 v146, a98
    v_accvgpr_read_b32 v147, a99
    v_accvgpr_read_b32 v148, a108
    v_accvgpr_read_b32 v149, a109
    v_accvgpr_read_b32 v150, a110
    v_accvgpr_read_b32 v151, a111
    v_mul_f32 v144, v144, v42
    v_mul_f32 v145, v145, v42
    v_mul_f32 v146, v146, v42
    v_mul_f32 v147, v147, v42
    v_mul_f32 v148, v148, v42
    v_mul_f32 v149, v149, v42
    v_mul_f32 v150, v150, v42
    v_mul_f32 v151, v151, v42
    v_cvt_pk_bf16_f32 v152, v144, v145
    v_cvt_pk_bf16_f32 v153, v146, v147
    v_cvt_pk_bf16_f32 v154, v148, v149
    v_cvt_pk_bf16_f32 v155, v150, v151
    s_nop 0
    v_permlane32_swap_b32 v152, v154
    v_permlane32_swap_b32 v153, v155
    s_nop 0
    v_permlane16_swap_b32 v152, v154
    v_permlane16_swap_b32 v153, v155
    s_add_u32 s67, s59, 4096
    s_waitcnt vmcnt(56)
    buffer_store_dwordx4 v[152:155], v13, s[48:51], s67 offen
    v_accvgpr_read_b32 v156, a100
    v_accvgpr_read_b32 v157, a101
    v_accvgpr_read_b32 v158, a102
    v_accvgpr_read_b32 v159, a103
    v_accvgpr_read_b32 v160, a112
    v_accvgpr_read_b32 v161, a113
    v_accvgpr_read_b32 v162, a114
    v_accvgpr_read_b32 v163, a115
    v_mul_f32 v156, v156, v43
    v_mul_f32 v157, v157, v43
    v_mul_f32 v158, v158, v43
    v_mul_f32 v159, v159, v43
    v_mul_f32 v160, v160, v43
    v_mul_f32 v161, v161, v43
    v_mul_f32 v162, v162, v43
    v_mul_f32 v163, v163, v43
    v_cvt_pk_bf16_f32 v164, v156, v157
    v_cvt_pk_bf16_f32 v165, v158, v159
    v_cvt_pk_bf16_f32 v166, v160, v161
    v_cvt_pk_bf16_f32 v167, v162, v163
    s_nop 0
    v_permlane32_swap_b32 v164, v166
    v_permlane32_swap_b32 v165, v167
    s_nop 0
    v_permlane16_swap_b32 v164, v166
    v_permlane16_swap_b32 v165, v167
    s_add_u32 s67, s59, 200704
    buffer_store_dwordx4 v[164:167], v13, s[48:51], s67 offen
    v_accvgpr_read_b32 v144, a104
    v_accvgpr_read_b32 v145, a105
    v_accvgpr_read_b32 v146, a106
    v_accvgpr_read_b32 v147, a107
    v_accvgpr_read_b32 v148, a116
    v_accvgpr_read_b32 v149, a117
    v_accvgpr_read_b32 v150, a118
    v_accvgpr_read_b32 v151, a119
    v_mul_f32 v144, v144, v44
    v_mul_f32 v145, v145, v44
    v_mul_f32 v146, v146, v44
    v_mul_f32 v147, v147, v44
    v_mul_f32 v148, v148, v44
    v_mul_f32 v149, v149, v44
    v_mul_f32 v150, v150, v44
    v_mul_f32 v151, v151, v44
    v_cvt_pk_bf16_f32 v152, v144, v145
    v_cvt_pk_bf16_f32 v153, v146, v147
    v_cvt_pk_bf16_f32 v154, v148, v149
    v_cvt_pk_bf16_f32 v155, v150, v151
    s_nop 0
    v_permlane32_swap_b32 v152, v154
    v_permlane32_swap_b32 v153, v155
    s_nop 0
    v_permlane16_swap_b32 v152, v154
    v_permlane16_swap_b32 v153, v155
    s_add_u32 s67, s59, 397312
    buffer_store_dwordx4 v[152:155], v13, s[48:51], s67 offen
    v_accvgpr_read_b32 v156, a120
    v_accvgpr_read_b32 v157, a121
    v_accvgpr_read_b32 v158, a122
    v_accvgpr_read_b32 v159, a123
    v_accvgpr_read_b32 v160, a132
    v_accvgpr_read_b32 v161, a133
    v_accvgpr_read_b32 v162, a134
    v_accvgpr_read_b32 v163, a135
    v_mul_f32 v156, v156, v42
    v_mul_f32 v157, v157, v42
    v_mul_f32 v158, v158, v42
    v_mul_f32 v159, v159, v42
    v_mul_f32 v160, v160, v42
    v_mul_f32 v161, v161, v42
    v_mul_f32 v162, v162, v42
    v_mul_f32 v163, v163, v42
    v_cvt_pk_bf16_f32 v164, v156, v157
    v_cvt_pk_bf16_f32 v165, v158, v159
    v_cvt_pk_bf16_f32 v166, v160, v161
    v_cvt_pk_bf16_f32 v167, v162, v163
    s_nop 0
    v_permlane32_swap_b32 v164, v166
    v_permlane32_swap_b32 v165, v167
    s_nop 0
    v_permlane16_swap_b32 v164, v166
    v_permlane16_swap_b32 v165, v167
    s_add_u32 s67, s59, 5120
    buffer_store_dwordx4 v[164:167], v13, s[48:51], s67 offen
    v_accvgpr_read_b32 v144, a124
    v_accvgpr_read_b32 v145, a125
    v_accvgpr_read_b32 v146, a126
    v_accvgpr_read_b32 v147, a127
    v_accvgpr_read_b32 v148, a136
    v_accvgpr_read_b32 v149, a137
    v_accvgpr_read_b32 v150, a138
    v_accvgpr_read_b32 v151, a139
    v_mul_f32 v144, v144, v43
    v_mul_f32 v145, v145, v43
    v_mul_f32 v146, v146, v43
    v_mul_f32 v147, v147, v43
    v_mul_f32 v148, v148, v43
    v_mul_f32 v149, v149, v43
    v_mul_f32 v150, v150, v43
    v_mul_f32 v151, v151, v43
    v_cvt_pk_bf16_f32 v152, v144, v145
    v_cvt_pk_bf16_f32 v153, v146, v147
    v_cvt_pk_bf16_f32 v154, v148, v149
    v_cvt_pk_bf16_f32 v155, v150, v151
    s_nop 0
    v_permlane32_swap_b32 v152, v154
    v_permlane32_swap_b32 v153, v155
    s_nop 0
    v_permlane16_swap_b32 v152, v154
    v_permlane16_swap_b32 v153, v155
    s_add_u32 s67, s59, 201728
    s_waitcnt vmcnt(56)
    buffer_store_dwordx4 v[152:155], v13, s[48:51], s67 offen
    v_accvgpr_read_b32 v156, a128
    v_accvgpr_read_b32 v157, a129
    v_accvgpr_read_b32 v158, a130
    v_accvgpr_read_b32 v159, a131
    v_accvgpr_read_b32 v160, a140
    v_accvgpr_read_b32 v161, a141
    v_accvgpr_read_b32 v162, a142
    v_accvgpr_read_b32 v163, a143
    v_mul_f32 v156, v156, v44
    v_mul_f32 v157, v157, v44
    v_mul_f32 v158, v158, v44
    v_mul_f32 v159, v159, v44
    v_mul_f32 v160, v160, v44
    v_mul_f32 v161, v161, v44
    v_mul_f32 v162, v162, v44
    v_mul_f32 v163, v163, v44
    v_cvt_pk_bf16_f32 v164, v156, v157
    v_cvt_pk_bf16_f32 v165, v158, v159
    v_cvt_pk_bf16_f32 v166, v160, v161
    v_cvt_pk_bf16_f32 v167, v162, v163
    s_nop 0
    v_permlane32_swap_b32 v164, v166
    v_permlane32_swap_b32 v165, v167
    s_nop 0
    v_permlane16_swap_b32 v164, v166
    v_permlane16_swap_b32 v165, v167
    s_add_u32 s67, s59, 398336
    buffer_store_dwordx4 v[164:167], v13, s[48:51], s67 offen
    s_sub_u32 s77, s77, 16384
    s_add_u32 s56, s56, 196608
    s_add_u32 s57, s57, 384
    s_add_u32 s59, s59, 6144
    s_mov_b32 s80, s62
    s_mov_b32 s81, s63
    s_mov_b32 s82, s64
    s_mov_b32 s83, s65
    s_mov_b32 s84, s60
    s_mov_b32 s85, s61
    s_mov_b32 s60, s80
    s_mov_b32 s61, s81
    s_mov_b32 s62, s82
    s_mov_b32 s63, s83
    s_mov_b32 s64, s84
    s_mov_b32 s65, s85
    s_add_u32 s76, s76, 1
    s_cmp_lt_u32 s76, 2
    s_cbranch_scc1 L1_head
L1_end:
    s_endpgm
L1_rescale:
    s_nop 15
    v_mov_b32 v39, v36
    v_mov_b32 v40, v37
    v_mov_b32 v41, v38
    s_nop 1
    v_permlane16_swap_b32 v36, v39
    v_permlane16_swap_b32 v37, v40
    v_permlane16_swap_b32 v38, v41
    s_nop 1
    v_max_f32 v36, v36, v39
    v_max_f32 v37, v37, v40
    v_max_f32 v38, v38, v41
    s_nop 1
    v_mov_b32 v39, v36
    v_mov_b32 v40, v37
    v_mov_b32 v41, v38
    s_nop 1
    v_permlane32_swap_b32 v36, v39
    v_permlane32_swap_b32 v37, v40
    v_permlane32_swap_b32 v38, v41
    s_nop 1
    v_max_f32 v36, v36, v39
    v_max_f32 v37, v37, v40
    v_max_f32 v38, v38, v41
    s_nop 1
    v_mul_f32 v39, s70, v36
    v_mul_f32 v40, s70, v37
    v_mul_f32 v41, s70, v38
    v_max_f32 v39, v39, v30
    v_max_f32 v40, v40, v31
    v_max_f32 v41, v41, v32
    v_sub_f32 v42, v30, v39
    v_sub_f32 v43, v31, v40
    v_sub_f32 v44, v32, v41
    v_exp_f32 v42, v42
    v_exp_f32 v43, v43
    v_exp_f32 v44, v44
    v_mov_b32 v30, v39
    v_mov_b32 v31, v40
    v_mov_b32 v32, v41
    s_nop 1
    v_accvgpr_read_b32 v45, a216
    v_mul_f32 v45, v45, v42
    v_accvgpr_write_b32 a216, v45
    v_accvgpr_read_b32 v46, a217
    v_mul_f32 v46, v46, v42
    v_accvgpr_write_b32 a217, v46
    v_accvgpr_read_b32 v45, a218
    v_mul_f32 v45, v45, v42
    v_accvgpr_write_b32 a218, v45
    v_accvgpr_read_b32 v46, a219
    v_mul_f32 v46, v46, v42
    v_accvgpr_write_b32 a219, v46
    v_accvgpr_read_b32 v45, a220
    v_mul_f32 v45, v45, v43
    v_accvgpr_write_b32 a220, v45
    v_accvgpr_read_b32 v46, a221
    v_mul_f32 v46, v46, v43
    v_accvgpr_write_b32 a221, v46
    v_accvgpr_read_b32 v45, a222
    v_mul_f32 v45, v45, v43
    v_accvgpr_write_b32 a222, v45
    v_accvgpr_read_b32 v46, a223
    v_mul_f32 v46, v46, v43
    v_accvgpr_write_b32 a223, v46
    v_accvgpr_read_b32 v45, a224
    v_mul_f32 v45, v45, v44
    v_accvgpr_write_b32 a224, v45
    v_accvgpr_read_b32 v46, a225
    v_mul_f32 v46, v46, v44
    v_accvgpr_write_b32 a225, v46
    v_accvgpr_read_b32 v45, a226
    v_mul_f32 v45, v45, v44
    v_accvgpr_write_b32 a226, v45
    v_accvgpr_read_b32 v46, a227
    v_mul_f32 v46, v46, v44
    v_accvgpr_write_b32 a227, v46
    v_accvgpr_read_b32 v45, a0
    v_mul_f32 v45, v45, v42
    v_accvgpr_write_b32 a0, v45
    v_accvgpr_read_b32 v46, a1
    v_mul_f32 v46, v46, v42
    v_accvgpr_write_b32 a1, v46
    v_accvgpr_read_b32 v45, a2
    v_mul_f32 v45, v45, v42
    v_accvgpr_write_b32 a2, v45
    v_accvgpr_read_b32 v46, a3
    v_mul_f32 v46, v46, v42
    v_accvgpr_write_b32 a3, v46
    v_accvgpr_read_b32 v45, a4
    v_mul_f32 v45, v45, v43
    v_accvgpr_write_b32 a4, v45
    v_accvgpr_read_b32 v46, a5
    v_mul_f32 v46, v46, v43
    v_accvgpr_write_b32 a5, v46
    v_accvgpr_read_b32 v45, a6
    v_mul_f32 v45, v45, v43
    v_accvgpr_write_b32 a6, v45
    v_accvgpr_read_b32 v46, a7
    v_mul_f32 v46, v46, v43
    v_accvgpr_write_b32 a7, v46
    v_accvgpr_read_b32 v45, a8
    v_mul_f32 v45, v45, v44
    v_accvgpr_write_b32 a8, v45
    v_accvgpr_read_b32 v46, a9
    v_mul_f32 v46, v46, v44
    v_accvgpr_write_b32 a9, v46
    v_accvgpr_read_b32 v45, a10
    v_mul_f32 v45, v45, v44
    v_accvgpr_write_b32 a10, v45
    v_accvgpr_read_b32 v46, a11
    v_mul_f32 v46, v46, v44
    v_accvgpr_write_b32 a11, v46
    v_accvgpr_read_b32 v45, a12
    v_mul_f32 v45, v45, v42
    v_accvgpr_write_b32 a12, v45
    v_accvgpr_read_b32 v46, a13
    v_mul_f32 v46, v46, v42
    v_accvgpr_write_b32 a13, v46
    v_accvgpr_read_b32 v45, a14
    v_mul_f32 v45, v45, v42
    v_accvgpr_write_b32 a14, v45
    v_accvgpr_read_b32 v46, a15
    v_mul_f32 v46, v46, v42
    v_accvgpr_write_b32 a15, v46
    v_accvgpr_read_b32 v45, a16
    v_mul_f32 v45, v45, v43
    v_accvgpr_write_b32 a16, v45
    v_accvgpr_read_b32 v46, a17
    v_mul_f32 v46, v46, v43
    v_accvgpr_write_b32 a17, v46
    v_accvgpr_read_b32 v45, a18
    v_mul_f32 v45, v45, v43
    v_accvgpr_write_b32 a18, v45
    v_accvgpr_read_b32 v46, a19
    v_mul_f32 v46, v46, v43
    v_accvgpr_write_b32 a19, v46
    v_accvgpr_read_b32 v45, a20
    v_mul_f32 v45, v45, v44
    v_accvgpr_write_b32 a20, v45
    v_accvgpr_read_b32 v46, a21
    v_mul_f32 v46, v46, v44
    v_accvgpr_write_b32 a21, v46
    v_accvgpr_read_b32 v45, a22
    v_mul_f32 v45, v45, v44
    v_accvgpr_write_b32 a22, v45
    v_accvgpr_read_b32 v46, a23
    v_mul_f32 v46, v46, v44
    v_accvgpr_write_b32 a23, v46
    v_accvgpr_read_b32 v45, a24
    v_mul_f32 v45, v45, v42
    v_accvgpr_write_b32 a24, v45
    v_accvgpr_read_b32 v46, a25
    v_mul_f32 v46, v46, v42
    v_accvgpr_write_b32 a25, v46
    v_accvgpr_read_b32 v45, a26
    v_mul_f32 v45, v45, v42
    v_accvgpr_write_b32 a26, v45
    v_accvgpr_read_b32 v46, a27
    v_mul_f32 v46, v46, v42
    v_accvgpr_write_b32 a27, v46
    v_accvgpr_read_b32 v45, a28
    v_mul_f32 v45, v45, v43
    v_accvgpr_write_b32 a28, v45
    v_accvgpr_read_b32 v46, a29
    v_mul_f32 v46, v46, v43
    v_accvgpr_write_b32 a29, v46
    v_accvgpr_read_b32 v45, a30
    v_mul_f32 v45, v45, v43
    v_accvgpr_write_b32 a30, v45
    v_accvgpr_read_b32 v46, a31
    v_mul_f32 v46, v46, v43
    v_accvgpr_write_b32 a31, v46
    v_accvgpr_read_b32 v45, a32
    v_mul_f32 v45, v45, v44
    v_accvgpr_write_b32 a32, v45
    v_accvgpr_read_b32 v46, a33
    v_mul_f32 v46, v46, v44
    v_accvgpr_write_b32 a33, v46
    v_accvgpr_read_b32 v45, a34
    v_mul_f32 v45, v45, v44
    v_accvgpr_write_b32 a34, v45
    v_accvgpr_read_b32 v46, a35
    v_mul_f32 v46, v46, v44
    v_accvgpr_write_b32 a35, v46
    v_accvgpr_read_b32 v45, a36
    v_mul_f32 v45, v45, v42
    v_accvgpr_write_b32 a36, v45
    v_accvgpr_read_b32 v46, a37
    v_mul_f32 v46, v46, v42
    v_accvgpr_write_b32 a37, v46
    v_accvgpr_read_b32 v45, a38
    v_mul_f32 v45, v45, v42
    v_accvgpr_write_b32 a38, v45
    v_accvgpr_read_b32 v46, a39
    v_mul_f32 v46, v46, v42
    v_accvgpr_write_b32 a39, v46
    v_accvgpr_read_b32 v45, a40
    v_mul_f32 v45, v45, v43
    v_accvgpr_write_b32 a40, v45
    v_accvgpr_read_b32 v46, a41
    v_mul_f32 v46, v46, v43
    v_accvgpr_write_b32 a41, v46
    v_accvgpr_read_b32 v45, a42
    v_mul_f32 v45, v45, v43
    v_accvgpr_write_b32 a42, v45
    v_accvgpr_read_b32 v46, a43
    v_mul_f32 v46, v46, v43
    v_accvgpr_write_b32 a43, v46
    v_accvgpr_read_b32 v45, a44
    v_mul_f32 v45, v45, v44
    v_accvgpr_write_b32 a44, v45
    v_accvgpr_read_b32 v46, a45
    v_mul_f32 v46, v46, v44
    v_accvgpr_write_b32 a45, v46
    v_accvgpr_read_b32 v45, a46
    v_mul_f32 v45, v45, v44
    v_accvgpr_write_b32 a46, v45
    v_accvgpr_read_b32 v46, a47
    v_mul_f32 v46, v46, v44
    v_accvgpr_write_b32 a47, v46
    v_accvgpr_read_b32 v45, a48
    v_mul_f32 v45, v45, v42
    v_accvgpr_write_b32 a48, v45
    v_accvgpr_read_b32 v46, a49
    v_mul_f32 v46, v46, v42
    v_accvgpr_write_b32 a49, v46
    v_accvgpr_read_b32 v45, a50
    v_mul_f32 v45, v45, v42
    v_accvgpr_write_b32 a50, v45
    v_accvgpr_read_b32 v46, a51
    v_mul_f32 v46, v46, v42
    v_accvgpr_write_b32 a51, v46
    v_accvgpr_read_b32 v45, a52
    v_mul_f32 v45, v45, v43
    v_accvgpr_write_b32 a52, v45
    v_accvgpr_read_b32 v46, a53
    v_mul_f32 v46, v46, v43
    v_accvgpr_write_b32 a53, v46
    v_accvgpr_read_b32 v45, a54
    v_mul_f32 v45, v45, v43
    v_accvgpr_write_b32 a54, v45
    v_accvgpr_read_b32 v46, a55
    v_mul_f32 v46, v46, v43
    v_accvgpr_write_b32 a55, v46
    v_accvgpr_read_b32 v45, a56
    v_mul_f32 v45, v45, v44
    v_accvgpr_write_b32 a56, v45
    v_accvgpr_read_b32 v46, a57
    v_mul_f32 v46, v46, v44
    v_accvgpr_write_b32 a57, v46
    v_accvgpr_read_b32 v45, a58
    v_mul_f32 v45, v45, v44
    v_accvgpr_write_b32 a58, v45
    v_accvgpr_read_b32 v46, a59
    v_mul_f32 v46, v46, v44
    v_accvgpr_write_b32 a59, v46
    v_accvgpr_read_b32 v45, a60
    v_mul_f32 v45, v45, v42
    v_accvgpr_write_b32 a60, v45
    v_accvgpr_read_b32 v46, a61
    v_mul_f32 v46, v46, v42
    v_accvgpr_write_b32 a61, v46
    v_accvgpr_read_b32 v45, a62
    v_mul_f32 v45, v45, v42
    v_accvgpr_write_b32 a62, v45
    v_accvgpr_read_b32 v46, a63
    v_mul_f32 v46, v46, v42
    v_accvgpr_write_b32 a63, v46
    v_accvgpr_read_b32 v45, a64
    v_mul_f32 v45, v45, v43
    v_accvgpr_write_b32 a64, v45
    v_accvgpr_read_b32 v46, a65
    v_mul_f32 v46, v46, v43
    v_accvgpr_write_b32 a65, v46
    v_accvgpr_read_b32 v45, a66
    v_mul_f32 v45, v45, v43
    v_accvgpr_write_b32 a66, v45
    v_accvgpr_read_b32 v46, a67
    v_mul_f32 v46, v46, v43
    v_accvgpr_write_b32 a67, v46
    v_accvgpr_read_b32 v45, a68
    v_mul_f32 v45, v45, v44
    v_accvgpr_write_b32 a68, v45
    v_accvgpr_read_b32 v46, a69
    v_mul_f32 v46, v46, v44
    v_accvgpr_write_b32 a69, v46
    v_accvgpr_read_b32 v45, a70
    v_mul_f32 v45, v45, v44
    v_accvgpr_write_b32 a70, v45
    v_accvgpr_read_b32 v46, a71
    v_mul_f32 v46, v46, v44
    v_accvgpr_write_b32 a71, v46
    v_accvgpr_read_b32 v45, a72
    v_mul_f32 v45, v45, v42
    v_accvgpr_write_b32 a72, v45
    v_accvgpr_read_b32 v46, a73
    v_mul_f32 v46, v46, v42
    v_accvgpr_write_b32 a73, v46
    v_accvgpr_read_b32 v45, a74
    v_mul_f32 v45, v45, v42
    v_accvgpr_write_b32 a74, v45
    v_accvgpr_read_b32 v46, a75
    v_mul_f32 v46, v46, v42
    v_accvgpr_write_b32 a75, v46
    v_accvgpr_read_b32 v45, a76
    v_mul_f32 v45, v45, v43
    v_accvgpr_write_b32 a76, v45
    v_accvgpr_read_b32 v46, a77
    v_mul_f32 v46, v46, v43
    v_accvgpr_write_b32 a77, v46
    v_accvgpr_read_b32 v45, a78
    v_mul_f32 v45, v45, v43
    v_accvgpr_write_b32 a78, v45
    v_accvgpr_read_b32 v46, a79
    v_mul_f32 v46, v46, v43
    v_accvgpr_write_b32 a79, v46
    v_accvgpr_read_b32 v45, a80
    v_mul_f32 v45, v45, v44
    v_accvgpr_write_b32 a80, v45
    v_accvgpr_read_b32 v46, a81
    v_mul_f32 v46, v46, v44
    v_accvgpr_write_b32 a81, v46
    v_accvgpr_read_b32 v45, a82
    v_mul_f32 v45, v45, v44
    v_accvgpr_write_b32 a82, v45
    v_accvgpr_read_b32 v46, a83
    v_mul_f32 v46, v46, v44
    v_accvgpr_write_b32 a83, v46
    v_accvgpr_read_b32 v45, a84
    v_mul_f32 v45, v45, v42
    v_accvgpr_write_b32 a84, v45
    v_accvgpr_read_b32 v46, a85
    v_mul_f32 v46, v46, v42
    v_accvgpr_write_b32 a85, v46
    v_accvgpr_read_b32 v45, a86
    v_mul_f32 v45, v45, v42
    v_accvgpr_write_b32 a86, v45
    v_accvgpr_read_b32 v46, a87
    v_mul_f32 v46, v46, v42
    v_accvgpr_write_b32 a87, v46
    v_accvgpr_read_b32 v45, a88
    v_mul_f32 v45, v45, v43
    v_accvgpr_write_b32 a88, v45
    v_accvgpr_read_b32 v46, a89
    v_mul_f32 v46, v46, v43
    v_accvgpr_write_b32 a89, v46
    v_accvgpr_read_b32 v45, a90
    v_mul_f32 v45, v45, v43
    v_accvgpr_write_b32 a90, v45
    v_accvgpr_read_b32 v46, a91
    v_mul_f32 v46, v46, v43
    v_accvgpr_write_b32 a91, v46
    v_accvgpr_read_b32 v45, a92
    v_mul_f32 v45, v45, v44
    v_accvgpr_write_b32 a92, v45
    v_accvgpr_read_b32 v46, a93
    v_mul_f32 v46, v46, v44
    v_accvgpr_write_b32 a93, v46
    v_accvgpr_read_b32 v45, a94
    v_mul_f32 v45, v45, v44
    v_accvgpr_write_b32 a94, v45
    v_accvgpr_read_b32 v46, a95
    v_mul_f32 v46, v46, v44
    v_accvgpr_write_b32 a95, v46
    v_accvgpr_read_b32 v45, a96
    v_mul_f32 v45, v45, v42
    v_accvgpr_write_b32 a96, v45
    v_accvgpr_read_b32 v46, a97
    v_mul_f32 v46, v46, v42
    v_accvgpr_write_b32 a97, v46
    v_accvgpr_read_b32 v45, a98
    v_mul_f32 v45, v45, v42
    v_accvgpr_write_b32 a98, v45
    v_accvgpr_read_b32 v46, a99
    v_mul_f32 v46, v46, v42
    v_accvgpr_write_b32 a99, v46
    v_accvgpr_read_b32 v45, a100
    v_mul_f32 v45, v45, v43
    v_accvgpr_write_b32 a100, v45
    v_accvgpr_read_b32 v46, a101
    v_mul_f32 v46, v46, v43
    v_accvgpr_write_b32 a101, v46
    v_accvgpr_read_b32 v45, a102
    v_mul_f32 v45, v45, v43
    v_accvgpr_write_b32 a102, v45
    v_accvgpr_read_b32 v46, a103
    v_mul_f32 v46, v46, v43
    v_accvgpr_write_b32 a103, v46
    v_accvgpr_read_b32 v45, a104
    v_mul_f32 v45, v45, v44
    v_accvgpr_write_b32 a104, v45
    v_accvgpr_read_b32 v46, a105
    v_mul_f32 v46, v46, v44
    v_accvgpr_write_b32 a105, v46
    v_accvgpr_read_b32 v45, a106
    v_mul_f32 v45, v45, v44
    v_accvgpr_write_b32 a106, v45
    v_accvgpr_read_b32 v46, a107
    v_mul_f32 v46, v46, v44
    v_accvgpr_write_b32 a107, v46
    v_accvgpr_read_b32 v45, a108
    v_mul_f32 v45, v45, v42
    v_accvgpr_write_b32 a108, v45
    v_accvgpr_read_b32 v46, a109
    v_mul_f32 v46, v46, v42
    v_accvgpr_write_b32 a109, v46
    v_accvgpr_read_b32 v45, a110
    v_mul_f32 v45, v45, v42
    v_accvgpr_write_b32 a110, v45
    v_accvgpr_read_b32 v46, a111
    v_mul_f32 v46, v46, v42
    v_accvgpr_write_b32 a111, v46
    v_accvgpr_read_b32 v45, a112
    v_mul_f32 v45, v45, v43
    v_accvgpr_write_b32 a112, v45
    v_accvgpr_read_b32 v46, a113
    v_mul_f32 v46, v46, v43
    v_accvgpr_write_b32 a113, v46
    v_accvgpr_read_b32 v45, a114
    v_mul_f32 v45, v45, v43
    v_accvgpr_write_b32 a114, v45
    v_accvgpr_read_b32 v46, a115
    v_mul_f32 v46, v46, v43
    v_accvgpr_write_b32 a115, v46
    v_accvgpr_read_b32 v45, a116
    v_mul_f32 v45, v45, v44
    v_accvgpr_write_b32 a116, v45
    v_accvgpr_read_b32 v46, a117
    v_mul_f32 v46, v46, v44
    v_accvgpr_write_b32 a117, v46
    v_accvgpr_read_b32 v45, a118
    v_mul_f32 v45, v45, v44
    v_accvgpr_write_b32 a118, v45
    v_accvgpr_read_b32 v46, a119
    v_mul_f32 v46, v46, v44
    v_accvgpr_write_b32 a119, v46
    v_accvgpr_read_b32 v45, a120
    v_mul_f32 v45, v45, v42
    v_accvgpr_write_b32 a120, v45
    v_accvgpr_read_b32 v46, a121
    v_mul_f32 v46, v46, v42
    v_accvgpr_write_b32 a121, v46
    v_accvgpr_read_b32 v45, a122
    v_mul_f32 v45, v45, v42
    v_accvgpr_write_b32 a122, v45
    v_accvgpr_read_b32 v46, a123
    v_mul_f32 v46, v46, v42
    v_accvgpr_write_b32 a123, v46
    v_accvgpr_read_b32 v45, a124
    v_mul_f32 v45, v45, v43
    v_accvgpr_write_b32 a124, v45
    v_accvgpr_read_b32 v46, a125
    v_mul_f32 v46, v46, v43
    v_accvgpr_write_b32 a125, v46
    v_accvgpr_read_b32 v45, a126
    v_mul_f32 v45, v45, v43
    v_accvgpr_write_b32 a126, v45
    v_accvgpr_read_b32 v46, a127
    v_mul_f32 v46, v46, v43
    v_accvgpr_write_b32 a127, v46
    v_accvgpr_read_b32 v45, a128
    v_mul_f32 v45, v45, v44
    v_accvgpr_write_b32 a128, v45
    v_accvgpr_read_b32 v46, a129
    v_mul_f32 v46, v46, v44
    v_accvgpr_write_b32 a129, v46
    v_accvgpr_read_b32 v45, a130
    v_mul_f32 v45, v45, v44
    v_accvgpr_write_b32 a130, v45
    v_accvgpr_read_b32 v46, a131
    v_mul_f32 v46, v46, v44
    v_accvgpr_write_b32 a131, v46
    v_accvgpr_read_b32 v45, a132
    v_mul_f32 v45, v45, v42
    v_accvgpr_write_b32 a132, v45
    v_accvgpr_read_b32 v46, a133
    v_mul_f32 v46, v46, v42
    v_accvgpr_write_b32 a133, v46
    v_accvgpr_read_b32 v45, a134
    v_mul_f32 v45, v45, v42
    v_accvgpr_write_b32 a134, v45
    v_accvgpr_read_b32 v46, a135
    v_mul_f32 v46, v46, v42
    v_accvgpr_write_b32 a135, v46
    v_accvgpr_read_b32 v45, a136
    v_mul_f32 v45, v45, v43
    v_accvgpr_write_b32 a136, v45
    v_accvgpr_read_b32 v46, a137
    v_mul_f32 v46, v46, v43
    v_accvgpr_write_b32 a137, v46
    v_accvgpr_read_b32 v45, a138
    v_mul_f32 v45, v45, v43
    v_accvgpr_write_b32 a138, v45
    v_accvgpr_read_b32 v46, a139
    v_mul_f32 v46, v46, v43
    v_accvgpr_write_b32 a139, v46
    v_accvgpr_read_b32 v45, a140
    v_mul_f32 v45, v45, v44
    v_accvgpr_write_b32 a140, v45
    v_accvgpr_read_b32 v46, a141
    v_mul_f32 v46, v46, v44
    v_accvgpr_write_b32 a141, v46
    v_accvgpr_read_b32 v45, a142
    v_mul_f32 v45, v45, v44
    v_accvgpr_write_b32 a142, v45
    v_accvgpr_read_b32 v46, a143
    v_mul_f32 v46, v46, v44
    v_accvgpr_write_b32 a143, v46
    s_nop 3
    s_setpc_b64 s[72:73]
.globl oproj_kernel
.p2align 8
.type oproj_kernel,@function
oproj_kernel:
    s_cmp_ge_u32 s2, 256
    s_cbranch_scc1 L2_end
    s_load_dwordx2 s[4:5], s[0:1], 32
    s_load_dwordx2 s[6:7], s[0:1], 72
    s_load_dwordx2 s[22:23], s[0:1], 96
    s_and_b32 s24, s2, 7
    s_lshr_b32 s25, s2, 3
    s_lshr_b32 s26, s24, 2
    s_and_b32 s27, s24, 3
    s_lshr_b32 s28, s25, 2
    s_and_b32 s29, s25, 3
    v_lshrrev_b32 v1, 6, v0
    v_and_b32 v2, 63, v0
    v_readfirstlane_b32 s30, v1
    s_waitcnt lgkmcnt(0)
    s_cmp_eq_u32 s26, 0
    s_cselect_b32 s8, s4, s6
    s_cselect_b32 s9, s5, s7
    s_mov_b32 s10, 7864320
    s_mov_b32 s11, 0x00020000
    s_mov_b32 s12, s22
    s_mov_b32 s13, s23
    s_mov_b32 s14, 37748736
    s_mov_b32 s15, 0x00020000
    s_mov_b32 s16, s22
    s_mov_b32 s17, s23
    s_mov_b32 s18, 98566144
    s_mov_b32 s19, 0x00020000
    s_lshr_b32 s31, s30, 2
    s_lshr_b32 s32, s30, 1
    s_and_b32 s32, s32, 1
    s_and_b32 s33, s30, 1
    s_mul_i32 s34, s26, 96
    s_mul_i32 s35, s28, 12
    s_add_u32 s34, s34, s35
    s_and_b32 s35, s30, 3
    s_mul_i32 s35, s35, 3
    s_add_u32 s34, s34, s35
    s_mul_i32 s34, s34, 192
    s_mul_i32 s35, s27, 48
    s_add_u32 s34, s34, s35
    s_add_u32 s34, s34, s31
    s_lshl_b32 s34, s34, 10
    s_mul_i32 s36, s30, 3072
    s_mul_i32 s35, s27, 1966080
    s_mul_i32 s37, s29, 320
    s_add_u32 s35, s35, s37
    v_lshlrev_b32 v8, 4, v2
    s_mul_i32 s37, s30, 192
    v_add_u32 v3, 0, v2
    v_add_u32 v3, s37, v3
    v_mul_u32_u24 v4, 3277, v3
    v_lshrrev_b32 v4, 16, v4
    v_mul_u32_u24 v5, 20, v4
    v_sub_u32 v5, v3, v5
    v_bfe_u32 v6, v4, 3, 1
    v_lshlrev_b32 v6, 1, v6
    v_xor_b32 v5, v5, v6
    v_mul_u32_u24 v6, 1280, v4
    v_lshl_add_u32 v6, v5, 4, v6
    v_cmp_gt_u32 vcc, 1280, v3
    v_mov_b32 v7, 0x7fffffff
    s_nop 0
    v_cndmask_b32 v9, v7, v6, vcc
    v_add_u32 v3, 64, v2
    v_add_u32 v3, s37, v3
    v_mul_u32_u24 v4, 3277, v3
    v_lshrrev_b32 v4, 16, v4
    v_mul_u32_u24 v5, 20, v4
    v_sub_u32 v5, v3, v5
    v_bfe_u32 v6, v4, 3, 1
    v_lshlrev_b32 v6, 1, v6
    v_xor_b32 v5, v5, v6
    v_mul_u32_u24 v6, 1280, v4
    v_lshl_add_u32 v6, v5, 4, v6
    v_cmp_gt_u32 vcc, 1280, v3
    v_mov_b32 v7, 0x7fffffff
    s_nop 0
    v_cndmask_b32 v10, v7, v6, vcc
    v_add_u32 v3, 128, v2
    v_add_u32 v3, s37, v3
    v_mul_u32_u24 v4, 3277, v3
    v_lshrrev_b32 v4, 16, v4
    v_mul_u32_u24 v5, 20, v4
    v_sub_u32 v5, v3, v5
    v_bfe_u32 v6, v4, 3, 1
    v_lshlrev_b32 v6, 1, v6
    v_xor_b32 v5, v5, v6
    v_mul_u32_u24 v6, 1280, v4
    v_lshl_add_u32 v6, v5, 4, v6
    v_cmp_gt_u32 vcc, 1280, v3
    v_mov_b32 v7, 0x7fffffff
    s_nop 0
    v_cndmask_b32 v11, v7, v6, vcc
    s_mul_i32 s37, s31, 12
    s_mul_i32 s38, s32, 6
    s_add_u32 s37, s37, s38
    s_lshl_b32 s37, s37, 10
    v_add_u32 v12, s37, v8
    v_and_b32 v3, 15, v2
    v_lshrrev_b32 v4, 4, v2
    v_lshrrev_b32 v5, 2, v3
    v_lshl_add_u32 v5, v4, 3, v5
    s_lshl_b32 s37, s31, 5
    v_add_u32 v5, s37, v5
    v_mul_u32_u24 v5, 320, v5
    v_and_b32 v6, 1, v3
    v_lshl_add_u32 v5, v6, 3, v5
    v_bfe_u32 v6, v3, 1, 1
    v_lshl_add_u32 v5, v6, 4, v5
    v_add_u32 v5, 24576, v5
    v_and_b32 v6, 1, v4
    s_mul_i32 s37, s33, 5
    v_add_u32 v7, 0, v6
    s_add_u32 s38, s37, 0
    v_xor_b32 v7, s38, v6
    v_lshl_add_u32 v13, v7, 5, v5
    v_add_u32 v7, 0, v6
    s_add_u32 s38, s37, 1
    v_xor_b32 v7, s38, v6
    v_lshl_add_u32 v14, v7, 5, v5
    v_add_u32 v7, 0, v6
    s_add_u32 s38, s37, 2
    v_xor_b32 v7, s38, v6
    v_lshl_add_u32 v15, v7, 5, v5
    v_add_u32 v7, 0, v6
    s_add_u32 s38, s37, 3
    v_xor_b32 v7, s38, v6
    v_lshl_add_u32 v16, v7, 5, v5
    v_add_u32 v7, 0, v6
    s_add_u32 s38, s37, 4
    v_xor_b32 v7, s38, v6
    v_lshl_add_u32 v17, v7, 5, v5
    v_add_u32 v20, 0, v12
    v_add_u32 v21, 0, v13
    v_add_u32 v22, 0, v14
    v_add_u32 v23, 0, v15
    v_add_u32 v24, 0, v16
    v_add_u32 v25, 0, v17
    v_add_u32 v26, 49152, v12
    v_add_u32 v27, 49152, v13
    v_add_u32 v28, 49152, v14
    v_add_u32 v29, 49152, v15
    v_add_u32 v30, 49152, v16
    v_add_u32 v31, 49152, v17
    v_add_u32 v32, 98304, v12
    v_add_u32 v33, 98304, v13
    v_add_u32 v34, 98304, v14
    v_add_u32 v35, 98304, v15
    v_add_u32 v36, 98304, v16
    v_add_u32 v37, 98304, v17
    s_add_u32 m0, s36, 0
    s_add_u32 s39, s34, 0
    buffer_load_dwordx4 v8, s[12:15], s39 offen lds
    s_add_u32 m0, s36, 1024
    s_add_u32 s39, s34, 196608
    buffer_load_dwordx4 v8, s[12:15], s39 offen lds
    s_add_u32 m0, s36, 2048
    s_add_u32 s39, s34, 393216
    buffer_load_dwordx4 v8, s[12:15], s39 offen lds
    s_add_u32 m0, s36, 24576
    s_nop 0
    buffer_load_dwordx4 v9, s[8:11], s35 offen lds
    s_add_u32 m0, s36, 25600
    s_nop 0
    buffer_load_dwordx4 v10, s[8:11], s35 offen lds
    s_add_u32 m0, s36, 26624
    s_nop 0
    buffer_load_dwordx4 v11, s[8:11], s35 offen lds
    s_add_u32 s34, s34, 2048
    s_add_u32 s35, s35, 81920
    s_add_u32 m0, s36, 49152
    s_add_u32 s39, s34, 0
    buffer_load_dwordx4 v8, s[12:15], s39 offen lds
    s_add_u32 m0, s36, 50176
    s_add_u32 s39, s34, 196608
    buffer_load_dwordx4 v8, s[12:15], s39 offen lds
    s_add_u32 m0, s36, 51200
    s_add_u32 s39, s34, 393216
    buffer_load_dwordx4 v8, s[12:15], s39 offen lds
    s_add_u32 m0, s36, 73728
    s_nop 0
    buffer_load_dwordx4 v9, s[8:11], s35 offen lds
    s_add_u32 m0, s36, 74752
    s_nop 0
    buffer_load_dwordx4 v10, s[8:11], s35 offen lds
    s_add_u32 m0, s36, 75776
    s_nop 0
    buffer_load_dwordx4 v11, s[8:11], s35 offen lds
    s_add_u32 s34, s34, 2048
    s_add_u32 s35, s35, 81920
    s_add_u32 m0, s36, 98304
    s_add_u32 s39, s34, 0
    buffer_load_dwordx4 v8, s[12:15], s39 offen lds
    s_add_u32 m0, s36, 99328
    s_add_u32 s39, s34, 196608
    buffer_load_dwordx4 v8, s[12:15], s39 offen lds
    s_add_u32 m0, s36, 100352
    s_add_u32 s39, s34, 393216
    buffer_load_dwordx4 v8, s[12:15], s39 offen lds
    s_add_u32 m0, s36, 122880
    s_nop 0
    buffer_load_dwordx4 v9, s[8:11], s35 offen lds
    s_add_u32 m0, s36, 123904
    s_nop 0
    buffer_load_dwordx4 v10, s[8:11], s35 offen lds
    s_add_u32 m0, s36, 124928
    s_nop 0
    buffer_load_dwordx4 v11, s[8:11], s35 offen lds
    s_add_u32 s34, s34, 2048
    s_add_u32 s35, s35, 81920
    s_waitcnt vmcnt(12)
    s_barrier
    ds_read_b64_tr_b16 v[64:65], v21
    ds_read_b64_tr_b16 v[66:67], v21 offset:1280
    ds_read_b128 v[40:43], v20 offset:0
    ds_read_b128 v[44:47], v20 offset:1024
    ds_read_b128 v[48:51], v20 offset:2048
    ds_read_b64_tr_b16 v[68:69], v22
    ds_read_b64_tr_b16 v[70:71], v22 offset:1280
    ds_read_b128 v[52:55], v20 offset:3072
    ds_read_b128 v[56:59], v20 offset:4096
    ds_read_b128 v[60:63], v20 offset:5120
    ds_read_b64_tr_b16 v[72:73], v23
    ds_read_b64_tr_b16 v[74:75], v23 offset:1280
    ds_read_b64_tr_b16 v[76:77], v24
    ds_read_b64_tr_b16 v[78:79], v24 offset:1280
    ds_read_b64_tr_b16 v[80:81], v25
    s_waitcnt lgkmcnt(12)
    ds_read_b64_tr_b16 v[82:83], v25 offset:1280
    s_waitcnt lgkmcnt(0)
    s_waitcnt vmcnt(6)
    s_barrier
    v_mfma_f32_16x16x32_bf16 a[0:3], v[64:67], v[40:43], 0
    ds_read_b64_tr_b16 v[108:109], v27
    ds_read_b64_tr_b16 v[110:111], v27 offset:1280
    v_mfma_f32_16x16x32_bf16 a[4:7], v[64:67], v[44:47], 0
    ds_read_b128 v[84:87], v26 offset:0
    v_mfma_f32_16x16x32_bf16 a[8:11], v[64:67], v[48:51], 0
    s_add_u32 m0, s36, 0
    s_add_u32 s39, s34, 0
    buffer_load_dwordx4 v8, s[12:15], s39 offen lds
    v_mfma_f32_16x16x32_bf16 a[12:15], v[64:67], v[52:55], 0
    ds_read_b128 v[88:91], v26 offset:1024
    v_mfma_f32_16x16x32_bf16 a[16:19], v[64:67], v[56:59], 0
    ds_read_b128 v[92:95], v26 offset:2048
    v_mfma_f32_16x16x32_bf16 a[20:23], v[64:67], v[60:63], 0
    s_add_u32 m0, s36, 1024
    s_add_u32 s39, s34, 196608
    buffer_load_dwordx4 v8, s[12:15], s39 offen lds
    v_mfma_f32_16x16x32_bf16 a[24:27], v[68:71], v[40:43], 0
    ds_read_b64_tr_b16 v[112:113], v28
    ds_read_b64_tr_b16 v[114:115], v28 offset:1280
    v_mfma_f32_16x16x32_bf16 a[28:31], v[68:71], v[44:47], 0
    ds_read_b128 v[96:99], v26 offset:3072
    v_mfma_f32_16x16x32_bf16 a[32:35], v[68:71], v[48:51], 0
    s_add_u32 m0, s36, 2048
    s_add_u32 s39, s34, 393216
    buffer_load_dwordx4 v8, s[12:15], s39 offen lds
    v_mfma_f32_16x16x32_bf16 a[36:39], v[68:71], v[52:55], 0
    ds_read_b128 v[100:103], v26 offset:4096
    v_mfma_f32_16x16x32_bf16 a[40:43], v[68:71], v[56:59], 0
    ds_read_b128 v[104:107], v26 offset:5120
    v_mfma_f32_16x16x32_bf16 a[44:47], v[68:71], v[60:63], 0
    s_add_u32 m0, s36, 24576
    s_nop 0
    buffer_load_dwordx4 v9, s[8:11], s35 offen lds
    v_mfma_f32_16x16x32_bf16 a[48:51], v[72:75], v[40:43], 0
    ds_read_b64_tr_b16 v[116:117], v29
    ds_read_b64_tr_b16 v[118:119], v29 offset:1280
    v_mfma_f32_16x16x32_bf16 a[52:55], v[72:75], v[44:47], 0
    ds_read_b64_tr_b16 v[120:121], v30
    ds_read_b64_tr_b16 v[122:123], v30 offset:1280
    v_mfma_f32_16x16x32_bf16 a[56:59], v[72:75], v[48:51], 0
    s_add_u32 m0, s36, 25600
    s_nop 0
    buffer_load_dwordx4 v10, s[8:11], s35 offen lds
    v_mfma_f32_16x16x32_bf16 a[60:63], v[72:75], v[52:55], 0
    ds_read_b64_tr_b16 v[124:125], v31
    s_waitcnt lgkmcnt(12)
    ds_read_b64_tr_b16 v[126:127], v31 offset:1280
    v_mfma_f32_16x16x32_bf16 a[64:67], v[72:75], v[56:59], 0
    s_add_u32 m0, s36, 26624
    s_nop 0
    buffer_load_dwordx4 v11, s[8:11], s35 offen lds
    s_add_u32 s34, s34, 2048
    s_add_u32 s35, s35, 81920
    v_mfma_f32_16x16x32_bf16 a[68:71], v[72:75], v[60:63], 0
    v_mfma_f32_16x16x32_bf16 a[72:75], v[76:79], v[40:43], 0
    v_mfma_f32_16x16x32_bf16 a[76:79], v[76:79], v[44:47], 0
    v_mfma_f32_16x16x32_bf16 a[80:83], v[76:79], v[48:51], 0
    v_mfma_f32_16x16x32_bf16 a[84:87], v[76:79], v[52:55], 0
    v_mfma_f32_16x16x32_bf16 a[88:91], v[76:79], v[56:59], 0
    v_mfma_f32_16x16x32_bf16 a[92:95], v[76:79], v[60:63], 0
    v_mfma_f32_16x16x32_bf16 a[96:99], v[80:83], v[40:43], 0
    v_mfma_f32_16x16x32_bf16 a[100:103], v[80:83], v[44:47], 0
    v_mfma_f32_16x16x32_bf16 a[104:107], v[80:83], v[48:51], 0
    v_mfma_f32_16x16x32_bf16 a[108:111], v[80:83], v[52:55], 0
    v_mfma_f32_16x16x32_bf16 a[112:115], v[80:83], v[56:59], 0
    v_mfma_f32_16x16x32_bf16 a[116:119], v[80:83], v[60:63], 0
    s_waitcnt lgkmcnt(0)
    s_waitcnt vmcnt(6)
    s_barrier
    v_mfma_f32_16x16x32_bf16 a[0:3], v[108:111], v[84:87], a[0:3]
    ds_read_b64_tr_b16 v[64:65], v33
    ds_read_b64_tr_b16 v[66:67], v33 offset:1280
    v_mfma_f32_16x16x32_bf16 a[4:7], v[108:111], v[88:91], a[4:7]
    ds_read_b128 v[40:43], v32 offset:0
    v_mfma_f32_16x16x32_bf16 a[8:11], v[108:111], v[92:95], a[8:11]
    s_add_u32 m0, s36, 49152
    s_add_u32 s39, s34, 0
    buffer_load_dwordx4 v8, s[12:15], s39 offen lds
    v_mfma_f32_16x16x32_bf16 a[12:15], v[108:111], v[96:99], a[12:15]
    ds_read_b128 v[44:47], v32 offset:1024
    v_mfma_f32_16x16x32_bf16 a[16:19], v[108:111], v[100:103], a[16:19]
    ds_read_b128 v[48:51], v32 offset:2048
    v_mfma_f32_16x16x32_bf16 a[20:23], v[108:111], v[104:107], a[20:23]
    s_add_u32 m0, s36, 50176
    s_add_u32 s39, s34, 196608
    buffer_load_dwordx4 v8, s[12:15], s39 offen lds
    v_mfma_f32_16x16x32_bf16 a[24:27], v[112:115], v[84:87], a[24:27]
    ds_read_b64_tr_b16 v[68:69], v34
    ds_read_b64_tr_b16 v[70:71], v34 offset:1280
    v_mfma_f32_16x16x32_bf16 a[28:31], v[112:115], v[88:91], a[28:31]
    ds_read_b128 v[52:55], v32 offset:3072
    v_mfma_f32_16x16x32_bf16 a[32:35], v[112:115], v[92:95], a[32:35]
    s_add_u32 m0, s36, 51200
    s_add_u32 s39, s34, 393216
    buffer_load_dwordx4 v8, s[12:15], s39 offen lds
    v_mfma_f32_16x16x32_bf16 a[36:39], v[112:115], v[96:99], a[36:39]
    ds_read_b128 v[56:59], v32 offset:4096
    v_mfma_f32_16x16x32_bf16 a[40:43], v[112:115], v[100:103], a[40:43]
    ds_read_b128 v[60:63], v32 offset:5120
    v_mfma_f32_16x16x32_bf16 a[44:47], v[112:115], v[104:107], a[44:47]
    s_add_u32 m0, s36, 73728
    s_nop 0
    buffer_load_dwordx4 v9, s[8:11], s35 offen lds
    v_mfma_f32_16x16x32_bf16 a[48:51], v[116:119], v[84:87], a[48:51]
    ds_read_b64_tr_b16 v[72:73], v35
    ds_read_b64_tr_b16 v[74:75], v35 offset:1280
    v_mfma_f32_16x16x32_bf16 a[52:55], v[116:119], v[88:91], a[52:55]
    ds_read_b64_tr_b16 v[76:77], v36
    ds_read_b64_tr_b16 v[78:79], v36 offset:1280
    v_mfma_f32_16x16x32_bf16 a[56:59], v[116:119], v[92:95], a[56:59]
    s_add_u32 m0, s36, 74752
    s_nop 0
    buffer_load_dwordx4 v10, s[8:11], s35 offen lds
    v_mfma_f32_16x16x32_bf16 a[60:63], v[116:119], v[96:99], a[60:63]
    ds_read_b64_tr_b16 v[80:81], v37
    s_waitcnt lgkmcnt(12)
    ds_read_b64_tr_b16 v[82:83], v37 offset:1280
    v_mfma_f32_16x16x32_bf16 a[64:67], v[116:119], v[100:103], a[64:67]
    s_add_u32 m0, s36, 75776
    s_nop 0
    buffer_load_dwordx4 v11, s[8:11], s35 offen lds
    s_add_u32 s34, s34, 2048
    s_add_u32 s35, s35, 81920
    v_mfma_f32_16x16x32_bf16 a[68:71], v[116:119], v[104:107], a[68:71]
    v_mfma_f32_16x16x32_bf16 a[72:75], v[120:123], v[84:87], a[72:75]
    v_mfma_f32_16x16x32_bf16 a[76:79], v[120:123], v[88:91], a[76:79]
    v_mfma_f32_16x16x32_bf16 a[80:83], v[120:123], v[92:95], a[80:83]
    v_mfma_f32_16x16x32_bf16 a[84:87], v[120:123], v[96:99], a[84:87]
    v_mfma_f32_16x16x32_bf16 a[88:91], v[120:123], v[100:103], a[88:91]
    v_mfma_f32_16x16x32_bf16 a[92:95], v[120:123], v[104:107], a[92:95]
    v_mfma_f32_16x16x32_bf16 a[96:99], v[124:127], v[84:87], a[96:99]
    v_mfma_f32_16x16x32_bf16 a[100:103], v[124:127], v[88:91], a[100:103]
    v_mfma_f32_16x16x32_bf16 a[104:107], v[124:127], v[92:95], a[104:107]
    v_mfma_f32_16x16x32_bf16 a[108:111], v[124:127], v[96:99], a[108:111]
    v_mfma_f32_16x16x32_bf16 a[112:115], v[124:127], v[100:103], a[112:115]
    v_mfma_f32_16x16x32_bf16 a[116:119], v[124:127], v[104:107], a[116:119]
    s_waitcnt lgkmcnt(0)
    s_waitcnt vmcnt(6)
    s_barrier
    v_mfma_f32_16x16x32_bf16 a[0:3], v[64:67], v[40:43], a[0:3]
    ds_read_b64_tr_b16 v[108:109], v21
    ds_read_b64_tr_b16 v[110:111], v21 offset:1280
    v_mfma_f32_16x16x32_bf16 a[4:7], v[64:67], v[44:47], a[4:7]
    ds_read_b128 v[84:87], v20 offset:0
    v_mfma_f32_16x16x32_bf16 a[8:11], v[64:67], v[48:51], a[8:11]
    s_add_u32 m0, s36, 98304
    s_add_u32 s39, s34, 0
    buffer_load_dwordx4 v8, s[12:15], s39 offen lds
    v_mfma_f32_16x16x32_bf16 a[12:15], v[64:67], v[52:55], a[12:15]
    ds_read_b128 v[88:91], v20 offset:1024
    v_mfma_f32_16x16x32_bf16 a[16:19], v[64:67], v[56:59], a[16:19]
    ds_read_b128 v[92:95], v20 offset:2048
    v_mfma_f32_16x16x32_bf16 a[20:23], v[64:67], v[60:63], a[20:23]
    s_add_u32 m0, s36, 99328
    s_add_u32 s39, s34, 196608
    buffer_load_dwordx4 v8, s[12:15], s39 offen lds
    v_mfma_f32_16x16x32_bf16 a[24:27], v[68:71], v[40:43], a[24:27]
    ds_read_b64_tr_b16 v[112:113], v22
    ds_read_b64_tr_b16 v[114:115], v22 offset:1280
    v_mfma_f32_16x16x32_bf16 a[28:31], v[68:71], v[44:47], a[28:31]
    ds_read_b128 v[96:99], v20 offset:3072
    v_mfma_f32_16x16x32_bf16 a[32:35], v[68:71], v[48:51], a[32:35]
    s_add_u32 m0, s36, 100352
    s_add_u32 s39, s34, 393216
    buffer_load_dwordx4 v8, s[12:15], s39 offen lds
    v_mfma_f32_16x16x32_bf16 a[36:39], v[68:71], v[52:55], a[36:39]
    ds_read_b128 v[100:103], v20 offset:4096
    v_mfma_f32_16x16x32_bf16 a[40:43], v[68:71], v[56:59], a[40:43]
    ds_read_b128 v[104:107], v20 offset:5120
    v_mfma_f32_16x16x32_bf16 a[44:47], v[68:71], v[60:63], a[44:47]
    s_add_u32 m0, s36, 122880
    s_nop 0
    buffer_load_dwordx4 v9, s[8:11], s35 offen lds
    v_mfma_f32_16x16x32_bf16 a[48:51], v[72:75], v[40:43], a[48:51]
    ds_read_b64_tr_b16 v[116:117], v23
    ds_read_b64_tr_b16 v[118:119], v23 offset:1280
    v_mfma_f32_16x16x32_bf16 a[52:55], v[72:75], v[44:47], a[52:55]
    ds_read_b64_tr_b16 v[120:121], v24
    ds_read_b64_tr_b16 v[122:123], v24 offset:1280
    v_mfma_f32_16x16x32_bf16 a[56:59], v[72:75], v[48:51], a[56:59]
    s_add_u32 m0, s36, 123904
    s_nop 0
    buffer_load_dwordx4 v10, s[8:11], s35 offen lds
    v_mfma_f32_16x16x32_bf16 a[60:63], v[72:75], v[52:55], a[60:63]
    ds_read_b64_tr_b16 v[124:125], v25
    s_waitcnt lgkmcnt(12)
    ds_read_b64_tr_b16 v[126:127], v25 offset:1280
    v_mfma_f32_16x16x32_bf16 a[64:67], v[72:75], v[56:59], a[64:67]
    s_add_u32 m0, s36, 124928
    s_nop 0
    buffer_load_dwordx4 v11, s[8:11], s35 offen lds
    s_add_u32 s34, s34, 2048
    s_add_u32 s35, s35, 81920
    v_mfma_f32_16x16x32_bf16 a[68:71], v[72:75], v[60:63], a[68:71]
    v_mfma_f32_16x16x32_bf16 a[72:75], v[76:79], v[40:43], a[72:75]
    v_mfma_f32_16x16x32_bf16 a[76:79], v[76:79], v[44:47], a[76:79]
    v_mfma_f32_16x16x32_bf16 a[80:83], v[76:79], v[48:51], a[80:83]
    v_mfma_f32_16x16x32_bf16 a[84:87], v[76:79], v[52:55], a[84:87]
    v_mfma_f32_16x16x32_bf16 a[88:91], v[76:79], v[56:59], a[88:91]
    v_mfma_f32_16x16x32_bf16 a[92:95], v[76:79], v[60:63], a[92:95]
    v_mfma_f32_16x16x32_bf16 a[96:99], v[80:83], v[40:43], a[96:99]
    v_mfma_f32_16x16x32_bf16 a[100:103], v[80:83], v[44:47], a[100:103]
    v_mfma_f32_16x16x32_bf16 a[104:107], v[80:83], v[48:51], a[104:107]
    v_mfma_f32_16x16x32_bf16 a[108:111], v[80:83], v[52:55], a[108:111]
    v_mfma_f32_16x16x32_bf16 a[112:115], v[80:83], v[56:59], a[112:115]
    v_mfma_f32_16x16x32_bf16 a[116:119], v[80:83], v[60:63], a[116:119]
    s_waitcnt lgkmcnt(0)
    s_waitcnt vmcnt(6)
    s_barrier
    v_mfma_f32_16x16x32_bf16 a[0:3], v[108:111], v[84:87], a[0:3]
    ds_read_b64_tr_b16 v[64:65], v27
    ds_read_b64_tr_b16 v[66:67], v27 offset:1280
    v_mfma_f32_16x16x32_bf16 a[4:7], v[108:111], v[88:91], a[4:7]
    ds_read_b128 v[40:43], v26 offset:0
    v_mfma_f32_16x16x32_bf16 a[8:11], v[108:111], v[92:95], a[8:11]
    s_add_u32 m0, s36, 0
    s_add_u32 s39, s34, 0
    buffer_load_dwordx4 v8, s[12:15], s39 offen lds
    v_mfma_f32_16x16x32_bf16 a[12:15], v[108:111], v[96:99], a[12:15]
    ds_read_b128 v[44:47], v26 offset:1024
    v_mfma_f32_16x16x32_bf16 a[16:19], v[108:111], v[100:103], a[16:19]
    ds_read_b128 v[48:51], v26 offset:2048
    v_mfma_f32_16x16x32_bf16 a[20:23], v[108:111], v[104:107], a[20:23]
    s_add_u32 m0, s36, 1024
    s_add_u32 s39, s34, 196608
    buffer_load_dwordx4 v8, s[12:15], s39 offen lds
    v_mfma_f32_16x16x32_bf16 a[24:27], v[112:115], v[84:87], a[24:27]
    ds_read_b64_tr_b16 v[68:69], v28
    ds_read_b64_tr_b16 v[70:71], v28 offset:1280
    v_mfma_f32_16x16x32_bf16 a[28:31], v[112:115], v[88:91], a[28:31]
    ds_read_b128 v[52:55], v26 offset:3072
    v_mfma_f32_16x16x32_bf16 a[32:35], v[112:115], v[92:95], a[32:35]
    s_add_u32 m0, s36, 2048
    s_add_u32 s39, s34, 393216
    buffer_load_dwordx4 v8, s[12:15], s39 offen lds
    v_mfma_f32_16x16x32_bf16 a[36:39], v[112:115], v[96:99], a[36:39]
    ds_read_b128 v[56:59], v26 offset:4096
    v_mfma_f32_16x16x32_bf16 a[40:43], v[112:115], v[100:103], a[40:43]
    ds_read_b128 v[60:63], v26 offset:5120
    v_mfma_f32_16x16x32_bf16 a[44:47], v[112:115], v[104:107], a[44:47]
    s_add_u32 m0, s36, 24576
    s_nop 0
    buffer_load_dwordx4 v9, s[8:11], s35 offen lds
    v_mfma_f32_16x16x32_bf16 a[48:51], v[116:119], v[84:87], a[48:51]
    ds_read_b64_tr_b16 v[72:73], v29
    ds_read_b64_tr_b16 v[74:75], v29 offset:1280
    v_mfma_f32_16x16x32_bf16 a[52:55], v[116:119], v[88:91], a[52:55]
    ds_read_b64_tr_b16 v[76:77], v30
    ds_read_b64_tr_b16 v[78:79], v30 offset:1280
    v_mfma_f32_16x16x32_bf16 a[56:59], v[116:119], v[92:95], a[56:59]
    s_add_u32 m0, s36, 25600
    s_nop 0
    buffer_load_dwordx4 v10, s[8:11], s35 offen lds
    v_mfma_f32_16x16x32_bf16 a[60:63], v[116:119], v[96:99], a[60:63]
    ds_read_b64_tr_b16 v[80:81], v31
    s_waitcnt lgkmcnt(12)
    ds_read_b64_tr_b16 v[82:83], v31 offset:1280
    v_mfma_f32_16x16x32_bf16 a[64:67], v[116:119], v[100:103], a[64:67]
    s_add_u32 m0, s36, 26624
    s_nop 0
    buffer_load_dwordx4 v11, s[8:11], s35 offen lds
    s_add_u32 s34, s34, 2048
    s_add_u32 s35, s35, 81920
    v_mfma_f32_16x16x32_bf16 a[68:71], v[116:119], v[104:107], a[68:71]
    v_mfma_f32_16x16x32_bf16 a[72:75], v[120:123], v[84:87], a[72:75]
    v_mfma_f32_16x16x32_bf16 a[76:79], v[120:123], v[88:91], a[76:79]
    v_mfma_f32_16x16x32_bf16 a[80:83], v[120:123], v[92:95], a[80:83]
    v_mfma_f32_16x16x32_bf16 a[84:87], v[120:123], v[96:99], a[84:87]
    v_mfma_f32_16x16x32_bf16 a[88:91], v[120:123], v[100:103], a[88:91]
    v_mfma_f32_16x16x32_bf16 a[92:95], v[120:123], v[104:107], a[92:95]
    v_mfma_f32_16x16x32_bf16 a[96:99], v[124:127], v[84:87], a[96:99]
    v_mfma_f32_16x16x32_bf16 a[100:103], v[124:127], v[88:91], a[100:103]
    v_mfma_f32_16x16x32_bf16 a[104:107], v[124:127], v[92:95], a[104:107]
    v_mfma_f32_16x16x32_bf16 a[108:111], v[124:127], v[96:99], a[108:111]
    v_mfma_f32_16x16x32_bf16 a[112:115], v[124:127], v[100:103], a[112:115]
    v_mfma_f32_16x16x32_bf16 a[116:119], v[124:127], v[104:107], a[116:119]
    s_waitcnt lgkmcnt(0)
    s_waitcnt vmcnt(6)
    s_barrier
    v_mfma_f32_16x16x32_bf16 a[0:3], v[64:67], v[40:43], a[0:3]
    ds_read_b64_tr_b16 v[108:109], v33
    ds_read_b64_tr_b16 v[110:111], v33 offset:1280
    v_mfma_f32_16x16x32_bf16 a[4:7], v[64:67], v[44:47], a[4:7]
    ds_read_b128 v[84:87], v32 offset:0
    v_mfma_f32_16x16x32_bf16 a[8:11], v[64:67], v[48:51], a[8:11]
    s_add_u32 m0, s36, 49152
    s_add_u32 s39, s34, 0
    buffer_load_dwordx4 v8, s[12:15], s39 offen lds
    v_mfma_f32_16x16x32_bf16 a[12:15], v[64:67], v[52:55], a[12:15]
    ds_read_b128 v[88:91], v32 offset:1024
    v_mfma_f32_16x16x32_bf16 a[16:19], v[64:67], v[56:59], a[16:19]
    ds_read_b128 v[92:95], v32 offset:2048
    v_mfma_f32_16x16x32_bf16 a[20:23], v[64:67], v[60:63], a[20:23]
    s_add_u32 m0, s36, 50176
    s_add_u32 s39, s34, 196608
    buffer_load_dwordx4 v8, s[12:15], s39 offen lds
    v_mfma_f32_16x16x32_bf16 a[24:27], v[68:71], v[40:43], a[24:27]
    ds_read_b64_tr_b16 v[112:113], v34
    ds_read_b64_tr_b16 v[114:115], v34 offset:1280
    v_mfma_f32_16x16x32_bf16 a[28:31], v[68:71], v[44:47], a[28:31]
    ds_read_b128 v[96:99], v32 offset:3072
    v_mfma_f32_16x16x32_bf16 a[32:35], v[68:71], v[48:51], a[32:35]
    s_add_u32 m0, s36, 51200
    s_add_u32 s39, s34, 393216
    buffer_load_dwordx4 v8, s[12:15], s39 offen lds
    v_mfma_f32_16x16x32_bf16 a[36:39], v[68:71], v[52:55], a[36:39]
    ds_read_b128 v[100:103], v32 offset:4096
    v_mfma_f32_16x16x32_bf16 a[40:43], v[68:71], v[56:59], a[40:43]
    ds_read_b128 v[104:107], v32 offset:5120
    v_mfma_f32_16x16x32_bf16 a[44:47], v[68:71], v[60:63], a[44:47]
    s_add_u32 m0, s36, 73728
    s_nop 0
    buffer_load_dwordx4 v9, s[8:11], s35 offen lds
    v_mfma_f32_16x16x32_bf16 a[48:51], v[72:75], v[40:43], a[48:51]
    ds_read_b64_tr_b16 v[116:117], v35
    ds_read_b64_tr_b16 v[118:119], v35 offset:1280
    v_mfma_f32_16x16x32_bf16 a[52:55], v[72:75], v[44:47], a[52:55]
    ds_read_b64_tr_b16 v[120:121], v36
    ds_read_b64_tr_b16 v[122:123], v36 offset:1280
    v_mfma_f32_16x16x32_bf16 a[56:59], v[72:75], v[48:51], a[56:59]
    s_add_u32 m0, s36, 74752
    s_nop 0
    buffer_load_dwordx4 v10, s[8:11], s35 offen lds
    v_mfma_f32_16x16x32_bf16 a[60:63], v[72:75], v[52:55], a[60:63]
    ds_read_b64_tr_b16 v[124:125], v37
    s_waitcnt lgkmcnt(12)
    ds_read_b64_tr_b16 v[126:127], v37 offset:1280
    v_mfma_f32_16x16x32_bf16 a[64:67], v[72:75], v[56:59], a[64:67]
    s_add_u32 m0, s36, 75776
    s_nop 0
    buffer_load_dwordx4 v11, s[8:11], s35 offen lds
    s_add_u32 s34, s34, 2048
    s_add_u32 s35, s35, 81920
    v_mfma_f32_16x16x32_bf16 a[68:71], v[72:75], v[60:63], a[68:71]
    v_mfma_f32_16x16x32_bf16 a[72:75], v[76:79], v[40:43], a[72:75]
    v_mfma_f32_16x16x32_bf16 a[76:79], v[76:79], v[44:47], a[76:79]
    v_mfma_f32_16x16x32_bf16 a[80:83], v[76:79], v[48:51], a[80:83]
    v_mfma_f32_16x16x32_bf16 a[84:87], v[76:79], v[52:55], a[84:87]
    v_mfma_f32_16x16x32_bf16 a[88:91], v[76:79], v[56:59], a[88:91]
    v_mfma_f32_16x16x32_bf16 a[92:95], v[76:79], v[60:63], a[92:95]
    v_mfma_f32_16x16x32_bf16 a[96:99], v[80:83], v[40:43], a[96:99]
    v_mfma_f32_16x16x32_bf16 a[100:103], v[80:83], v[44:47], a[100:103]
    v_mfma_f32_16x16x32_bf16 a[104:107], v[80:83], v[48:51], a[104:107]
    v_mfma_f32_16x16x32_bf16 a[108:111], v[80:83], v[52:55], a[108:111]
    v_mfma_f32_16x16x32_bf16 a[112:115], v[80:83], v[56:59], a[112:115]
    v_mfma_f32_16x16x32_bf16 a[116:119], v[80:83], v[60:63], a[116:119]
    s_waitcnt lgkmcnt(0)
    s_waitcnt vmcnt(6)
    s_barrier
    v_mfma_f32_16x16x32_bf16 a[0:3], v[108:111], v[84:87], a[0:3]
    ds_read_b64_tr_b16 v[64:65], v21
    ds_read_b64_tr_b16 v[66:67], v21 offset:1280
    v_mfma_f32_16x16x32_bf16 a[4:7], v[108:111], v[88:91], a[4:7]
    ds_read_b128 v[40:43], v20 offset:0
    v_mfma_f32_16x16x32_bf16 a[8:11], v[108:111], v[92:95], a[8:11]
    s_add_u32 m0, s36, 98304
    s_add_u32 s39, s34, 0
    buffer_load_dwordx4 v8, s[12:15], s39 offen lds
    v_mfma_f32_16x16x32_bf16 a[12:15], v[108:111], v[96:99], a[12:15]
    ds_read_b128 v[44:47], v20 offset:1024
    v_mfma_f32_16x16x32_bf16 a[16:19], v[108:111], v[100:103], a[16:19]
    ds_read_b128 v[48:51], v20 offset:2048
    v_mfma_f32_16x16x32_bf16 a[20:23], v[108:111], v[104:107], a[20:23]
    s_add_u32 m0, s36, 99328
    s_add_u32 s39, s34, 196608
    buffer_load_dwordx4 v8, s[12:15], s39 offen lds
    v_mfma_f32_16x16x32_bf16 a[24:27], v[112:115], v[84:87], a[24:27]
    ds_read_b64_tr_b16 v[68:69], v22
    ds_read_b64_tr_b16 v[70:71], v22 offset:1280
    v_mfma_f32_16x16x32_bf16 a[28:31], v[112:115], v[88:91], a[28:31]
    ds_read_b128 v[52:55], v20 offset:3072
    v_mfma_f32_16x16x32_bf16 a[32:35], v[112:115], v[92:95], a[32:35]
    s_add_u32 m0, s36, 100352
    s_add_u32 s39, s34, 393216
    buffer_load_dwordx4 v8, s[12:15], s39 offen lds
    v_mfma_f32_16x16x32_bf16 a[36:39], v[112:115], v[96:99], a[36:39]
    ds_read_b128 v[56:59], v20 offset:4096
    v_mfma_f32_16x16x32_bf16 a[40:43], v[112:115], v[100:103], a[40:43]
    ds_read_b128 v[60:63], v20 offset:5120
    v_mfma_f32_16x16x32_bf16 a[44:47], v[112:115], v[104:107], a[44:47]
    s_add_u32 m0, s36, 122880
    s_nop 0
    buffer_load_dwordx4 v9, s[8:11], s35 offen lds
    v_mfma_f32_16x16x32_bf16 a[48:51], v[116:119], v[84:87], a[48:51]
    ds_read_b64_tr_b16 v[72:73], v23
    ds_read_b64_tr_b16 v[74:75], v23 offset:1280
    v_mfma_f32_16x16x32_bf16 a[52:55], v[116:119], v[88:91], a[52:55]
    ds_read_b64_tr_b16 v[76:77], v24
    ds_read_b64_tr_b16 v[78:79], v24 offset:1280
    v_mfma_f32_16x16x32_bf16 a[56:59], v[116:119], v[92:95], a[56:59]
    s_add_u32 m0, s36, 123904
    s_nop 0
    buffer_load_dwordx4 v10, s[8:11], s35 offen lds
    v_mfma_f32_16x16x32_bf16 a[60:63], v[116:119], v[96:99], a[60:63]
    ds_read_b64_tr_b16 v[80:81], v25
    s_waitcnt lgkmcnt(12)
    ds_read_b64_tr_b16 v[82:83], v25 offset:1280
    v_mfma_f32_16x16x32_bf16 a[64:67], v[116:119], v[100:103], a[64:67]
    s_add_u32 m0, s36, 124928
    s_nop 0
    buffer_load_dwordx4 v11, s[8:11], s35 offen lds
    s_add_u32 s34, s34, 2048
    s_add_u32 s35, s35, 81920
    v_mfma_f32_16x16x32_bf16 a[68:71], v[116:119], v[104:107], a[68:71]
    v_mfma_f32_16x16x32_bf16 a[72:75], v[120:123], v[84:87], a[72:75]
    v_mfma_f32_16x16x32_bf16 a[76:79], v[120:123], v[88:91], a[76:79]
    v_mfma_f32_16x16x32_bf16 a[80:83], v[120:123], v[92:95], a[80:83]
    v_mfma_f32_16x16x32_bf16 a[84:87], v[120:123], v[96:99], a[84:87]
    v_mfma_f32_16x16x32_bf16 a[88:91], v[120:123], v[100:103], a[88:91]
    v_mfma_f32_16x16x32_bf16 a[92:95], v[120:123], v[104:107], a[92:95]
    v_mfma_f32_16x16x32_bf16 a[96:99], v[124:127], v[84:87], a[96:99]
    v_mfma_f32_16x16x32_bf16 a[100:103], v[124:127], v[88:91], a[100:103]
    v_mfma_f32_16x16x32_bf16 a[104:107], v[124:127], v[92:95], a[104:107]
    v_mfma_f32_16x16x32_bf16 a[108:111], v[124:127], v[96:99], a[108:111]
    v_mfma_f32_16x16x32_bf16 a[112:115], v[124:127], v[100:103], a[112:115]
    v_mfma_f32_16x16x32_bf16 a[116:119], v[124:127], v[104:107], a[116:119]
    s_waitcnt lgkmcnt(0)
    s_waitcnt vmcnt(6)
    s_barrier
    v_mfma_f32_16x16x32_bf16 a[0:3], v[64:67], v[40:43], a[0:3]
    ds_read_b64_tr_b16 v[108:109], v27
    ds_read_b64_tr_b16 v[110:111], v27 offset:1280
    v_mfma_f32_16x16x32_bf16 a[4:7], v[64:67], v[44:47], a[4:7]
    ds_read_b128 v[84:87], v26 offset:0
    v_mfma_f32_16x16x32_bf16 a[8:11], v[64:67], v[48:51], a[8:11]
    s_add_u32 m0, s36, 0
    s_add_u32 s39, s34, 0
    buffer_load_dwordx4 v8, s[12:15], s39 offen lds
    v_mfma_f32_16x16x32_bf16 a[12:15], v[64:67], v[52:55], a[12:15]
    ds_read_b128 v[88:91], v26 offset:1024
    v_mfma_f32_16x16x32_bf16 a[16:19], v[64:67], v[56:59], a[16:19]
    ds_read_b128 v[92:95], v26 offset:2048
    v_mfma_f32_16x16x32_bf16 a[20:23], v[64:67], v[60:63], a[20:23]
    s_add_u32 m0, s36, 1024
    s_add_u32 s39, s34, 196608
    buffer_load_dwordx4 v8, s[12:15], s39 offen lds
    v_mfma_f32_16x16x32_bf16 a[24:27], v[68:71], v[40:43], a[24:27]
    ds_read_b64_tr_b16 v[112:113], v28
    ds_read_b64_tr_b16 v[114:115], v28 offset:1280
    v_mfma_f32_16x16x32_bf16 a[28:31], v[68:71], v[44:47], a[28:31]
    ds_read_b128 v[96:99], v26 offset:3072
    v_mfma_f32_16x16x32_bf16 a[32:35], v[68:71], v[48:51], a[32:35]
    s_add_u32 m0, s36, 2048
    s_add_u32 s39, s34, 393216
    buffer_load_dwordx4 v8, s[12:15], s39 offen lds
    v_mfma_f32_16x16x32_bf16 a[36:39], v[68:71], v[52:55], a[36:39]
    ds_read_b128 v[100:103], v26 offset:4096
    v_mfma_f32_16x16x32_bf16 a[40:43], v[68:71], v[56:59], a[40:43]
    ds_read_b128 v[104:107], v26 offset:5120
    v_mfma_f32_16x16x32_bf16 a[44:47], v[68:71], v[60:63], a[44:47]
    s_add_u32 m0, s36, 24576
    s_nop 0
    buffer_load_dwordx4 v9, s[8:11], s35 offen lds
    v_mfma_f32_16x16x32_bf16 a[48:51], v[72:75], v[40:43], a[48:51]
    ds_read_b64_tr_b16 v[116:117], v29
    ds_read_b64_tr_b16 v[118:119], v29 offset:1280
    v_mfma_f32_16x16x32_bf16 a[52:55], v[72:75], v[44:47], a[52:55]
    ds_read_b64_tr_b16 v[120:121], v30
    ds_read_b64_tr_b16 v[122:123], v30 offset:1280
    v_mfma_f32_16x16x32_bf16 a[56:59], v[72:75], v[48:51], a[56:59]
    s_add_u32 m0, s36, 25600
    s_nop 0
    buffer_load_dwordx4 v10, s[8:11], s35 offen lds
    v_mfma_f32_16x16x32_bf16 a[60:63], v[72:75], v[52:55], a[60:63]
    ds_read_b64_tr_b16 v[124:125], v31
    s_waitcnt lgkmcnt(12)
    ds_read_b64_tr_b16 v[126:127], v31 offset:1280
    v_mfma_f32_16x16x32_bf16 a[64:67], v[72:75], v[56:59], a[64:67]
    s_add_u32 m0, s36, 26624
    s_nop 0
    buffer_load_dwordx4 v11, s[8:11], s35 offen lds
    s_add_u32 s34, s34, 2048
    s_add_u32 s35, s35, 81920
    v_mfma_f32_16x16x32_bf16 a[68:71], v[72:75], v[60:63], a[68:71]
    v_mfma_f32_16x16x32_bf16 a[72:75], v[76:79], v[40:43], a[72:75]
    v_mfma_f32_16x16x32_bf16 a[76:79], v[76:79], v[44:47], a[76:79]
    v_mfma_f32_16x16x32_bf16 a[80:83], v[76:79], v[48:51], a[80:83]
    v_mfma_f32_16x16x32_bf16 a[84:87], v[76:79], v[52:55], a[84:87]
    v_mfma_f32_16x16x32_bf16 a[88:91], v[76:79], v[56:59], a[88:91]
    v_mfma_f32_16x16x32_bf16 a[92:95], v[76:79], v[60:63], a[92:95]
    v_mfma_f32_16x16x32_bf16 a[96:99], v[80:83], v[40:43], a[96:99]
    v_mfma_f32_16x16x32_bf16 a[100:103], v[80:83], v[44:47], a[100:103]
    v_mfma_f32_16x16x32_bf16 a[104:107], v[80:83], v[48:51], a[104:107]
    v_mfma_f32_16x16x32_bf16 a[108:111], v[80:83], v[52:55], a[108:111]
    v_mfma_f32_16x16x32_bf16 a[112:115], v[80:83], v[56:59], a[112:115]
    v_mfma_f32_16x16x32_bf16 a[116:119], v[80:83], v[60:63], a[116:119]
    s_waitcnt lgkmcnt(0)
    s_waitcnt vmcnt(6)
    s_barrier
    v_mfma_f32_16x16x32_bf16 a[0:3], v[108:111], v[84:87], a[0:3]
    ds_read_b64_tr_b16 v[64:65], v33
    ds_read_b64_tr_b16 v[66:67], v33 offset:1280
    v_mfma_f32_16x16x32_bf16 a[4:7], v[108:111], v[88:91], a[4:7]
    ds_read_b128 v[40:43], v32 offset:0
    v_mfma_f32_16x16x32_bf16 a[8:11], v[108:111], v[92:95], a[8:11]
    s_add_u32 m0, s36, 49152
    s_add_u32 s39, s34, 0
    buffer_load_dwordx4 v8, s[12:15], s39 offen lds
    v_mfma_f32_16x16x32_bf16 a[12:15], v[108:111], v[96:99], a[12:15]
    ds_read_b128 v[44:47], v32 offset:1024
    v_mfma_f32_16x16x32_bf16 a[16:19], v[108:111], v[100:103], a[16:19]
    ds_read_b128 v[48:51], v32 offset:2048
    v_mfma_f32_16x16x32_bf16 a[20:23], v[108:111], v[104:107], a[20:23]
    s_add_u32 m0, s36, 50176
    s_add_u32 s39, s34, 196608
    buffer_load_dwordx4 v8, s[12:15], s39 offen lds
    v_mfma_f32_16x16x32_bf16 a[24:27], v[112:115], v[84:87], a[24:27]
    ds_read_b64_tr_b16 v[68:69], v34
    ds_read_b64_tr_b16 v[70:71], v34 offset:1280
    v_mfma_f32_16x16x32_bf16 a[28:31], v[112:115], v[88:91], a[28:31]
    ds_read_b128 v[52:55], v32 offset:3072
    v_mfma_f32_16x16x32_bf16 a[32:35], v[112:115], v[92:95], a[32:35]
    s_add_u32 m0, s36, 51200
    s_add_u32 s39, s34, 393216
    buffer_load_dwordx4 v8, s[12:15], s39 offen lds
    v_mfma_f32_16x16x32_bf16 a[36:39], v[112:115], v[96:99], a[36:39]
    ds_read_b128 v[56:59], v32 offset:4096
    v_mfma_f32_16x16x32_bf16 a[40:43], v[112:115], v[100:103], a[40:43]
    ds_read_b128 v[60:63], v32 offset:5120
    v_mfma_f32_16x16x32_bf16 a[44:47], v[112:115], v[104:107], a[44:47]
    s_add_u32 m0, s36, 73728
    s_nop 0
    buffer_load_dwordx4 v9, s[8:11], s35 offen lds
    v_mfma_f32_16x16x32_bf16 a[48:51], v[116:119], v[84:87], a[48:51]
    ds_read_b64_tr_b16 v[72:73], v35
    ds_read_b64_tr_b16 v[74:75], v35 offset:1280
    v_mfma_f32_16x16x32_bf16 a[52:55], v[116:119], v[88:91], a[52:55]
    ds_read_b64_tr_b16 v[76:77], v36
    ds_read_b64_tr_b16 v[78:79], v36 offset:1280
    v_mfma_f32_16x16x32_bf16 a[56:59], v[116:119], v[92:95], a[56:59]
    s_add_u32 m0, s36, 74752
    s_nop 0
    buffer_load_dwordx4 v10, s[8:11], s35 offen lds
    v_mfma_f32_16x16x32_bf16 a[60:63], v[116:119], v[96:99], a[60:63]
    ds_read_b64_tr_b16 v[80:81], v37
    s_waitcnt lgkmcnt(12)
    ds_read_b64_tr_b16 v[82:83], v37 offset:1280
    v_mfma_f32_16x16x32_bf16 a[64:67], v[116:119], v[100:103], a[64:67]
    s_add_u32 m0, s36, 75776
    s_nop 0
    buffer_load_dwordx4 v11, s[8:11], s35 offen lds
    s_add_u32 s34, s34, 2048
    s_add_u32 s35, s35, 81920
    v_mfma_f32_16x16x32_bf16 a[68:71], v[116:119], v[104:107], a[68:71]
    v_mfma_f32_16x16x32_bf16 a[72:75], v[120:123], v[84:87], a[72:75]
    v_mfma_f32_16x16x32_bf16 a[76:79], v[120:123], v[88:91], a[76:79]
    v_mfma_f32_16x16x32_bf16 a[80:83], v[120:123], v[92:95], a[80:83]
    v_mfma_f32_16x16x32_bf16 a[84:87], v[120:123], v[96:99], a[84:87]
    v_mfma_f32_16x16x32_bf16 a[88:91], v[120:123], v[100:103], a[88:91]
    v_mfma_f32_16x16x32_bf16 a[92:95], v[120:123], v[104:107], a[92:95]
    v_mfma_f32_16x16x32_bf16 a[96:99], v[124:127], v[84:87], a[96:99]
    v_mfma_f32_16x16x32_bf16 a[100:103], v[124:127], v[88:91], a[100:103]
    v_mfma_f32_16x16x32_bf16 a[104:107], v[124:127], v[92:95], a[104:107]
    v_mfma_f32_16x16x32_bf16 a[108:111], v[124:127], v[96:99], a[108:111]
    v_mfma_f32_16x16x32_bf16 a[112:115], v[124:127], v[100:103], a[112:115]
    v_mfma_f32_16x16x32_bf16 a[116:119], v[124:127], v[104:107], a[116:119]
    s_waitcnt lgkmcnt(0)
    s_waitcnt vmcnt(6)
    s_barrier
    v_mfma_f32_16x16x32_bf16 a[0:3], v[64:67], v[40:43], a[0:3]
    ds_read_b64_tr_b16 v[108:109], v21
    ds_read_b64_tr_b16 v[110:111], v21 offset:1280
    v_mfma_f32_16x16x32_bf16 a[4:7], v[64:67], v[44:47], a[4:7]
    ds_read_b128 v[84:87], v20 offset:0
    v_mfma_f32_16x16x32_bf16 a[8:11], v[64:67], v[48:51], a[8:11]
    s_add_u32 m0, s36, 98304
    s_add_u32 s39, s34, 0
    buffer_load_dwordx4 v8, s[12:15], s39 offen lds
    v_mfma_f32_16x16x32_bf16 a[12:15], v[64:67], v[52:55], a[12:15]
    ds_read_b128 v[88:91], v20 offset:1024
    v_mfma_f32_16x16x32_bf16 a[16:19], v[64:67], v[56:59], a[16:19]
    ds_read_b128 v[92:95], v20 offset:2048
    v_mfma_f32_16x16x32_bf16 a[20:23], v[64:67], v[60:63], a[20:23]
    s_add_u32 m0, s36, 99328
    s_add_u32 s39, s34, 196608
    buffer_load_dwordx4 v8, s[12:15], s39 offen lds
    v_mfma_f32_16x16x32_bf16 a[24:27], v[68:71], v[40:43], a[24:27]
    ds_read_b64_tr_b16 v[112:113], v22
    ds_read_b64_tr_b16 v[114:115], v22 offset:1280
    v_mfma_f32_16x16x32_bf16 a[28:31], v[68:71], v[44:47], a[28:31]
    ds_read_b128 v[96:99], v20 offset:3072
    v_mfma_f32_16x16x32_bf16 a[32:35], v[68:71], v[48:51], a[32:35]
    s_add_u32 m0, s36, 100352
    s_add_u32 s39, s34, 393216
    buffer_load_dwordx4 v8, s[12:15], s39 offen lds
    v_mfma_f32_16x16x32_bf16 a[36:39], v[68:71], v[52:55], a[36:39]
    ds_read_b128 v[100:103], v20 offset:4096
    v_mfma_f32_16x16x32_bf16 a[40:43], v[68:71], v[56:59], a[40:43]
    ds_read_b128 v[104:107], v20 offset:5120
    v_mfma_f32_16x16x32_bf16 a[44:47], v[68:71], v[60:63], a[44:47]
    s_add_u32 m0, s36, 122880
    s_nop 0
    buffer_load_dwordx4 v9, s[8:11], s35 offen lds
    v_mfma_f32_16x16x32_bf16 a[48:51], v[72:75], v[40:43], a[48:51]
    ds_read_b64_tr_b16 v[116:117], v23
    ds_read_b64_tr_b16 v[118:119], v23 offset:1280
    v_mfma_f32_16x16x32_bf16 a[52:55], v[72:75], v[44:47], a[52:55]
    ds_read_b64_tr_b16 v[120:121], v24
    ds_read_b64_tr_b16 v[122:123], v24 offset:1280
    v_mfma_f32_16x16x32_bf16 a[56:59], v[72:75], v[48:51], a[56:59]
    s_add_u32 m0, s36, 123904
    s_nop 0
    buffer_load_dwordx4 v10, s[8:11], s35 offen lds
    v_mfma_f32_16x16x32_bf16 a[60:63], v[72:75], v[52:55], a[60:63]
    ds_read_b64_tr_b16 v[124:125], v25
    s_waitcnt lgkmcnt(12)
    ds_read_b64_tr_b16 v[126:127], v25 offset:1280
    v_mfma_f32_16x16x32_bf16 a[64:67], v[72:75], v[56:59], a[64:67]
    s_add_u32 m0, s36, 124928
    s_nop 0
    buffer_load_dwordx4 v11, s[8:11], s35 offen lds
    s_add_u32 s34, s34, 2048
    s_add_u32 s35, s35, 81920
    v_mfma_f32_16x16x32_bf16 a[68:71], v[72:75], v[60:63], a[68:71]
    v_mfma_f32_16x16x32_bf16 a[72:75], v[76:79], v[40:43], a[72:75]
    v_mfma_f32_16x16x32_bf16 a[76:79], v[76:79], v[44:47], a[76:79]
    v_mfma_f32_16x16x32_bf16 a[80:83], v[76:79], v[48:51], a[80:83]
    v_mfma_f32_16x16x32_bf16 a[84:87], v[76:79], v[52:55], a[84:87]
    v_mfma_f32_16x16x32_bf16 a[88:91], v[76:79], v[56:59], a[88:91]
    v_mfma_f32_16x16x32_bf16 a[92:95], v[76:79], v[60:63], a[92:95]
    v_mfma_f32_16x16x32_bf16 a[96:99], v[80:83], v[40:43], a[96:99]
    v_mfma_f32_16x16x32_bf16 a[100:103], v[80:83], v[44:47], a[100:103]
    v_mfma_f32_16x16x32_bf16 a[104:107], v[80:83], v[48:51], a[104:107]
    v_mfma_f32_16x16x32_bf16 a[108:111], v[80:83], v[52:55], a[108:111]
    v_mfma_f32_16x16x32_bf16 a[112:115], v[80:83], v[56:59], a[112:115]
    v_mfma_f32_16x16x32_bf16 a[116:119], v[80:83], v[60:63], a[116:119]
    s_waitcnt lgkmcnt(0)
    s_waitcnt vmcnt(6)
    s_barrier
    v_mfma_f32_16x16x32_bf16 a[0:3], v[108:111], v[84:87], a[0:3]
    ds_read_b64_tr_b16 v[64:65], v27
    ds_read_b64_tr_b16 v[66:67], v27 offset:1280
    v_mfma_f32_16x16x32_bf16 a[4:7], v[108:111], v[88:91], a[4:7]
    ds_read_b128 v[40:43], v26 offset:0
    v_mfma_f32_16x16x32_bf16 a[8:11], v[108:111], v[92:95], a[8:11]
    s_add_u32 m0, s36, 0
    s_add_u32 s39, s34, 0
    buffer_load_dwordx4 v8, s[12:15], s39 offen lds
    v_mfma_f32_16x16x32_bf16 a[12:15], v[108:111], v[96:99], a[12:15]
    ds_read_b128 v[44:47], v26 offset:1024
    v_mfma_f32_16x16x32_bf16 a[16:19], v[108:111], v[100:103], a[16:19]
    ds_read_b128 v[48:51], v26 offset:2048
    v_mfma_f32_16x16x32_bf16 a[20:23], v[108:111], v[104:107], a[20:23]
    s_add_u32 m0, s36, 1024
    s_add_u32 s39, s34, 196608
    buffer_load_dwordx4 v8, s[12:15], s39 offen lds
    v_mfma_f32_16x16x32_bf16 a[24:27], v[112:115], v[84:87], a[24:27]
    ds_read_b64_tr_b16 v[68:69], v28
    ds_read_b64_tr_b16 v[70:71], v28 offset:1280
    v_mfma_f32_16x16x32_bf16 a[28:31], v[112:115], v[88:91], a[28:31]
    ds_read_b128 v[52:55], v26 offset:3072
    v_mfma_f32_16x16x32_bf16 a[32:35], v[112:115], v[92:95], a[32:35]
    s_add_u32 m0, s36, 2048
    s_add_u32 s39, s34, 393216
    buffer_load_dwordx4 v8, s[12:15], s39 offen lds
    v_mfma_f32_16x16x32_bf16 a[36:39], v[112:115], v[96:99], a[36:39]
    ds_read_b128 v[56:59], v26 offset:4096
    v_mfma_f32_16x16x32_bf16 a[40:43], v[112:115], v[100:103], a[40:43]
    ds_read_b128 v[60:63], v26 offset:5120
    v_mfma_f32_16x16x32_bf16 a[44:47], v[112:115], v[104:107], a[44:47]
    s_add_u32 m0, s36, 24576
    s_nop 0
    buffer_load_dwordx4 v9, s[8:11], s35 offen lds
    v_mfma_f32_16x16x32_bf16 a[48:51], v[116:119], v[84:87], a[48:51]
    ds_read_b64_tr_b16 v[72:73], v29
    ds_read_b64_tr_b16 v[74:75], v29 offset:1280
    v_mfma_f32_16x16x32_bf16 a[52:55], v[116:119], v[88:91], a[52:55]
    ds_read_b64_tr_b16 v[76:77], v30
    ds_read_b64_tr_b16 v[78:79], v30 offset:1280
    v_mfma_f32_16x16x32_bf16 a[56:59], v[116:119], v[92:95], a[56:59]
    s_add_u32 m0, s36, 25600
    s_nop 0
    buffer_load_dwordx4 v10, s[8:11], s35 offen lds
    v_mfma_f32_16x16x32_bf16 a[60:63], v[116:119], v[96:99], a[60:63]
    ds_read_b64_tr_b16 v[80:81], v31
    s_waitcnt lgkmcnt(12)
    ds_read_b64_tr_b16 v[82:83], v31 offset:1280
    v_mfma_f32_16x16x32_bf16 a[64:67], v[116:119], v[100:103], a[64:67]
    s_add_u32 m0, s36, 26624
    s_nop 0
    buffer_load_dwordx4 v11, s[8:11], s35 offen lds
    s_add_u32 s34, s34, 2048
    s_add_u32 s35, s35, 81920
    v_mfma_f32_16x16x32_bf16 a[68:71], v[116:119], v[104:107], a[68:71]
    v_mfma_f32_16x16x32_bf16 a[72:75], v[120:123], v[84:87], a[72:75]
    v_mfma_f32_16x16x32_bf16 a[76:79], v[120:123], v[88:91], a[76:79]
    v_mfma_f32_16x16x32_bf16 a[80:83], v[120:123], v[92:95], a[80:83]
    v_mfma_f32_16x16x32_bf16 a[84:87], v[120:123], v[96:99], a[84:87]
    v_mfma_f32_16x16x32_bf16 a[88:91], v[120:123], v[100:103], a[88:91]
    v_mfma_f32_16x16x32_bf16 a[92:95], v[120:123], v[104:107], a[92:95]
    v_mfma_f32_16x16x32_bf16 a[96:99], v[124:127], v[84:87], a[96:99]
    v_mfma_f32_16x16x32_bf16 a[100:103], v[124:127], v[88:91], a[100:103]
    v_mfma_f32_16x16x32_bf16 a[104:107], v[124:127], v[92:95], a[104:107]
    v_mfma_f32_16x16x32_bf16 a[108:111], v[124:127], v[96:99], a[108:111]
    v_mfma_f32_16x16x32_bf16 a[112:115], v[124:127], v[100:103], a[112:115]
    v_mfma_f32_16x16x32_bf16 a[116:119], v[124:127], v[104:107], a[116:119]
    s_waitcnt lgkmcnt(0)
    s_waitcnt vmcnt(6)
    s_barrier
    v_mfma_f32_16x16x32_bf16 a[0:3], v[64:67], v[40:43], a[0:3]
    ds_read_b64_tr_b16 v[108:109], v33
    ds_read_b64_tr_b16 v[110:111], v33 offset:1280
    v_mfma_f32_16x16x32_bf16 a[4:7], v[64:67], v[44:47], a[4:7]
    ds_read_b128 v[84:87], v32 offset:0
    v_mfma_f32_16x16x32_bf16 a[8:11], v[64:67], v[48:51], a[8:11]
    s_add_u32 m0, s36, 49152
    s_add_u32 s39, s34, 0
    buffer_load_dwordx4 v8, s[12:15], s39 offen lds
    v_mfma_f32_16x16x32_bf16 a[12:15], v[64:67], v[52:55], a[12:15]
    ds_read_b128 v[88:91], v32 offset:1024
    v_mfma_f32_16x16x32_bf16 a[16:19], v[64:67], v[56:59], a[16:19]
    ds_read_b128 v[92:95], v32 offset:2048
    v_mfma_f32_16x16x32_bf16 a[20:23], v[64:67], v[60:63], a[20:23]
    s_add_u32 m0, s36, 50176
    s_add_u32 s39, s34, 196608
    buffer_load_dwordx4 v8, s[12:15], s39 offen lds
    v_mfma_f32_16x16x32_bf16 a[24:27], v[68:71], v[40:43], a[24:27]
    ds_read_b64_tr_b16 v[112:113], v34
    ds_read_b64_tr_b16 v[114:115], v34 offset:1280
    v_mfma_f32_16x16x32_bf16 a[28:31], v[68:71], v[44:47], a[28:31]
    ds_read_b128 v[96:99], v32 offset:3072
    v_mfma_f32_16x16x32_bf16 a[32:35], v[68:71], v[48:51], a[32:35]
    s_add_u32 m0, s36, 51200
    s_add_u32 s39, s34, 393216
    buffer_load_dwordx4 v8, s[12:15], s39 offen lds
    v_mfma_f32_16x16x32_bf16 a[36:39], v[68:71], v[52:55], a[36:39]
    ds_read_b128 v[100:103], v32 offset:4096
    v_mfma_f32_16x16x32_bf16 a[40:43], v[68:71], v[56:59], a[40:43]
    ds_read_b128 v[104:107], v32 offset:5120
    v_mfma_f32_16x16x32_bf16 a[44:47], v[68:71], v[60:63], a[44:47]
    s_add_u32 m0, s36, 73728
    s_nop 0
    buffer_load_dwordx4 v9, s[8:11], s35 offen lds
    v_mfma_f32_16x16x32_bf16 a[48:51], v[72:75], v[40:43], a[48:51]
    ds_read_b64_tr_b16 v[116:117], v35
    ds_read_b64_tr_b16 v[118:119], v35 offset:1280
    v_mfma_f32_16x16x32_bf16 a[52:55], v[72:75], v[44:47], a[52:55]
    ds_read_b64_tr_b16 v[120:121], v36
    ds_read_b64_tr_b16 v[122:123], v36 offset:1280
    v_mfma_f32_16x16x32_bf16 a[56:59], v[72:75], v[48:51], a[56:59]
    s_add_u32 m0, s36, 74752
    s_nop 0
    buffer_load_dwordx4 v10, s[8:11], s35 offen lds
    v_mfma_f32_16x16x32_bf16 a[60:63], v[72:75], v[52:55], a[60:63]
    ds_read_b64_tr_b16 v[124:125], v37
    s_waitcnt lgkmcnt(12)
    ds_read_b64_tr_b16 v[126:127], v37 offset:1280
    v_mfma_f32_16x16x32_bf16 a[64:67], v[72:75], v[56:59], a[64:67]
    s_add_u32 m0, s36, 75776
    s_nop 0
    buffer_load_dwordx4 v11, s[8:11], s35 offen lds
    s_add_u32 s34, s34, 2048
    s_add_u32 s35, s35, 81920
    v_mfma_f32_16x16x32_bf16 a[68:71], v[72:75], v[60:63], a[68:71]
    v_mfma_f32_16x16x32_bf16 a[72:75], v[76:79], v[40:43], a[72:75]
    v_mfma_f32_16x16x32_bf16 a[76:79], v[76:79], v[44:47], a[76:79]
    v_mfma_f32_16x16x32_bf16 a[80:83], v[76:79], v[48:51], a[80:83]
    v_mfma_f32_16x16x32_bf16 a[84:87], v[76:79], v[52:55], a[84:87]
    v_mfma_f32_16x16x32_bf16 a[88:91], v[76:79], v[56:59], a[88:91]
    v_mfma_f32_16x16x32_bf16 a[92:95], v[76:79], v[60:63], a[92:95]
    v_mfma_f32_16x16x32_bf16 a[96:99], v[80:83], v[40:43], a[96:99]
    v_mfma_f32_16x16x32_bf16 a[100:103], v[80:83], v[44:47], a[100:103]
    v_mfma_f32_16x16x32_bf16 a[104:107], v[80:83], v[48:51], a[104:107]
    v_mfma_f32_16x16x32_bf16 a[108:111], v[80:83], v[52:55], a[108:111]
    v_mfma_f32_16x16x32_bf16 a[112:115], v[80:83], v[56:59], a[112:115]
    v_mfma_f32_16x16x32_bf16 a[116:119], v[80:83], v[60:63], a[116:119]
    s_waitcnt lgkmcnt(0)
    s_waitcnt vmcnt(6)
    s_barrier
    v_mfma_f32_16x16x32_bf16 a[0:3], v[108:111], v[84:87], a[0:3]
    ds_read_b64_tr_b16 v[64:65], v21
    ds_read_b64_tr_b16 v[66:67], v21 offset:1280
    v_mfma_f32_16x16x32_bf16 a[4:7], v[108:111], v[88:91], a[4:7]
    ds_read_b128 v[40:43], v20 offset:0
    v_mfma_f32_16x16x32_bf16 a[8:11], v[108:111], v[92:95], a[8:11]
    s_add_u32 m0, s36, 98304
    s_add_u32 s39, s34, 0
    buffer_load_dwordx4 v8, s[12:15], s39 offen lds
    v_mfma_f32_16x16x32_bf16 a[12:15], v[108:111], v[96:99], a[12:15]
    ds_read_b128 v[44:47], v20 offset:1024
    v_mfma_f32_16x16x32_bf16 a[16:19], v[108:111], v[100:103], a[16:19]
    ds_read_b128 v[48:51], v20 offset:2048
    v_mfma_f32_16x16x32_bf16 a[20:23], v[108:111], v[104:107], a[20:23]
    s_add_u32 m0, s36, 99328
    s_add_u32 s39, s34, 196608
    buffer_load_dwordx4 v8, s[12:15], s39 offen lds
    v_mfma_f32_16x16x32_bf16 a[24:27], v[112:115], v[84:87], a[24:27]
    ds_read_b64_tr_b16 v[68:69], v22
    ds_read_b64_tr_b16 v[70:71], v22 offset:1280
    v_mfma_f32_16x16x32_bf16 a[28:31], v[112:115], v[88:91], a[28:31]
    ds_read_b128 v[52:55], v20 offset:3072
    v_mfma_f32_16x16x32_bf16 a[32:35], v[112:115], v[92:95], a[32:35]
    s_add_u32 m0, s36, 100352
    s_add_u32 s39, s34, 393216
    buffer_load_dwordx4 v8, s[12:15], s39 offen lds
    v_mfma_f32_16x16x32_bf16 a[36:39], v[112:115], v[96:99], a[36:39]
    ds_read_b128 v[56:59], v20 offset:4096
    v_mfma_f32_16x16x32_bf16 a[40:43], v[112:115], v[100:103], a[40:43]
    ds_read_b128 v[60:63], v20 offset:5120
    v_mfma_f32_16x16x32_bf16 a[44:47], v[112:115], v[104:107], a[44:47]
    s_add_u32 m0, s36, 122880
    s_nop 0
    buffer_load_dwordx4 v9, s[8:11], s35 offen lds
    v_mfma_f32_16x16x32_bf16 a[48:51], v[116:119], v[84:87], a[48:51]
    ds_read_b64_tr_b16 v[72:73], v23
    ds_read_b64_tr_b16 v[74:75], v23 offset:1280
    v_mfma_f32_16x16x32_bf16 a[52:55], v[116:119], v[88:91], a[52:55]
    ds_read_b64_tr_b16 v[76:77], v24
    ds_read_b64_tr_b16 v[78:79], v24 offset:1280
    v_mfma_f32_16x16x32_bf16 a[56:59], v[116:119], v[92:95], a[56:59]
    s_add_u32 m0, s36, 123904
    s_nop 0
    buffer_load_dwordx4 v10, s[8:11], s35 offen lds
    v_mfma_f32_16x16x32_bf16 a[60:63], v[116:119], v[96:99], a[60:63]
    ds_read_b64_tr_b16 v[80:81], v25
    s_waitcnt lgkmcnt(12)
    ds_read_b64_tr_b16 v[82:83], v25 offset:1280
    v_mfma_f32_16x16x32_bf16 a[64:67], v[116:119], v[100:103], a[64:67]
    s_add_u32 m0, s36, 124928
    s_nop 0
    buffer_load_dwordx4 v11, s[8:11], s35 offen lds
    s_add_u32 s34, s34, 2048
    s_add_u32 s35, s35, 81920
    v_mfma_f32_16x16x32_bf16 a[68:71], v[116:119], v[104:107], a[68:71]
    v_mfma_f32_16x16x32_bf16 a[72:75], v[120:123], v[84:87], a[72:75]
    v_mfma_f32_16x16x32_bf16 a[76:79], v[120:123], v[88:91], a[76:79]
    v_mfma_f32_16x16x32_bf16 a[80:83], v[120:123], v[92:95], a[80:83]
    v_mfma_f32_16x16x32_bf16 a[84:87], v[120:123], v[96:99], a[84:87]
    v_mfma_f32_16x16x32_bf16 a[88:91], v[120:123], v[100:103], a[88:91]
    v_mfma_f32_16x16x32_bf16 a[92:95], v[120:123], v[104:107], a[92:95]
    v_mfma_f32_16x16x32_bf16 a[96:99], v[124:127], v[84:87], a[96:99]
    v_mfma_f32_16x16x32_bf16 a[100:103], v[124:127], v[88:91], a[100:103]
    v_mfma_f32_16x16x32_bf16 a[104:107], v[124:127], v[92:95], a[104:107]
    v_mfma_f32_16x16x32_bf16 a[108:111], v[124:127], v[96:99], a[108:111]
    v_mfma_f32_16x16x32_bf16 a[112:115], v[124:127], v[100:103], a[112:115]
    v_mfma_f32_16x16x32_bf16 a[116:119], v[124:127], v[104:107], a[116:119]
    s_waitcnt lgkmcnt(0)
    s_waitcnt vmcnt(6)
    s_barrier
    v_mfma_f32_16x16x32_bf16 a[0:3], v[64:67], v[40:43], a[0:3]
    ds_read_b64_tr_b16 v[108:109], v27
    ds_read_b64_tr_b16 v[110:111], v27 offset:1280
    v_mfma_f32_16x16x32_bf16 a[4:7], v[64:67], v[44:47], a[4:7]
    ds_read_b128 v[84:87], v26 offset:0
    v_mfma_f32_16x16x32_bf16 a[8:11], v[64:67], v[48:51], a[8:11]
    s_add_u32 m0, s36, 0
    s_add_u32 s39, s34, 0
    buffer_load_dwordx4 v8, s[12:15], s39 offen lds
    v_mfma_f32_16x16x32_bf16 a[12:15], v[64:67], v[52:55], a[12:15]
    ds_read_b128 v[88:91], v26 offset:1024
    v_mfma_f32_16x16x32_bf16 a[16:19], v[64:67], v[56:59], a[16:19]
    ds_read_b128 v[92:95], v26 offset:2048
    v_mfma_f32_16x16x32_bf16 a[20:23], v[64:67], v[60:63], a[20:23]
    s_add_u32 m0, s36, 1024
    s_add_u32 s39, s34, 196608
    buffer_load_dwordx4 v8, s[12:15], s39 offen lds
    v_mfma_f32_16x16x32_bf16 a[24:27], v[68:71], v[40:43], a[24:27]
    ds_read_b64_tr_b16 v[112:113], v28
    ds_read_b64_tr_b16 v[114:115], v28 offset:1280
    v_mfma_f32_16x16x32_bf16 a[28:31], v[68:71], v[44:47], a[28:31]
    ds_read_b128 v[96:99], v26 offset:3072
    v_mfma_f32_16x16x32_bf16 a[32:35], v[68:71], v[48:51], a[32:35]
    s_add_u32 m0, s36, 2048
    s_add_u32 s39, s34, 393216
    buffer_load_dwordx4 v8, s[12:15], s39 offen lds
    v_mfma_f32_16x16x32_bf16 a[36:39], v[68:71], v[52:55], a[36:39]
    ds_read_b128 v[100:103], v26 offset:4096
    v_mfma_f32_16x16x32_bf16 a[40:43], v[68:71], v[56:59], a[40:43]
    ds_read_b128 v[104:107], v26 offset:5120
    v_mfma_f32_16x16x32_bf16 a[44:47], v[68:71], v[60:63], a[44:47]
    s_add_u32 m0, s36, 24576
    s_nop 0
    buffer_load_dwordx4 v9, s[8:11], s35 offen lds
    v_mfma_f32_16x16x32_bf16 a[48:51], v[72:75], v[40:43], a[48:51]
    ds_read_b64_tr_b16 v[116:117], v29
    ds_read_b64_tr_b16 v[118:119], v29 offset:1280
    v_mfma_f32_16x16x32_bf16 a[52:55], v[72:75], v[44:47], a[52:55]
    ds_read_b64_tr_b16 v[120:121], v30
    ds_read_b64_tr_b16 v[122:123], v30 offset:1280
    v_mfma_f32_16x16x32_bf16 a[56:59], v[72:75], v[48:51], a[56:59]
    s_add_u32 m0, s36, 25600
    s_nop 0
    buffer_load_dwordx4 v10, s[8:11], s35 offen lds
    v_mfma_f32_16x16x32_bf16 a[60:63], v[72:75], v[52:55], a[60:63]
    ds_read_b64_tr_b16 v[124:125], v31
    s_waitcnt lgkmcnt(12)
    ds_read_b64_tr_b16 v[126:127], v31 offset:1280
    v_mfma_f32_16x16x32_bf16 a[64:67], v[72:75], v[56:59], a[64:67]
    s_add_u32 m0, s36, 26624
    s_nop 0
    buffer_load_dwordx4 v11, s[8:11], s35 offen lds
    s_add_u32 s34, s34, 2048
    s_add_u32 s35, s35, 81920
    v_mfma_f32_16x16x32_bf16 a[68:71], v[72:75], v[60:63], a[68:71]
    v_mfma_f32_16x16x32_bf16 a[72:75], v[76:79], v[40:43], a[72:75]
    v_mfma_f32_16x16x32_bf16 a[76:79], v[76:79], v[44:47], a[76:79]
    v_mfma_f32_16x16x32_bf16 a[80:83], v[76:79], v[48:51], a[80:83]
    v_mfma_f32_16x16x32_bf16 a[84:87], v[76:79], v[52:55], a[84:87]
    v_mfma_f32_16x16x32_bf16 a[88:91], v[76:79], v[56:59], a[88:91]
    v_mfma_f32_16x16x32_bf16 a[92:95], v[76:79], v[60:63], a[92:95]
    v_mfma_f32_16x16x32_bf16 a[96:99], v[80:83], v[40:43], a[96:99]
    v_mfma_f32_16x16x32_bf16 a[100:103], v[80:83], v[44:47], a[100:103]
    v_mfma_f32_16x16x32_bf16 a[104:107], v[80:83], v[48:51], a[104:107]
    v_mfma_f32_16x16x32_bf16 a[108:111], v[80:83], v[52:55], a[108:111]
    v_mfma_f32_16x16x32_bf16 a[112:115], v[80:83], v[56:59], a[112:115]
    v_mfma_f32_16x16x32_bf16 a[116:119], v[80:83], v[60:63], a[116:119]
    s_waitcnt lgkmcnt(0)
    s_waitcnt vmcnt(6)
    s_barrier
    v_mfma_f32_16x16x32_bf16 a[0:3], v[108:111], v[84:87], a[0:3]
    ds_read_b64_tr_b16 v[64:65], v33
    ds_read_b64_tr_b16 v[66:67], v33 offset:1280
    v_mfma_f32_16x16x32_bf16 a[4:7], v[108:111], v[88:91], a[4:7]
    ds_read_b128 v[40:43], v32 offset:0
    v_mfma_f32_16x16x32_bf16 a[8:11], v[108:111], v[92:95], a[8:11]
    s_add_u32 m0, s36, 49152
    s_add_u32 s39, s34, 0
    buffer_load_dwordx4 v8, s[12:15], s39 offen lds
    v_mfma_f32_16x16x32_bf16 a[12:15], v[108:111], v[96:99], a[12:15]
    ds_read_b128 v[44:47], v32 offset:1024
    v_mfma_f32_16x16x32_bf16 a[16:19], v[108:111], v[100:103], a[16:19]
    ds_read_b128 v[48:51], v32 offset:2048
    v_mfma_f32_16x16x32_bf16 a[20:23], v[108:111], v[104:107], a[20:23]
    s_add_u32 m0, s36, 50176
    s_add_u32 s39, s34, 196608
    buffer_load_dwordx4 v8, s[12:15], s39 offen lds
    v_mfma_f32_16x16x32_bf16 a[24:27], v[112:115], v[84:87], a[24:27]
    ds_read_b64_tr_b16 v[68:69], v34
    ds_read_b64_tr_b16 v[70:71], v34 offset:1280
    v_mfma_f32_16x16x32_bf16 a[28:31], v[112:115], v[88:91], a[28:31]
    ds_read_b128 v[52:55], v32 offset:3072
    v_mfma_f32_16x16x32_bf16 a[32:35], v[112:115], v[92:95], a[32:35]
    s_add_u32 m0, s36, 51200
    s_add_u32 s39, s34, 393216
    buffer_load_dwordx4 v8, s[12:15], s39 offen lds
    v_mfma_f32_16x16x32_bf16 a[36:39], v[112:115], v[96:99], a[36:39]
    ds_read_b128 v[56:59], v32 offset:4096
    v_mfma_f32_16x16x32_bf16 a[40:43], v[112:115], v[100:103], a[40:43]
    ds_read_b128 v[60:63], v32 offset:5120
    v_mfma_f32_16x16x32_bf16 a[44:47], v[112:115], v[104:107], a[44:47]
    s_add_u32 m0, s36, 73728
    s_nop 0
    buffer_load_dwordx4 v9, s[8:11], s35 offen lds
    v_mfma_f32_16x16x32_bf16 a[48:51], v[116:119], v[84:87], a[48:51]
    ds_read_b64_tr_b16 v[72:73], v35
    ds_read_b64_tr_b16 v[74:75], v35 offset:1280
    v_mfma_f32_16x16x32_bf16 a[52:55], v[116:119], v[88:91], a[52:55]
    ds_read_b64_tr_b16 v[76:77], v36
    ds_read_b64_tr_b16 v[78:79], v36 offset:1280
    v_mfma_f32_16x16x32_bf16 a[56:59], v[116:119], v[92:95], a[56:59]
    s_add_u32 m0, s36, 74752
    s_nop 0
    buffer_load_dwordx4 v10, s[8:11], s35 offen lds
    v_mfma_f32_16x16x32_bf16 a[60:63], v[116:119], v[96:99], a[60:63]
    ds_read_b64_tr_b16 v[80:81], v37
    s_waitcnt lgkmcnt(12)
    ds_read_b64_tr_b16 v[82:83], v37 offset:1280
    v_mfma_f32_16x16x32_bf16 a[64:67], v[116:119], v[100:103], a[64:67]
    s_add_u32 m0, s36, 75776
    s_nop 0
    buffer_load_dwordx4 v11, s[8:11], s35 offen lds
    s_add_u32 s34, s34, 2048
    s_add_u32 s35, s35, 81920
    v_mfma_f32_16x16x32_bf16 a[68:71], v[116:119], v[104:107], a[68:71]
    v_mfma_f32_16x16x32_bf16 a[72:75], v[120:123], v[84:87], a[72:75]
    v_mfma_f32_16x16x32_bf16 a[76:79], v[120:123], v[88:91], a[76:79]
    v_mfma_f32_16x16x32_bf16 a[80:83], v[120:123], v[92:95], a[80:83]
    v_mfma_f32_16x16x32_bf16 a[84:87], v[120:123], v[96:99], a[84:87]
    v_mfma_f32_16x16x32_bf16 a[88:91], v[120:123], v[100:103], a[88:91]
    v_mfma_f32_16x16x32_bf16 a[92:95], v[120:123], v[104:107], a[92:95]
    v_mfma_f32_16x16x32_bf16 a[96:99], v[124:127], v[84:87], a[96:99]
    v_mfma_f32_16x16x32_bf16 a[100:103], v[124:127], v[88:91], a[100:103]
    v_mfma_f32_16x16x32_bf16 a[104:107], v[124:127], v[92:95], a[104:107]
    v_mfma_f32_16x16x32_bf16 a[108:111], v[124:127], v[96:99], a[108:111]
    v_mfma_f32_16x16x32_bf16 a[112:115], v[124:127], v[100:103], a[112:115]
    v_mfma_f32_16x16x32_bf16 a[116:119], v[124:127], v[104:107], a[116:119]
    s_waitcnt lgkmcnt(0)
    s_waitcnt vmcnt(6)
    s_barrier
    v_mfma_f32_16x16x32_bf16 a[0:3], v[64:67], v[40:43], a[0:3]
    ds_read_b64_tr_b16 v[108:109], v21
    ds_read_b64_tr_b16 v[110:111], v21 offset:1280
    v_mfma_f32_16x16x32_bf16 a[4:7], v[64:67], v[44:47], a[4:7]
    ds_read_b128 v[84:87], v20 offset:0
    v_mfma_f32_16x16x32_bf16 a[8:11], v[64:67], v[48:51], a[8:11]
    s_add_u32 m0, s36, 98304
    s_add_u32 s39, s34, 0
    buffer_load_dwordx4 v8, s[12:15], s39 offen lds
    v_mfma_f32_16x16x32_bf16 a[12:15], v[64:67], v[52:55], a[12:15]
    ds_read_b128 v[88:91], v20 offset:1024
    v_mfma_f32_16x16x32_bf16 a[16:19], v[64:67], v[56:59], a[16:19]
    ds_read_b128 v[92:95], v20 offset:2048
    v_mfma_f32_16x16x32_bf16 a[20:23], v[64:67], v[60:63], a[20:23]
    s_add_u32 m0, s36, 99328
    s_add_u32 s39, s34, 196608
    buffer_load_dwordx4 v8, s[12:15], s39 offen lds
    v_mfma_f32_16x16x32_bf16 a[24:27], v[68:71], v[40:43], a[24:27]
    ds_read_b64_tr_b16 v[112:113], v22
    ds_read_b64_tr_b16 v[114:115], v22 offset:1280
    v_mfma_f32_16x16x32_bf16 a[28:31], v[68:71], v[44:47], a[28:31]
    ds_read_b128 v[96:99], v20 offset:3072
    v_mfma_f32_16x16x32_bf16 a[32:35], v[68:71], v[48:51], a[32:35]
    s_add_u32 m0, s36, 100352
    s_add_u32 s39, s34, 393216
    buffer_load_dwordx4 v8, s[12:15], s39 offen lds
    v_mfma_f32_16x16x32_bf16 a[36:39], v[68:71], v[52:55], a[36:39]
    ds_read_b128 v[100:103], v20 offset:4096
    v_mfma_f32_16x16x32_bf16 a[40:43], v[68:71], v[56:59], a[40:43]
    ds_read_b128 v[104:107], v20 offset:5120
    v_mfma_f32_16x16x32_bf16 a[44:47], v[68:71], v[60:63], a[44:47]
    s_add_u32 m0, s36, 122880
    s_nop 0
    buffer_load_dwordx4 v9, s[8:11], s35 offen lds
    v_mfma_f32_16x16x32_bf16 a[48:51], v[72:75], v[40:43], a[48:51]
    ds_read_b64_tr_b16 v[116:117], v23
    ds_read_b64_tr_b16 v[118:119], v23 offset:1280
    v_mfma_f32_16x16x32_bf16 a[52:55], v[72:75], v[44:47], a[52:55]
    ds_read_b64_tr_b16 v[120:121], v24
    ds_read_b64_tr_b16 v[122:123], v24 offset:1280
    v_mfma_f32_16x16x32_bf16 a[56:59], v[72:75], v[48:51], a[56:59]
    s_add_u32 m0, s36, 123904
    s_nop 0
    buffer_load_dwordx4 v10, s[8:11], s35 offen lds
    v_mfma_f32_16x16x32_bf16 a[60:63], v[72:75], v[52:55], a[60:63]
    ds_read_b64_tr_b16 v[124:125], v25
    s_waitcnt lgkmcnt(12)
    ds_read_b64_tr_b16 v[126:127], v25 offset:1280
    v_mfma_f32_16x16x32_bf16 a[64:67], v[72:75], v[56:59], a[64:67]
    s_add_u32 m0, s36, 124928
    s_nop 0
    buffer_load_dwordx4 v11, s[8:11], s35 offen lds
    s_add_u32 s34, s34, 2048
    s_add_u32 s35, s35, 81920
    v_mfma_f32_16x16x32_bf16 a[68:71], v[72:75], v[60:63], a[68:71]
    v_mfma_f32_16x16x32_bf16 a[72:75], v[76:79], v[40:43], a[72:75]
    v_mfma_f32_16x16x32_bf16 a[76:79], v[76:79], v[44:47], a[76:79]
    v_mfma_f32_16x16x32_bf16 a[80:83], v[76:79], v[48:51], a[80:83]
    v_mfma_f32_16x16x32_bf16 a[84:87], v[76:79], v[52:55], a[84:87]
    v_mfma_f32_16x16x32_bf16 a[88:91], v[76:79], v[56:59], a[88:91]
    v_mfma_f32_16x16x32_bf16 a[92:95], v[76:79], v[60:63], a[92:95]
    v_mfma_f32_16x16x32_bf16 a[96:99], v[80:83], v[40:43], a[96:99]
    v_mfma_f32_16x16x32_bf16 a[100:103], v[80:83], v[44:47], a[100:103]
    v_mfma_f32_16x16x32_bf16 a[104:107], v[80:83], v[48:51], a[104:107]
    v_mfma_f32_16x16x32_bf16 a[108:111], v[80:83], v[52:55], a[108:111]
    v_mfma_f32_16x16x32_bf16 a[112:115], v[80:83], v[56:59], a[112:115]
    v_mfma_f32_16x16x32_bf16 a[116:119], v[80:83], v[60:63], a[116:119]
    s_waitcnt lgkmcnt(0)
    s_waitcnt vmcnt(6)
    s_barrier
    v_mfma_f32_16x16x32_bf16 a[0:3], v[108:111], v[84:87], a[0:3]
    ds_read_b64_tr_b16 v[64:65], v27
    ds_read_b64_tr_b16 v[66:67], v27 offset:1280
    v_mfma_f32_16x16x32_bf16 a[4:7], v[108:111], v[88:91], a[4:7]
    ds_read_b128 v[40:43], v26 offset:0
    v_mfma_f32_16x16x32_bf16 a[8:11], v[108:111], v[92:95], a[8:11]
    s_add_u32 m0, s36, 0
    s_add_u32 s39, s34, 0
    buffer_load_dwordx4 v8, s[12:15], s39 offen lds
    v_mfma_f32_16x16x32_bf16 a[12:15], v[108:111], v[96:99], a[12:15]
    ds_read_b128 v[44:47], v26 offset:1024
    v_mfma_f32_16x16x32_bf16 a[16:19], v[108:111], v[100:103], a[16:19]
    ds_read_b128 v[48:51], v26 offset:2048
    v_mfma_f32_16x16x32_bf16 a[20:23], v[108:111], v[104:107], a[20:23]
    s_add_u32 m0, s36, 1024
    s_add_u32 s39, s34, 196608
    buffer_load_dwordx4 v8, s[12:15], s39 offen lds
    v_mfma_f32_16x16x32_bf16 a[24:27], v[112:115], v[84:87], a[24:27]
    ds_read_b64_tr_b16 v[68:69], v28
    ds_read_b64_tr_b16 v[70:71], v28 offset:1280
    v_mfma_f32_16x16x32_bf16 a[28:31], v[112:115], v[88:91], a[28:31]
    ds_read_b128 v[52:55], v26 offset:3072
    v_mfma_f32_16x16x32_bf16 a[32:35], v[112:115], v[92:95], a[32:35]
    s_add_u32 m0, s36, 2048
    s_add_u32 s39, s34, 393216
    buffer_load_dwordx4 v8, s[12:15], s39 offen lds
    v_mfma_f32_16x16x32_bf16 a[36:39], v[112:115], v[96:99], a[36:39]
    ds_read_b128 v[56:59], v26 offset:4096
    v_mfma_f32_16x16x32_bf16 a[40:43], v[112:115], v[100:103], a[40:43]
    ds_read_b128 v[60:63], v26 offset:5120
    v_mfma_f32_16x16x32_bf16 a[44:47], v[112:115], v[104:107], a[44:47]
    s_add_u32 m0, s36, 24576
    s_nop 0
    buffer_load_dwordx4 v9, s[8:11], s35 offen lds
    v_mfma_f32_16x16x32_bf16 a[48:51], v[116:119], v[84:87], a[48:51]
    ds_read_b64_tr_b16 v[72:73], v29
    ds_read_b64_tr_b16 v[74:75], v29 offset:1280
    v_mfma_f32_16x16x32_bf16 a[52:55], v[116:119], v[88:91], a[52:55]
    ds_read_b64_tr_b16 v[76:77], v30
    ds_read_b64_tr_b16 v[78:79], v30 offset:1280
    v_mfma_f32_16x16x32_bf16 a[56:59], v[116:119], v[92:95], a[56:59]
    s_add_u32 m0, s36, 25600
    s_nop 0
    buffer_load_dwordx4 v10, s[8:11], s35 offen lds
    v_mfma_f32_16x16x32_bf16 a[60:63], v[116:119], v[96:99], a[60:63]
    ds_read_b64_tr_b16 v[80:81], v31
    s_waitcnt lgkmcnt(12)
    ds_read_b64_tr_b16 v[82:83], v31 offset:1280
    v_mfma_f32_16x16x32_bf16 a[64:67], v[116:119], v[100:103], a[64:67]
    s_add_u32 m0, s36, 26624
    s_nop 0
    buffer_load_dwordx4 v11, s[8:11], s35 offen lds
    s_add_u32 s34, s34, 2048
    s_add_u32 s35, s35, 81920
    v_mfma_f32_16x16x32_bf16 a[68:71], v[116:119], v[104:107], a[68:71]
    v_mfma_f32_16x16x32_bf16 a[72:75], v[120:123], v[84:87], a[72:75]
    v_mfma_f32_16x16x32_bf16 a[76:79], v[120:123], v[88:91], a[76:79]
    v_mfma_f32_16x16x32_bf16 a[80:83], v[120:123], v[92:95], a[80:83]
    v_mfma_f32_16x16x32_bf16 a[84:87], v[120:123], v[96:99], a[84:87]
    v_mfma_f32_16x16x32_bf16 a[88:91], v[120:123], v[100:103], a[88:91]
    v_mfma_f32_16x16x32_bf16 a[92:95], v[120:123], v[104:107], a[92:95]
    v_mfma_f32_16x16x32_bf16 a[96:99], v[124:127], v[84:87], a[96:99]
    v_mfma_f32_16x16x32_bf16 a[100:103], v[124:127], v[88:91], a[100:103]
    v_mfma_f32_16x16x32_bf16 a[104:107], v[124:127], v[92:95], a[104:107]
    v_mfma_f32_16x16x32_bf16 a[108:111], v[124:127], v[96:99], a[108:111]
    v_mfma_f32_16x16x32_bf16 a[112:115], v[124:127], v[100:103], a[112:115]
    v_mfma_f32_16x16x32_bf16 a[116:119], v[124:127], v[104:107], a[116:119]
    s_waitcnt lgkmcnt(0)
    s_waitcnt vmcnt(6)
    s_barrier
    v_mfma_f32_16x16x32_bf16 a[0:3], v[64:67], v[40:43], a[0:3]
    ds_read_b64_tr_b16 v[108:109], v33
    ds_read_b64_tr_b16 v[110:111], v33 offset:1280
    v_mfma_f32_16x16x32_bf16 a[4:7], v[64:67], v[44:47], a[4:7]
    ds_read_b128 v[84:87], v32 offset:0
    v_mfma_f32_16x16x32_bf16 a[8:11], v[64:67], v[48:51], a[8:11]
    s_add_u32 m0, s36, 49152
    s_add_u32 s39, s34, 0
    buffer_load_dwordx4 v8, s[12:15], s39 offen lds
    v_mfma_f32_16x16x32_bf16 a[12:15], v[64:67], v[52:55], a[12:15]
    ds_read_b128 v[88:91], v32 offset:1024
    v_mfma_f32_16x16x32_bf16 a[16:19], v[64:67], v[56:59], a[16:19]
    ds_read_b128 v[92:95], v32 offset:2048
    v_mfma_f32_16x16x32_bf16 a[20:23], v[64:67], v[60:63], a[20:23]
    s_add_u32 m0, s36, 50176
    s_add_u32 s39, s34, 196608
    buffer_load_dwordx4 v8, s[12:15], s39 offen lds
    v_mfma_f32_16x16x32_bf16 a[24:27], v[68:71], v[40:43], a[24:27]
    ds_read_b64_tr_b16 v[112:113], v34
    ds_read_b64_tr_b16 v[114:115], v34 offset:1280
    v_mfma_f32_16x16x32_bf16 a[28:31], v[68:71], v[44:47], a[28:31]
    ds_read_b128 v[96:99], v32 offset:3072
    v_mfma_f32_16x16x32_bf16 a[32:35], v[68:71], v[48:51], a[32:35]
    s_add_u32 m0, s36, 51200
    s_add_u32 s39, s34, 393216
    buffer_load_dwordx4 v8, s[12:15], s39 offen lds
    v_mfma_f32_16x16x32_bf16 a[36:39], v[68:71], v[52:55], a[36:39]
    ds_read_b128 v[100:103], v32 offset:4096
    v_mfma_f32_16x16x32_bf16 a[40:43], v[68:71], v[56:59], a[40:43]
    ds_read_b128 v[104:107], v32 offset:5120
    v_mfma_f32_16x16x32_bf16 a[44:47], v[68:71], v[60:63], a[44:47]
    s_add_u32 m0, s36, 73728
    s_nop 0
    buffer_load_dwordx4 v9, s[8:11], s35 offen lds
    v_mfma_f32_16x16x32_bf16 a[48:51], v[72:75], v[40:43], a[48:51]
    ds_read_b64_tr_b16 v[116:117], v35
    ds_read_b64_tr_b16 v[118:119], v35 offset:1280
    v_mfma_f32_16x16x32_bf16 a[52:55], v[72:75], v[44:47], a[52:55]
    ds_read_b64_tr_b16 v[120:121], v36
    ds_read_b64_tr_b16 v[122:123], v36 offset:1280
    v_mfma_f32_16x16x32_bf16 a[56:59], v[72:75], v[48:51], a[56:59]
    s_add_u32 m0, s36, 74752
    s_nop 0
    buffer_load_dwordx4 v10, s[8:11], s35 offen lds
    v_mfma_f32_16x16x32_bf16 a[60:63], v[72:75], v[52:55], a[60:63]
    ds_read_b64_tr_b16 v[124:125], v37
    s_waitcnt lgkmcnt(12)
    ds_read_b64_tr_b16 v[126:127], v37 offset:1280
    v_mfma_f32_16x16x32_bf16 a[64:67], v[72:75], v[56:59], a[64:67]
    s_add_u32 m0, s36, 75776
    s_nop 0
    buffer_load_dwordx4 v11, s[8:11], s35 offen lds
    s_add_u32 s34, s34, 2048
    s_add_u32 s35, s35, 81920
    v_mfma_f32_16x16x32_bf16 a[68:71], v[72:75], v[60:63], a[68:71]
    v_mfma_f32_16x16x32_bf16 a[72:75], v[76:79], v[40:43], a[72:75]
    v_mfma_f32_16x16x32_bf16 a[76:79], v[76:79], v[44:47], a[76:79]
    v_mfma_f32_16x16x32_bf16 a[80:83], v[76:79], v[48:51], a[80:83]
    v_mfma_f32_16x16x32_bf16 a[84:87], v[76:79], v[52:55], a[84:87]
    v_mfma_f32_16x16x32_bf16 a[88:91], v[76:79], v[56:59], a[88:91]
    v_mfma_f32_16x16x32_bf16 a[92:95], v[76:79], v[60:63], a[92:95]
    v_mfma_f32_16x16x32_bf16 a[96:99], v[80:83], v[40:43], a[96:99]
    v_mfma_f32_16x16x32_bf16 a[100:103], v[80:83], v[44:47], a[100:103]
    v_mfma_f32_16x16x32_bf16 a[104:107], v[80:83], v[48:51], a[104:107]
    v_mfma_f32_16x16x32_bf16 a[108:111], v[80:83], v[52:55], a[108:111]
    v_mfma_f32_16x16x32_bf16 a[112:115], v[80:83], v[56:59], a[112:115]
    v_mfma_f32_16x16x32_bf16 a[116:119], v[80:83], v[60:63], a[116:119]
    s_waitcnt lgkmcnt(0)
    s_waitcnt vmcnt(6)
    s_barrier
    v_mfma_f32_16x16x32_bf16 a[0:3], v[108:111], v[84:87], a[0:3]
    ds_read_b64_tr_b16 v[64:65], v21
    ds_read_b64_tr_b16 v[66:67], v21 offset:1280
    v_mfma_f32_16x16x32_bf16 a[4:7], v[108:111], v[88:91], a[4:7]
    ds_read_b128 v[40:43], v20 offset:0
    v_mfma_f32_16x16x32_bf16 a[8:11], v[108:111], v[92:95], a[8:11]
    s_add_u32 m0, s36, 98304
    s_add_u32 s39, s34, 0
    buffer_load_dwordx4 v8, s[12:15], s39 offen lds
    v_mfma_f32_16x16x32_bf16 a[12:15], v[108:111], v[96:99], a[12:15]
    ds_read_b128 v[44:47], v20 offset:1024
    v_mfma_f32_16x16x32_bf16 a[16:19], v[108:111], v[100:103], a[16:19]
    ds_read_b128 v[48:51], v20 offset:2048
    v_mfma_f32_16x16x32_bf16 a[20:23], v[108:111], v[104:107], a[20:23]
    s_add_u32 m0, s36, 99328
    s_add_u32 s39, s34, 196608
    buffer_load_dwordx4 v8, s[12:15], s39 offen lds
    v_mfma_f32_16x16x32_bf16 a[24:27], v[112:115], v[84:87], a[24:27]
    ds_read_b64_tr_b16 v[68:69], v22
    ds_read_b64_tr_b16 v[70:71], v22 offset:1280
    v_mfma_f32_16x16x32_bf16 a[28:31], v[112:115], v[88:91], a[28:31]
    ds_read_b128 v[52:55], v20 offset:3072
    v_mfma_f32_16x16x32_bf16 a[32:35], v[112:115], v[92:95], a[32:35]
    s_add_u32 m0, s36, 100352
    s_add_u32 s39, s34, 393216
    buffer_load_dwordx4 v8, s[12:15], s39 offen lds
    v_mfma_f32_16x16x32_bf16 a[36:39], v[112:115], v[96:99], a[36:39]
    ds_read_b128 v[56:59], v20 offset:4096
    v_mfma_f32_16x16x32_bf16 a[40:43], v[112:115], v[100:103], a[40:43]
    ds_read_b128 v[60:63], v20 offset:5120
    v_mfma_f32_16x16x32_bf16 a[44:47], v[112:115], v[104:107], a[44:47]
    s_add_u32 m0, s36, 122880
    s_nop 0
    buffer_load_dwordx4 v9, s[8:11], s35 offen lds
    v_mfma_f32_16x16x32_bf16 a[48:51], v[116:119], v[84:87], a[48:51]
    ds_read_b64_tr_b16 v[72:73], v23
    ds_read_b64_tr_b16 v[74:75], v23 offset:1280
    v_mfma_f32_16x16x32_bf16 a[52:55], v[116:119], v[88:91], a[52:55]
    ds_read_b64_tr_b16 v[76:77], v24
    ds_read_b64_tr_b16 v[78:79], v24 offset:1280
    v_mfma_f32_16x16x32_bf16 a[56:59], v[116:119], v[92:95], a[56:59]
    s_add_u32 m0, s36, 123904
    s_nop 0
    buffer_load_dwordx4 v10, s[8:11], s35 offen lds
    v_mfma_f32_16x16x32_bf16 a[60:63], v[116:119], v[96:99], a[60:63]
    ds_read_b64_tr_b16 v[80:81], v25
    s_waitcnt lgkmcnt(12)
    ds_read_b64_tr_b16 v[82:83], v25 offset:1280
    v_mfma_f32_16x16x32_bf16 a[64:67], v[116:119], v[100:103], a[64:67]
    s_add_u32 m0, s36, 124928
    s_nop 0
    buffer_load_dwordx4 v11, s[8:11], s35 offen lds
    s_add_u32 s34, s34, 2048
    s_add_u32 s35, s35, 81920
    v_mfma_f32_16x16x32_bf16 a[68:71], v[116:119], v[104:107], a[68:71]
    v_mfma_f32_16x16x32_bf16 a[72:75], v[120:123], v[84:87], a[72:75]
    v_mfma_f32_16x16x32_bf16 a[76:79], v[120:123], v[88:91], a[76:79]
    v_mfma_f32_16x16x32_bf16 a[80:83], v[120:123], v[92:95], a[80:83]
    v_mfma_f32_16x16x32_bf16 a[84:87], v[120:123], v[96:99], a[84:87]
    v_mfma_f32_16x16x32_bf16 a[88:91], v[120:123], v[100:103], a[88:91]
    v_mfma_f32_16x16x32_bf16 a[92:95], v[120:123], v[104:107], a[92:95]
    v_mfma_f32_16x16x32_bf16 a[96:99], v[124:127], v[84:87], a[96:99]
    v_mfma_f32_16x16x32_bf16 a[100:103], v[124:127], v[88:91], a[100:103]
    v_mfma_f32_16x16x32_bf16 a[104:107], v[124:127], v[92:95], a[104:107]
    v_mfma_f32_16x16x32_bf16 a[108:111], v[124:127], v[96:99], a[108:111]
    v_mfma_f32_16x16x32_bf16 a[112:115], v[124:127], v[100:103], a[112:115]
    v_mfma_f32_16x16x32_bf16 a[116:119], v[124:127], v[104:107], a[116:119]
    s_waitcnt lgkmcnt(0)
    s_waitcnt vmcnt(6)
    s_barrier
    v_mfma_f32_16x16x32_bf16 a[0:3], v[64:67], v[40:43], a[0:3]
    ds_read_b64_tr_b16 v[108:109], v27
    ds_read_b64_tr_b16 v[110:111], v27 offset:1280
    v_mfma_f32_16x16x32_bf16 a[4:7], v[64:67], v[44:47], a[4:7]
    ds_read_b128 v[84:87], v26 offset:0
    v_mfma_f32_16x16x32_bf16 a[8:11], v[64:67], v[48:51], a[8:11]
    s_add_u32 m0, s36, 0
    s_add_u32 s39, s34, 0
    buffer_load_dwordx4 v8, s[12:15], s39 offen lds
    v_mfma_f32_16x16x32_bf16 a[12:15], v[64:67], v[52:55], a[12:15]
    ds_read_b128 v[88:91], v26 offset:1024
    v_mfma_f32_16x16x32_bf16 a[16:19], v[64:67], v[56:59], a[16:19]
    ds_read_b128 v[92:95], v26 offset:2048
    v_mfma_f32_16x16x32_bf16 a[20:23], v[64:67], v[60:63], a[20:23]
    s_add_u32 m0, s36, 1024
    s_add_u32 s39, s34, 196608
    buffer_load_dwordx4 v8, s[12:15], s39 offen lds
    v_mfma_f32_16x16x32_bf16 a[24:27], v[68:71], v[40:43], a[24:27]
    ds_read_b64_tr_b16 v[112:113], v28
    ds_read_b64_tr_b16 v[114:115], v28 offset:1280
    v_mfma_f32_16x16x32_bf16 a[28:31], v[68:71], v[44:47], a[28:31]
    ds_read_b128 v[96:99], v26 offset:3072
    v_mfma_f32_16x16x32_bf16 a[32:35], v[68:71], v[48:51], a[32:35]
    s_add_u32 m0, s36, 2048
    s_add_u32 s39, s34, 393216
    buffer_load_dwordx4 v8, s[12:15], s39 offen lds
    v_mfma_f32_16x16x32_bf16 a[36:39], v[68:71], v[52:55], a[36:39]
    ds_read_b128 v[100:103], v26 offset:4096
    v_mfma_f32_16x16x32_bf16 a[40:43], v[68:71], v[56:59], a[40:43]
    ds_read_b128 v[104:107], v26 offset:5120
    v_mfma_f32_16x16x32_bf16 a[44:47], v[68:71], v[60:63], a[44:47]
    s_add_u32 m0, s36, 24576
    s_nop 0
    buffer_load_dwordx4 v9, s[8:11], s35 offen lds
    v_mfma_f32_16x16x32_bf16 a[48:51], v[72:75], v[40:43], a[48:51]
    ds_read_b64_tr_b16 v[116:117], v29
    ds_read_b64_tr_b16 v[118:119], v29 offset:1280
    v_mfma_f32_16x16x32_bf16 a[52:55], v[72:75], v[44:47], a[52:55]
    ds_read_b64_tr_b16 v[120:121], v30
    ds_read_b64_tr_b16 v[122:123], v30 offset:1280
    v_mfma_f32_16x16x32_bf16 a[56:59], v[72:75], v[48:51], a[56:59]
    s_add_u32 m0, s36, 25600
    s_nop 0
    buffer_load_dwordx4 v10, s[8:11], s35 offen lds
    v_mfma_f32_16x16x32_bf16 a[60:63], v[72:75], v[52:55], a[60:63]
    ds_read_b64_tr_b16 v[124:125], v31
    s_waitcnt lgkmcnt(12)
    ds_read_b64_tr_b16 v[126:127], v31 offset:1280
    v_mfma_f32_16x16x32_bf16 a[64:67], v[72:75], v[56:59], a[64:67]
    s_add_u32 m0, s36, 26624
    s_nop 0
    buffer_load_dwordx4 v11, s[8:11], s35 offen lds
    s_add_u32 s34, s34, 2048
    s_add_u32 s35, s35, 81920
    v_mfma_f32_16x16x32_bf16 a[68:71], v[72:75], v[60:63], a[68:71]
    v_mfma_f32_16x16x32_bf16 a[72:75], v[76:79], v[40:43], a[72:75]
    v_mfma_f32_16x16x32_bf16 a[76:79], v[76:79], v[44:47], a[76:79]
    v_mfma_f32_16x16x32_bf16 a[80:83], v[76:79], v[48:51], a[80:83]
    v_mfma_f32_16x16x32_bf16 a[84:87], v[76:79], v[52:55], a[84:87]
    v_mfma_f32_16x16x32_bf16 a[88:91], v[76:79], v[56:59], a[88:91]
    v_mfma_f32_16x16x32_bf16 a[92:95], v[76:79], v[60:63], a[92:95]
    v_mfma_f32_16x16x32_bf16 a[96:99], v[80:83], v[40:43], a[96:99]
    v_mfma_f32_16x16x32_bf16 a[100:103], v[80:83], v[44:47], a[100:103]
    v_mfma_f32_16x16x32_bf16 a[104:107], v[80:83], v[48:51], a[104:107]
    v_mfma_f32_16x16x32_bf16 a[108:111], v[80:83], v[52:55], a[108:111]
    v_mfma_f32_16x16x32_bf16 a[112:115], v[80:83], v[56:59], a[112:115]
    v_mfma_f32_16x16x32_bf16 a[116:119], v[80:83], v[60:63], a[116:119]
    s_waitcnt lgkmcnt(0)
    s_waitcnt vmcnt(6)
    s_barrier
    v_mfma_f32_16x16x32_bf16 a[0:3], v[108:111], v[84:87], a[0:3]
    ds_read_b64_tr_b16 v[64:65], v33
    ds_read_b64_tr_b16 v[66:67], v33 offset:1280
    v_mfma_f32_16x16x32_bf16 a[4:7], v[108:111], v[88:91], a[4:7]
    ds_read_b128 v[40:43], v32 offset:0
    v_mfma_f32_16x16x32_bf16 a[8:11], v[108:111], v[92:95], a[8:11]
    s_add_u32 m0, s36, 49152
    s_add_u32 s39, s34, 0
    buffer_load_dwordx4 v8, s[12:15], s39 offen lds
    v_mfma_f32_16x16x32_bf16 a[12:15], v[108:111], v[96:99], a[12:15]
    ds_read_b128 v[44:47], v32 offset:1024
    v_mfma_f32_16x16x32_bf16 a[16:19], v[108:111], v[100:103], a[16:19]
    ds_read_b128 v[48:51], v32 offset:2048
    v_mfma_f32_16x16x32_bf16 a[20:23], v[108:111], v[104:107], a[20:23]
    s_add_u32 m0, s36, 50176
    s_add_u32 s39, s34, 196608
    buffer_load_dwordx4 v8, s[12:15], s39 offen lds
    v_mfma_f32_16x16x32_bf16 a[24:27], v[112:115], v[84:87], a[24:27]
    ds_read_b64_tr_b16 v[68:69], v34
    ds_read_b64_tr_b16 v[70:71], v34 offset:1280
    v_mfma_f32_16x16x32_bf16 a[28:31], v[112:115], v[88:91], a[28:31]
    ds_read_b128 v[52:55], v32 offset:3072
    v_mfma_f32_16x16x32_bf16 a[32:35], v[112:115], v[92:95], a[32:35]
    s_add_u32 m0, s36, 51200
    s_add_u32 s39, s34, 393216
    buffer_load_dwordx4 v8, s[12:15], s39 offen lds
    v_mfma_f32_16x16x32_bf16 a[36:39], v[112:115], v[96:99], a[36:39]
    ds_read_b128 v[56:59], v32 offset:4096
    v_mfma_f32_16x16x32_bf16 a[40:43], v[112:115], v[100:103], a[40:43]
    ds_read_b128 v[60:63], v32 offset:5120
    v_mfma_f32_16x16x32_bf16 a[44:47], v[112:115], v[104:107], a[44:47]
    s_add_u32 m0, s36, 73728
    s_nop 0
    buffer_load_dwordx4 v9, s[8:11], s35 offen lds
    v_mfma_f32_16x16x32_bf16 a[48:51], v[116:119], v[84:87], a[48:51]
    ds_read_b64_tr_b16 v[72:73], v35
    ds_read_b64_tr_b16 v[74:75], v35 offset:1280
    v_mfma_f32_16x16x32_bf16 a[52:55], v[116:119], v[88:91], a[52:55]
    ds_read_b64_tr_b16 v[76:77], v36
    ds_read_b64_tr_b16 v[78:79], v36 offset:1280
    v_mfma_f32_16x16x32_bf16 a[56:59], v[116:119], v[92:95], a[56:59]
    s_add_u32 m0, s36, 74752
    s_nop 0
    buffer_load_dwordx4 v10, s[8:11], s35 offen lds
    v_mfma_f32_16x16x32_bf16 a[60:63], v[116:119], v[96:99], a[60:63]
    ds_read_b64_tr_b16 v[80:81], v37
    s_waitcnt lgkmcnt(12)
    ds_read_b64_tr_b16 v[82:83], v37 offset:1280
    v_mfma_f32_16x16x32_bf16 a[64:67], v[116:119], v[100:103], a[64:67]
    s_add_u32 m0, s36, 75776
    s_nop 0
    buffer_load_dwordx4 v11, s[8:11], s35 offen lds
    s_add_u32 s34, s34, 2048
    s_add_u32 s35, s35, 81920
    v_mfma_f32_16x16x32_bf16 a[68:71], v[116:119], v[104:107], a[68:71]
    v_mfma_f32_16x16x32_bf16 a[72:75], v[120:123], v[84:87], a[72:75]
    v_mfma_f32_16x16x32_bf16 a[76:79], v[120:123], v[88:91], a[76:79]
    v_mfma_f32_16x16x32_bf16 a[80:83], v[120:123], v[92:95], a[80:83]
    v_mfma_f32_16x16x32_bf16 a[84:87], v[120:123], v[96:99], a[84:87]
    v_mfma_f32_16x16x32_bf16 a[88:91], v[120:123], v[100:103], a[88:91]
    v_mfma_f32_16x16x32_bf16 a[92:95], v[120:123], v[104:107], a[92:95]
    v_mfma_f32_16x16x32_bf16 a[96:99], v[124:127], v[84:87], a[96:99]
    v_mfma_f32_16x16x32_bf16 a[100:103], v[124:127], v[88:91], a[100:103]
    v_mfma_f32_16x16x32_bf16 a[104:107], v[124:127], v[92:95], a[104:107]
    v_mfma_f32_16x16x32_bf16 a[108:111], v[124:127], v[96:99], a[108:111]
    v_mfma_f32_16x16x32_bf16 a[112:115], v[124:127], v[100:103], a[112:115]
    v_mfma_f32_16x16x32_bf16 a[116:119], v[124:127], v[104:107], a[116:119]
    s_waitcnt lgkmcnt(0)
    s_waitcnt vmcnt(6)
    s_barrier
    v_mfma_f32_16x16x32_bf16 a[0:3], v[64:67], v[40:43], a[0:3]
    ds_read_b64_tr_b16 v[108:109], v21
    ds_read_b64_tr_b16 v[110:111], v21 offset:1280
    v_mfma_f32_16x16x32_bf16 a[4:7], v[64:67], v[44:47], a[4:7]
    ds_read_b128 v[84:87], v20 offset:0
    v_mfma_f32_16x16x32_bf16 a[8:11], v[64:67], v[48:51], a[8:11]
    s_add_u32 m0, s36, 98304
    s_add_u32 s39, s34, 0
    buffer_load_dwordx4 v8, s[12:15], s39 offen lds
    v_mfma_f32_16x16x32_bf16 a[12:15], v[64:67], v[52:55], a[12:15]
    ds_read_b128 v[88:91], v20 offset:1024
    v_mfma_f32_16x16x32_bf16 a[16:19], v[64:67], v[56:59], a[16:19]
    ds_read_b128 v[92:95], v20 offset:2048
    v_mfma_f32_16x16x32_bf16 a[20:23], v[64:67], v[60:63], a[20:23]
    s_add_u32 m0, s36, 99328
    s_add_u32 s39, s34, 196608
    buffer_load_dwordx4 v8, s[12:15], s39 offen lds
    v_mfma_f32_16x16x32_bf16 a[24:27], v[68:71], v[40:43], a[24:27]
    ds_read_b64_tr_b16 v[112:113], v22
    ds_read_b64_tr_b16 v[114:115], v22 offset:1280
    v_mfma_f32_16x16x32_bf16 a[28:31], v[68:71], v[44:47], a[28:31]
    ds_read_b128 v[96:99], v20 offset:3072
    v_mfma_f32_16x16x32_bf16 a[32:35], v[68:71], v[48:51], a[32:35]
    s_add_u32 m0, s36, 100352
    s_add_u32 s39, s34, 393216
    buffer_load_dwordx4 v8, s[12:15], s39 offen lds
    v_mfma_f32_16x16x32_bf16 a[36:39], v[68:71], v[52:55], a[36:39]
    ds_read_b128 v[100:103], v20 offset:4096
    v_mfma_f32_16x16x32_bf16 a[40:43], v[68:71], v[56:59], a[40:43]
    ds_read_b128 v[104:107], v20 offset:5120
    v_mfma_f32_16x16x32_bf16 a[44:47], v[68:71], v[60:63], a[44:47]
    s_add_u32 m0, s36, 122880
    s_nop 0
    buffer_load_dwordx4 v9, s[8:11], s35 offen lds
    v_mfma_f32_16x16x32_bf16 a[48:51], v[72:75], v[40:43], a[48:51]
    ds_read_b64_tr_b16 v[116:117], v23
    ds_read_b64_tr_b16 v[118:119], v23 offset:1280
    v_mfma_f32_16x16x32_bf16 a[52:55], v[72:75], v[44:47], a[52:55]
    ds_read_b64_tr_b16 v[120:121], v24
    ds_read_b64_tr_b16 v[122:123], v24 offset:1280
    v_mfma_f32_16x16x32_bf16 a[56:59], v[72:75], v[48:51], a[56:59]
    s_add_u32 m0, s36, 123904
    s_nop 0
    buffer_load_dwordx4 v10, s[8:11], s35 offen lds
    v_mfma_f32_16x16x32_bf16 a[60:63], v[72:75], v[52:55], a[60:63]
    ds_read_b64_tr_b16 v[124:125], v25
    s_waitcnt lgkmcnt(12)
    ds_read_b64_tr_b16 v[126:127], v25 offset:1280
    v_mfma_f32_16x16x32_bf16 a[64:67], v[72:75], v[56:59], a[64:67]
    s_add_u32 m0, s36, 124928
    s_nop 0
    buffer_load_dwordx4 v11, s[8:11], s35 offen lds
    s_add_u32 s34, s34, 2048
    s_add_u32 s35, s35, 81920
    v_mfma_f32_16x16x32_bf16 a[68:71], v[72:75], v[60:63], a[68:71]
    v_mfma_f32_16x16x32_bf16 a[72:75], v[76:79], v[40:43], a[72:75]
    v_mfma_f32_16x16x32_bf16 a[76:79], v[76:79], v[44:47], a[76:79]
    v_mfma_f32_16x16x32_bf16 a[80:83], v[76:79], v[48:51], a[80:83]
    v_mfma_f32_16x16x32_bf16 a[84:87], v[76:79], v[52:55], a[84:87]
    v_mfma_f32_16x16x32_bf16 a[88:91], v[76:79], v[56:59], a[88:91]
    v_mfma_f32_16x16x32_bf16 a[92:95], v[76:79], v[60:63], a[92:95]
    v_mfma_f32_16x16x32_bf16 a[96:99], v[80:83], v[40:43], a[96:99]
    v_mfma_f32_16x16x32_bf16 a[100:103], v[80:83], v[44:47], a[100:103]
    v_mfma_f32_16x16x32_bf16 a[104:107], v[80:83], v[48:51], a[104:107]
    v_mfma_f32_16x16x32_bf16 a[108:111], v[80:83], v[52:55], a[108:111]
    v_mfma_f32_16x16x32_bf16 a[112:115], v[80:83], v[56:59], a[112:115]
    v_mfma_f32_16x16x32_bf16 a[116:119], v[80:83], v[60:63], a[116:119]
    s_waitcnt lgkmcnt(0)
    s_waitcnt vmcnt(6)
    s_barrier
    v_mfma_f32_16x16x32_bf16 a[0:3], v[108:111], v[84:87], a[0:3]
    ds_read_b64_tr_b16 v[64:65], v27
    ds_read_b64_tr_b16 v[66:67], v27 offset:1280
    v_mfma_f32_16x16x32_bf16 a[4:7], v[108:111], v[88:91], a[4:7]
    ds_read_b128 v[40:43], v26 offset:0
    v_mfma_f32_16x16x32_bf16 a[8:11], v[108:111], v[92:95], a[8:11]
    ds_read_b128 v[44:47], v26 offset:1024
    v_mfma_f32_16x16x32_bf16 a[12:15], v[108:111], v[96:99], a[12:15]
    ds_read_b128 v[48:51], v26 offset:2048
    v_mfma_f32_16x16x32_bf16 a[16:19], v[108:111], v[100:103], a[16:19]
    ds_read_b64_tr_b16 v[68:69], v28
    ds_read_b64_tr_b16 v[70:71], v28 offset:1280
    v_mfma_f32_16x16x32_bf16 a[20:23], v[108:111], v[104:107], a[20:23]
    ds_read_b128 v[52:55], v26 offset:3072
    v_mfma_f32_16x16x32_bf16 a[24:27], v[112:115], v[84:87], a[24:27]
    ds_read_b128 v[56:59], v26 offset:4096
    v_mfma_f32_16x16x32_bf16 a[28:31], v[112:115], v[88:91], a[28:31]
    ds_read_b128 v[60:63], v26 offset:5120
    v_mfma_f32_16x16x32_bf16 a[32:35], v[112:115], v[92:95], a[32:35]
    ds_read_b64_tr_b16 v[72:73], v29
    ds_read_b64_tr_b16 v[74:75], v29 offset:1280
    v_mfma_f32_16x16x32_bf16 a[36:39], v[112:115], v[96:99], a[36:39]
    ds_read_b64_tr_b16 v[76:77], v30
    ds_read_b64_tr_b16 v[78:79], v30 offset:1280
    v_mfma_f32_16x16x32_bf16 a[40:43], v[112:115], v[100:103], a[40:43]
    ds_read_b64_tr_b16 v[80:81], v31
    s_waitcnt lgkmcnt(12)
    ds_read_b64_tr_b16 v[82:83], v31 offset:1280
    v_mfma_f32_16x16x32_bf16 a[44:47], v[112:115], v[104:107], a[44:47]
    v_mfma_f32_16x16x32_bf16 a[48:51], v[116:119], v[84:87], a[48:51]
    v_mfma_f32_16x16x32_bf16 a[52:55], v[116:119], v[88:91], a[52:55]
    v_mfma_f32_16x16x32_bf16 a[56:59], v[116:119], v[92:95], a[56:59]
    v_mfma_f32_16x16x32_bf16 a[60:63], v[116:119], v[96:99], a[60:63]
    v_mfma_f32_16x16x32_bf16 a[64:67], v[116:119], v[100:103], a[64:67]
    v_mfma_f32_16x16x32_bf16 a[68:71], v[116:119], v[104:107], a[68:71]
    v_mfma_f32_16x16x32_bf16 a[72:75], v[120:123], v[84:87], a[72:75]
    v_mfma_f32_16x16x32_bf16 a[76:79], v[120:123], v[88:91], a[76:79]
    v_mfma_f32_16x16x32_bf16 a[80:83], v[120:123], v[92:95], a[80:83]
    v_mfma_f32_16x16x32_bf16 a[84:87], v[120:123], v[96:99], a[84:87]
    v_mfma_f32_16x16x32_bf16 a[88:91], v[120:123], v[100:103], a[88:91]
    v_mfma_f32_16x16x32_bf16 a[92:95], v[120:123], v[104:107], a[92:95]
    v_mfma_f32_16x16x32_bf16 a[96:99], v[124:127], v[84:87], a[96:99]
    v_mfma_f32_16x16x32_bf16 a[100:103], v[124:127], v[88:91], a[100:103]
    v_mfma_f32_16x16x32_bf16 a[104:107], v[124:127], v[92:95], a[104:107]
    v_mfma_f32_16x16x32_bf16 a[108:111], v[124:127], v[96:99], a[108:111]
    v_mfma_f32_16x16x32_bf16 a[112:115], v[124:127], v[100:103], a[112:115]
    v_mfma_f32_16x16x32_bf16 a[116:119], v[124:127], v[104:107], a[116:119]
    s_waitcnt lgkmcnt(0)
    s_waitcnt vmcnt(0)
    s_barrier
    v_mfma_f32_16x16x32_bf16 a[0:3], v[64:67], v[40:43], a[0:3]
    ds_read_b64_tr_b16 v[108:109], v33
    ds_read_b64_tr_b16 v[110:111], v33 offset:1280
    v_mfma_f32_16x16x32_bf16 a[4:7], v[64:67], v[44:47], a[4:7]
    ds_read_b128 v[84:87], v32 offset:0
    v_mfma_f32_16x16x32_bf16 a[8:11], v[64:67], v[48:51], a[8:11]
    ds_read_b128 v[88:91], v32 offset:1024
    v_mfma_f32_16x16x32_bf16 a[12:15], v[64:67], v[52:55], a[12:15]
    ds_read_b128 v[92:95], v32 offset:2048
    v_mfma_f32_16x16x32_bf16 a[16:19], v[64:67], v[56:59], a[16:19]
    ds_read_b64_tr_b16 v[112:113], v34
    ds_read_b64_tr_b16 v[114:115], v34 offset:1280
    v_mfma_f32_16x16x32_bf16 a[20:23], v[64:67], v[60:63], a[20:23]
    ds_read_b128 v[96:99], v32 offset:3072
    v_mfma_f32_16x16x32_bf16 a[24:27], v[68:71], v[40:43], a[24:27]
    ds_read_b128 v[100:103], v32 offset:4096
    v_mfma_f32_16x16x32_bf16 a[28:31], v[68:71], v[44:47], a[28:31]
    ds_read_b128 v[104:107], v32 offset:5120
    v_mfma_f32_16x16x32_bf16 a[32:35], v[68:71], v[48:51], a[32:35]
    ds_read_b64_tr_b16 v[116:117], v35
    ds_read_b64_tr_b16 v[118:119], v35 offset:1280
    v_mfma_f32_16x16x32_bf16 a[36:39], v[68:71], v[52:55], a[36:39]
    ds_read_b64_tr_b16 v[120:121], v36
    ds_read_b64_tr_b16 v[122:123], v36 offset:1280
    v_mfma_f32_16x16x32_bf16 a[40:43], v[68:71], v[56:59], a[40:43]
    ds_read_b64_tr_b16 v[124:125], v37
    s_waitcnt lgkmcnt(12)
    ds_read_b64_tr_b16 v[126:127], v37 offset:1280
    v_mfma_f32_16x16x32_bf16 a[44:47], v[68:71], v[60:63], a[44:47]
    v_mfma_f32_16x16x32_bf16 a[48:51], v[72:75], v[40:43], a[48:51]
    v_mfma_f32_16x16x32_bf16 a[52:55], v[72:75], v[44:47], a[52:55]
    v_mfma_f32_16x16x32_bf16 a[56:59], v[72:75], v[48:51], a[56:59]
    v_mfma_f32_16x16x32_bf16 a[60:63], v[72:75], v[52:55], a[60:63]
    v_mfma_f32_16x16x32_bf16 a[64:67], v[72:75], v[56:59], a[64:67]
    v_mfma_f32_16x16x32_bf16 a[68:71], v[72:75], v[60:63], a[68:71]
    v_mfma_f32_16x16x32_bf16 a[72:75], v[76:79], v[40:43], a[72:75]
    v_mfma_f32_16x16x32_bf16 a[76:79], v[76:79], v[44:47], a[76:79]
    v_mfma_f32_16x16x32_bf16 a[80:83], v[76:79], v[48:51], a[80:83]
    v_mfma_f32_16x16x32_bf16 a[84:87], v[76:79], v[52:55], a[84:87]
    v_mfma_f32_16x16x32_bf16 a[88:91], v[76:79], v[56:59], a[88:91]
    v_mfma_f32_16x16x32_bf16 a[92:95], v[76:79], v[60:63], a[92:95]
    v_mfma_f32_16x16x32_bf16 a[96:99], v[80:83], v[40:43], a[96:99]
    v_mfma_f32_16x16x32_bf16 a[100:103], v[80:83], v[44:47], a[100:103]
    v_mfma_f32_16x16x32_bf16 a[104:107], v[80:83], v[48:51], a[104:107]
    v_mfma_f32_16x16x32_bf16 a[108:111], v[80:83], v[52:55], a[108:111]
    v_mfma_f32_16x16x32_bf16 a[112:115], v[80:83], v[56:59], a[112:115]
    v_mfma_f32_16x16x32_bf16 a[116:119], v[80:83], v[60:63], a[116:119]
    v_mfma_f32_16x16x32_bf16 a[0:3], v[108:111], v[84:87], a[0:3]
    s_waitcnt lgkmcnt(12)
    v_mfma_f32_16x16x32_bf16 a[4:7], v[108:111], v[88:91], a[4:7]
    s_waitcnt lgkmcnt(11)
    v_mfma_f32_16x16x32_bf16 a[8:11], v[108:111], v[92:95], a[8:11]
    s_waitcnt lgkmcnt(8)
    v_mfma_f32_16x16x32_bf16 a[12:15], v[108:111], v[96:99], a[12:15]
    s_waitcnt lgkmcnt(7)
    v_mfma_f32_16x16x32_bf16 a[16:19], v[108:111], v[100:103], a[16:19]
    s_waitcnt lgkmcnt(6)
    v_mfma_f32_16x16x32_bf16 a[20:23], v[108:111], v[104:107], a[20:23]
    v_mfma_f32_16x16x32_bf16 a[24:27], v[112:115], v[84:87], a[24:27]
    v_mfma_f32_16x16x32_bf16 a[28:31], v[112:115], v[88:91], a[28:31]
    v_mfma_f32_16x16x32_bf16 a[32:35], v[112:115], v[92:95], a[32:35]
    v_mfma_f32_16x16x32_bf16 a[36:39], v[112:115], v[96:99], a[36:39]
    v_mfma_f32_16x16x32_bf16 a[40:43], v[112:115], v[100:103], a[40:43]
    v_mfma_f32_16x16x32_bf16 a[44:47], v[112:115], v[104:107], a[44:47]
    s_waitcnt lgkmcnt(4)
    v_mfma_f32_16x16x32_bf16 a[48:51], v[116:119], v[84:87], a[48:51]
    v_mfma_f32_16x16x32_bf16 a[52:55], v[116:119], v[88:91], a[52:55]
    v_mfma_f32_16x16x32_bf16 a[56:59], v[116:119], v[92:95], a[56:59]
    v_mfma_f32_16x16x32_bf16 a[60:63], v[116:119], v[96:99], a[60:63]
    v_mfma_f32_16x16x32_bf16 a[64:67], v[116:119], v[100:103], a[64:67]
    v_mfma_f32_16x16x32_bf16 a[68:71], v[116:119], v[104:107], a[68:71]
    s_waitcnt lgkmcnt(2)
    v_mfma_f32_16x16x32_bf16 a[72:75], v[120:123], v[84:87], a[72:75]
    v_mfma_f32_16x16x32_bf16 a[76:79], v[120:123], v[88:91], a[76:79]
    v_mfma_f32_16x16x32_bf16 a[80:83], v[120:123], v[92:95], a[80:83]
    v_mfma_f32_16x16x32_bf16 a[84:87], v[120:123], v[96:99], a[84:87]
    v_mfma_f32_16x16x32_bf16 a[88:91], v[120:123], v[100:103], a[88:91]
    v_mfma_f32_16x16x32_bf16 a[92:95], v[120:123], v[104:107], a[92:95]
    s_waitcnt lgkmcnt(0)
    v_mfma_f32_16x16x32_bf16 a[96:99], v[124:127], v[84:87], a[96:99]
    v_mfma_f32_16x16x32_bf16 a[100:103], v[124:127], v[88:91], a[100:103]
    v_mfma_f32_16x16x32_bf16 a[104:107], v[124:127], v[92:95], a[104:107]
    v_mfma_f32_16x16x32_bf16 a[108:111], v[124:127], v[96:99], a[108:111]
    v_mfma_f32_16x16x32_bf16 a[112:115], v[124:127], v[100:103], a[112:115]
    v_mfma_f32_16x16x32_bf16 a[116:119], v[124:127], v[104:107], a[116:119]
    s_waitcnt vmcnt(0) lgkmcnt(0)
    s_barrier
    s_and_b32 s37, s30, 3
    s_mul_i32 s37, s37, 30720
    v_add_u32 v13, s37, v8
    s_cmp_eq_u32 s31, 0
    s_cbranch_scc1 L2_k0
    v_accvgpr_read_b32 v40, a0
    v_accvgpr_read_b32 v41, a1
    v_accvgpr_read_b32 v42, a2
    v_accvgpr_read_b32 v43, a3
    ds_write_b128 v13, v[40:43] offset:0
    v_accvgpr_read_b32 v44, a4
    v_accvgpr_read_b32 v45, a5
    v_accvgpr_read_b32 v46, a6
    v_accvgpr_read_b32 v47, a7
    ds_write_b128 v13, v[44:47] offset:1024
    v_accvgpr_read_b32 v48, a8
    v_accvgpr_read_b32 v49, a9
    v_accvgpr_read_b32 v50, a10
    v_accvgpr_read_b32 v51, a11
    ds_write_b128 v13, v[48:51] offset:2048
    v_accvgpr_read_b32 v52, a12
    v_accvgpr_read_b32 v53, a13
    v_accvgpr_read_b32 v54, a14
    v_accvgpr_read_b32 v55, a15
    ds_write_b128 v13, v[52:55] offset:3072
    v_accvgpr_read_b32 v56, a16
    v_accvgpr_read_b32 v57, a17
    v_accvgpr_read_b32 v58, a18
    v_accvgpr_read_b32 v59, a19
    ds_write_b128 v13, v[56:59] offset:4096
    v_accvgpr_read_b32 v60, a20
    v_accvgpr_read_b32 v61, a21
    v_accvgpr_read_b32 v62, a22
    v_accvgpr_read_b32 v63, a23
    ds_write_b128 v13, v[60:63] offset:5120
    v_accvgpr_read_b32 v64, a24
    v_accvgpr_read_b32 v65, a25
    v_accvgpr_read_b32 v66, a26
    v_accvgpr_read_b32 v67, a27
    ds_write_b128 v13, v[64:67] offset:6144
    v_accvgpr_read_b32 v68, a28
    v_accvgpr_read_b32 v69, a29
    v_accvgpr_read_b32 v70, a30
    v_accvgpr_read_b32 v71, a31
    ds_write_b128 v13, v[68:71] offset:7168
    v_accvgpr_read_b32 v40, a32
    v_accvgpr_read_b32 v41, a33
    v_accvgpr_read_b32 v42, a34
    v_accvgpr_read_b32 v43, a35
    ds_write_b128 v13, v[40:43] offset:8192
    v_accvgpr_read_b32 v44, a36
    v_accvgpr_read_b32 v45, a37
    v_accvgpr_read_b32 v46, a38
    v_accvgpr_read_b32 v47, a39
    ds_write_b128 v13, v[44:47] offset:9216
    v_accvgpr_read_b32 v48, a40
    v_accvgpr_read_b32 v49, a41
    v_accvgpr_read_b32 v50, a42
    v_accvgpr_read_b32 v51, a43
    ds_write_b128 v13, v[48:51] offset:10240
    v_accvgpr_read_b32 v52, a44
    v_accvgpr_read_b32 v53, a45
    v_accvgpr_read_b32 v54, a46
    v_accvgpr_read_b32 v55, a47
    ds_write_b128 v13, v[52:55] offset:11264
    v_accvgpr_read_b32 v56, a48
    v_accvgpr_read_b32 v57, a49
    v_accvgpr_read_b32 v58, a50
    v_accvgpr_read_b32 v59, a51
    ds_write_b128 v13, v[56:59] offset:12288
    v_accvgpr_read_b32 v60, a52
    v_accvgpr_read_b32 v61, a53
    v_accvgpr_read_b32 v62, a54
    v_accvgpr_read_b32 v63, a55
    ds_write_b128 v13, v[60:63] offset:13312
    v_accvgpr_read_b32 v64, a56
    v_accvgpr_read_b32 v65, a57
    v_accvgpr_read_b32 v66, a58
    v_accvgpr_read_b32 v67, a59
    ds_write_b128 v13, v[64:67] offset:14336
    v_accvgpr_read_b32 v68, a60
    v_accvgpr_read_b32 v69, a61
    v_accvgpr_read_b32 v70, a62
    v_accvgpr_read_b32 v71, a63
    s_waitcnt lgkmcnt(12)
    ds_write_b128 v13, v[68:71] offset:15360
    v_accvgpr_read_b32 v40, a64
    v_accvgpr_read_b32 v41, a65
    v_accvgpr_read_b32 v42, a66
    v_accvgpr_read_b32 v43, a67
    ds_write_b128 v13, v[40:43] offset:16384
    v_accvgpr_read_b32 v44, a68
    v_accvgpr_read_b32 v45, a69
    v_accvgpr_read_b32 v46, a70
    v_accvgpr_read_b32 v47, a71
    ds_write_b128 v13, v[44:47] offset:17408
    v_accvgpr_read_b32 v48, a72
    v_accvgpr_read_b32 v49, a73
    v_accvgpr_read_b32 v50, a74
    v_accvgpr_read_b32 v51, a75
    s_waitcnt lgkmcnt(12)
    ds_write_b128 v13, v[48:51] offset:18432
    v_accvgpr_read_b32 v52, a76
    v_accvgpr_read_b32 v53, a77
    v_accvgpr_read_b32 v54, a78
    v_accvgpr_read_b32 v55, a79
    ds_write_b128 v13, v[52:55] offset:19456
    v_accvgpr_read_b32 v56, a80
    v_accvgpr_read_b32 v57, a81
    v_accvgpr_read_b32 v58, a82
    v_accvgpr_read_b32 v59, a83
    ds_write_b128 v13, v[56:59] offset:20480
    v_accvgpr_read_b32 v60, a84
    v_accvgpr_read_b32 v61, a85
    v_accvgpr_read_b32 v62, a86
    v_accvgpr_read_b32 v63, a87
    s_waitcnt lgkmcnt(12)
    ds_write_b128 v13, v[60:63] offset:21504
    v_accvgpr_read_b32 v64, a88
    v_accvgpr_read_b32 v65, a89
    v_accvgpr_read_b32 v66, a90
    v_accvgpr_read_b32 v67, a91
    ds_write_b128 v13, v[64:67] offset:22528
    v_accvgpr_read_b32 v68, a92
    v_accvgpr_read_b32 v69, a93
    v_accvgpr_read_b32 v70, a94
    v_accvgpr_read_b32 v71, a95
    ds_write_b128 v13, v[68:71] offset:23552
    v_accvgpr_read_b32 v40, a96
    v_accvgpr_read_b32 v41, a97
    v_accvgpr_read_b32 v42, a98
    v_accvgpr_read_b32 v43, a99
    s_waitcnt lgkmcnt(12)
    ds_write_b128 v13, v[40:43] offset:24576
    v_accvgpr_read_b32 v44, a100
    v_accvgpr_read_b32 v45, a101
    v_accvgpr_read_b32 v46, a102
    v_accvgpr_read_b32 v47, a103
    ds_write_b128 v13, v[44:47] offset:25600
    v_accvgpr_read_b32 v48, a104
    v_accvgpr_read_b32 v49, a105
    v_accvgpr_read_b32 v50, a106
    v_accvgpr_read_b32 v51, a107
    ds_write_b128 v13, v[48:51] offset:26624
    v_accvgpr_read_b32 v52, a108
    v_accvgpr_read_b32 v53, a109
    v_accvgpr_read_b32 v54, a110
    v_accvgpr_read_b32 v55, a111
    s_waitcnt lgkmcnt(12)
    ds_write_b128 v13, v[52:55] offset:27648
    v_accvgpr_read_b32 v56, a112
    v_accvgpr_read_b32 v57, a113
    v_accvgpr_read_b32 v58, a114
    v_accvgpr_read_b32 v59, a115
    ds_write_b128 v13, v[56:59] offset:28672
    v_accvgpr_read_b32 v60, a116
    v_accvgpr_read_b32 v61, a117
    v_accvgpr_read_b32 v62, a118
    v_accvgpr_read_b32 v63, a119
    ds_write_b128 v13, v[60:63] offset:29696
    s_waitcnt lgkmcnt(0)
    s_barrier
    s_branch L2_end
L2_k0:
    s_barrier
    s_mul_i32 s37, s27, 192
    s_mul_i32 s38, s26, 96
    s_add_u32 s37, s37, s38
    s_mul_i32 s38, s28, 12
    s_add_u32 s37, s37, s38
    s_mul_i32 s38, s32, 6
    s_add_u32 s37, s37, s38
    s_mul_i32 s37, s37, 40
    s_mul_i32 s38, s29, 10
    s_add_u32 s37, s37, s38
    s_mul_i32 s38, s33, 5
    s_add_u32 s37, s37, s38
    s_lshl_b32 s37, s37, 10
    s_add_u32 s37, s37, 67108864
    ds_read_b128 v[40:43], v13 offset:0
    v_accvgpr_read_b32 v44, a0
    v_accvgpr_read_b32 v45, a1
    v_accvgpr_read_b32 v46, a2
    v_accvgpr_read_b32 v47, a3
    s_waitcnt lgkmcnt(0)
    v_add_f32 v40, v40, v44
    v_add_f32 v41, v41, v45
    v_add_f32 v42, v42, v46
    v_add_f32 v43, v43, v47
    s_add_u32 s38, s37, 0
    buffer_store_dwordx4 v[40:43], v8, s[16:19], s38 offen
    ds_read_b128 v[48:51], v13 offset:1024
    v_accvgpr_read_b32 v52, a4
    v_accvgpr_read_b32 v53, a5
    v_accvgpr_read_b32 v54, a6
    v_accvgpr_read_b32 v55, a7
    s_waitcnt lgkmcnt(0)
    v_add_f32 v48, v48, v52
    v_add_f32 v49, v49, v53
    v_add_f32 v50, v50, v54
    v_add_f32 v51, v51, v55
    s_add_u32 s38, s37, 40960
    buffer_store_dwordx4 v[48:51], v8, s[16:19], s38 offen
    ds_read_b128 v[56:59], v13 offset:2048
    v_accvgpr_read_b32 v60, a8
    v_accvgpr_read_b32 v61, a9
    v_accvgpr_read_b32 v62, a10
    v_accvgpr_read_b32 v63, a11
    s_waitcnt lgkmcnt(0)
    v_add_f32 v56, v56, v60
    v_add_f32 v57, v57, v61
    v_add_f32 v58, v58, v62
    v_add_f32 v59, v59, v63
    s_add_u32 s38, s37, 81920
    buffer_store_dwordx4 v[56:59], v8, s[16:19], s38 offen
    ds_read_b128 v[64:67], v13 offset:3072
    v_accvgpr_read_b32 v68, a12
    v_accvgpr_read_b32 v69, a13
    v_accvgpr_read_b32 v70, a14
    v_accvgpr_read_b32 v71, a15
    s_waitcnt lgkmcnt(0)
    v_add_f32 v64, v64, v68
    v_add_f32 v65, v65, v69
    v_add_f32 v66, v66, v70
    v_add_f32 v67, v67, v71
    s_add_u32 s38, s37, 122880
    buffer_store_dwordx4 v[64:67], v8, s[16:19], s38 offen
    ds_read_b128 v[72:75], v13 offset:4096
    v_accvgpr_read_b32 v76, a16
    v_accvgpr_read_b32 v77, a17
    v_accvgpr_read_b32 v78, a18
    v_accvgpr_read_b32 v79, a19
    s_waitcnt lgkmcnt(0)
    v_add_f32 v72, v72, v76
    v_add_f32 v73, v73, v77
    v_add_f32 v74, v74, v78
    v_add_f32 v75, v75, v79
    s_add_u32 s38, s37, 163840
    buffer_store_dwordx4 v[72:75], v8, s[16:19], s38 offen
    ds_read_b128 v[80:83], v13 offset:5120
    v_accvgpr_read_b32 v84, a20
    v_accvgpr_read_b32 v85, a21
    v_accvgpr_read_b32 v86, a22
    v_accvgpr_read_b32 v87, a23
    s_waitcnt lgkmcnt(0)
    v_add_f32 v80, v80, v84
    v_add_f32 v81, v81, v85
    v_add_f32 v82, v82, v86
    v_add_f32 v83, v83, v87
    s_add_u32 s38, s37, 204800
    buffer_store_dwordx4 v[80:83], v8, s[16:19], s38 offen
    ds_read_b128 v[40:43], v13 offset:6144
    v_accvgpr_read_b32 v44, a24
    v_accvgpr_read_b32 v45, a25
    v_accvgpr_read_b32 v46, a26
    v_accvgpr_read_b32 v47, a27
    s_waitcnt lgkmcnt(0)
    v_add_f32 v40, v40, v44
    v_add_f32 v41, v41, v45
    v_add_f32 v42, v42, v46
    v_add_f32 v43, v43, v47
    s_add_u32 s38, s37, 1024
    buffer_store_dwordx4 v[40:43], v8, s[16:19], s38 offen
    ds_read_b128 v[48:51], v13 offset:7168
    v_accvgpr_read_b32 v52, a28
    v_accvgpr_read_b32 v53, a29
    v_accvgpr_read_b32 v54, a30
    v_accvgpr_read_b32 v55, a31
    s_waitcnt lgkmcnt(0)
    v_add_f32 v48, v48, v52
    v_add_f32 v49, v49, v53
    v_add_f32 v50, v50, v54
    v_add_f32 v51, v51, v55
    s_add_u32 s38, s37, 41984
    buffer_store_dwordx4 v[48:51], v8, s[16:19], s38 offen
    ds_read_b128 v[56:59], v13 offset:8192
    v_accvgpr_read_b32 v60, a32
    v_accvgpr_read_b32 v61, a33
    v_accvgpr_read_b32 v62, a34
    v_accvgpr_read_b32 v63, a35
    s_waitcnt lgkmcnt(0)
    v_add_f32 v56, v56, v60
    v_add_f32 v57, v57, v61
    v_add_f32 v58, v58, v62
    v_add_f32 v59, v59, v63
    s_add_u32 s38, s37, 82944
    buffer_store_dwordx4 v[56:59], v8, s[16:19], s38 offen
    ds_read_b128 v[64:67], v13 offset:9216
    v_accvgpr_read_b32 v68, a36
    v_accvgpr_read_b32 v69, a37
    v_accvgpr_read_b32 v70, a38
    v_accvgpr_read_b32 v71, a39
    s_waitcnt lgkmcnt(0)
    v_add_f32 v64, v64, v68
    v_add_f32 v65, v65, v69
    v_add_f32 v66, v66, v70
    v_add_f32 v67, v67, v71
    s_add_u32 s38, s37, 123904
    buffer_store_dwordx4 v[64:67], v8, s[16:19], s38 offen
    ds_read_b128 v[72:75], v13 offset:10240
    v_accvgpr_read_b32 v76, a40
    v_accvgpr_read_b32 v77, a41
    v_accvgpr_read_b32 v78, a42
    v_accvgpr_read_b32 v79, a43
    s_waitcnt lgkmcnt(0)
    v_add_f32 v72, v72, v76
    v_add_f32 v73, v73, v77
    v_add_f32 v74, v74, v78
    v_add_f32 v75, v75, v79
    s_add_u32 s38, s37, 164864
    buffer_store_dwordx4 v[72:75], v8, s[16:19], s38 offen
    ds_read_b128 v[80:83], v13 offset:11264
    v_accvgpr_read_b32 v84, a44
    v_accvgpr_read_b32 v85, a45
    v_accvgpr_read_b32 v86, a46
    v_accvgpr_read_b32 v87, a47
    s_waitcnt lgkmcnt(0)
    v_add_f32 v80, v80, v84
    v_add_f32 v81, v81, v85
    v_add_f32 v82, v82, v86
    v_add_f32 v83, v83, v87
    s_add_u32 s38, s37, 205824
    buffer_store_dwordx4 v[80:83], v8, s[16:19], s38 offen
    ds_read_b128 v[40:43], v13 offset:12288
    v_accvgpr_read_b32 v44, a48
    v_accvgpr_read_b32 v45, a49
    v_accvgpr_read_b32 v46, a50
    v_accvgpr_read_b32 v47, a51
    s_waitcnt lgkmcnt(0)
    v_add_f32 v40, v40, v44
    v_add_f32 v41, v41, v45
    v_add_f32 v42, v42, v46
    v_add_f32 v43, v43, v47
    s_add_u32 s38, s37, 2048
    buffer_store_dwordx4 v[40:43], v8, s[16:19], s38 offen
    ds_read_b128 v[48:51], v13 offset:13312
    v_accvgpr_read_b32 v52, a52
    v_accvgpr_read_b32 v53, a53
    v_accvgpr_read_b32 v54, a54
    v_accvgpr_read_b32 v55, a55
    s_waitcnt lgkmcnt(0)
    v_add_f32 v48, v48, v52
    v_add_f32 v49, v49, v53
    v_add_f32 v50, v50, v54
    v_add_f32 v51, v51, v55
    s_add_u32 s38, s37, 43008
    buffer_store_dwordx4 v[48:51], v8, s[16:19], s38 offen
    ds_read_b128 v[56:59], v13 offset:14336
    v_accvgpr_read_b32 v60, a56
    v_accvgpr_read_b32 v61, a57
    v_accvgpr_read_b32 v62, a58
    v_accvgpr_read_b32 v63, a59
    s_waitcnt lgkmcnt(0)
    v_add_f32 v56, v56, v60
    v_add_f32 v57, v57, v61
    v_add_f32 v58, v58, v62
    v_add_f32 v59, v59, v63
    s_add_u32 s38, s37, 83968
    buffer_store_dwordx4 v[56:59], v8, s[16:19], s38 offen
    ds_read_b128 v[64:67], v13 offset:15360
    v_accvgpr_read_b32 v68, a60
    v_accvgpr_read_b32 v69, a61
    v_accvgpr_read_b32 v70, a62
    v_accvgpr_read_b32 v71, a63
    s_waitcnt lgkmcnt(0)
    v_add_f32 v64, v64, v68
    v_add_f32 v65, v65, v69
    v_add_f32 v66, v66, v70
    v_add_f32 v67, v67, v71
    s_add_u32 s38, s37, 124928
    buffer_store_dwordx4 v[64:67], v8, s[16:19], s38 offen
    ds_read_b128 v[72:75], v13 offset:16384
    v_accvgpr_read_b32 v76, a64
    v_accvgpr_read_b32 v77, a65
    v_accvgpr_read_b32 v78, a66
    v_accvgpr_read_b32 v79, a67
    s_waitcnt lgkmcnt(0)
    v_add_f32 v72, v72, v76
    v_add_f32 v73, v73, v77
    v_add_f32 v74, v74, v78
    v_add_f32 v75, v75, v79
    s_add_u32 s38, s37, 165888
    buffer_store_dwordx4 v[72:75], v8, s[16:19], s38 offen
    ds_read_b128 v[80:83], v13 offset:17408
    v_accvgpr_read_b32 v84, a68
    v_accvgpr_read_b32 v85, a69
    v_accvgpr_read_b32 v86, a70
    v_accvgpr_read_b32 v87, a71
    s_waitcnt lgkmcnt(0)
    v_add_f32 v80, v80, v84
    v_add_f32 v81, v81, v85
    v_add_f32 v82, v82, v86
    v_add_f32 v83, v83, v87
    s_add_u32 s38, s37, 206848
    buffer_store_dwordx4 v[80:83], v8, s[16:19], s38 offen
    ds_read_b128 v[40:43], v13 offset:18432
    v_accvgpr_read_b32 v44, a72
    v_accvgpr_read_b32 v45, a73
    v_accvgpr_read_b32 v46, a74
    v_accvgpr_read_b32 v47, a75
    s_waitcnt lgkmcnt(0)
    v_add_f32 v40, v40, v44
    v_add_f32 v41, v41, v45
    v_add_f32 v42, v42, v46
    v_add_f32 v43, v43, v47
    s_add_u32 s38, s37, 3072
    buffer_store_dwordx4 v[40:43], v8, s[16:19], s38 offen
    ds_read_b128 v[48:51], v13 offset:19456
    v_accvgpr_read_b32 v52, a76
    v_accvgpr_read_b32 v53, a77
    v_accvgpr_read_b32 v54, a78
    v_accvgpr_read_b32 v55, a79
    s_waitcnt lgkmcnt(0)
    v_add_f32 v48, v48, v52
    v_add_f32 v49, v49, v53
    v_add_f32 v50, v50, v54
    v_add_f32 v51, v51, v55
    s_add_u32 s38, s37, 44032
    buffer_store_dwordx4 v[48:51], v8, s[16:19], s38 offen
    ds_read_b128 v[56:59], v13 offset:20480
    v_accvgpr_read_b32 v60, a80
    v_accvgpr_read_b32 v61, a81
    v_accvgpr_read_b32 v62, a82
    v_accvgpr_read_b32 v63, a83
    s_waitcnt lgkmcnt(0)
    v_add_f32 v56, v56, v60
    v_add_f32 v57, v57, v61
    v_add_f32 v58, v58, v62
    v_add_f32 v59, v59, v63
    s_add_u32 s38, s37, 84992
    buffer_store_dwordx4 v[56:59], v8, s[16:19], s38 offen
    ds_read_b128 v[64:67], v13 offset:21504
    v_accvgpr_read_b32 v68, a84
    v_accvgpr_read_b32 v69, a85
    v_accvgpr_read_b32 v70, a86
    v_accvgpr_read_b32 v71, a87
    s_waitcnt lgkmcnt(0)
    v_add_f32 v64, v64, v68
    v_add_f32 v65, v65, v69
    v_add_f32 v66, v66, v70
    v_add_f32 v67, v67, v71
    s_add_u32 s38, s37, 125952
    buffer_store_dwordx4 v[64:67], v8, s[16:19], s38 offen
    ds_read_b128 v[72:75], v13 offset:22528
    v_accvgpr_read_b32 v76, a88
    v_accvgpr_read_b32 v77, a89
    v_accvgpr_read_b32 v78, a90
    v_accvgpr_read_b32 v79, a91
    s_waitcnt lgkmcnt(0)
    v_add_f32 v72, v72, v76
    v_add_f32 v73, v73, v77
    v_add_f32 v74, v74, v78
    v_add_f32 v75, v75, v79
    s_add_u32 s38, s37, 166912
    buffer_store_dwordx4 v[72:75], v8, s[16:19], s38 offen
    ds_read_b128 v[80:83], v13 offset:23552
    v_accvgpr_read_b32 v84, a92
    v_accvgpr_read_b32 v85, a93
    v_accvgpr_read_b32 v86, a94
    v_accvgpr_read_b32 v87, a95
    s_waitcnt lgkmcnt(0)
    v_add_f32 v80, v80, v84
    v_add_f32 v81, v81, v85
    v_add_f32 v82, v82, v86
    v_add_f32 v83, v83, v87
    s_add_u32 s38, s37, 207872
    buffer_store_dwordx4 v[80:83], v8, s[16:19], s38 offen
    ds_read_b128 v[40:43], v13 offset:24576
    v_accvgpr_read_b32 v44, a96
    v_accvgpr_read_b32 v45, a97
    v_accvgpr_read_b32 v46, a98
    v_accvgpr_read_b32 v47, a99
    s_waitcnt lgkmcnt(0)
    v_add_f32 v40, v40, v44
    v_add_f32 v41, v41, v45
    v_add_f32 v42, v42, v46
    v_add_f32 v43, v43, v47
    s_add_u32 s38, s37, 4096
    buffer_store_dwordx4 v[40:43], v8, s[16:19], s38 offen
    ds_read_b128 v[48:51], v13 offset:25600
    v_accvgpr_read_b32 v52, a100
    v_accvgpr_read_b32 v53, a101
    v_accvgpr_read_b32 v54, a102
    v_accvgpr_read_b32 v55, a103
    s_waitcnt lgkmcnt(0)
    v_add_f32 v48, v48, v52
    v_add_f32 v49, v49, v53
    v_add_f32 v50, v50, v54
    v_add_f32 v51, v51, v55
    s_add_u32 s38, s37, 45056
    buffer_store_dwordx4 v[48:51], v8, s[16:19], s38 offen
    ds_read_b128 v[56:59], v13 offset:26624
    v_accvgpr_read_b32 v60, a104
    v_accvgpr_read_b32 v61, a105
    v_accvgpr_read_b32 v62, a106
    v_accvgpr_read_b32 v63, a107
    s_waitcnt lgkmcnt(0)
    v_add_f32 v56, v56, v60
    v_add_f32 v57, v57, v61
    v_add_f32 v58, v58, v62
    v_add_f32 v59, v59, v63
    s_add_u32 s38, s37, 86016
    buffer_store_dwordx4 v[56:59], v8, s[16:19], s38 offen
    ds_read_b128 v[64:67], v13 offset:27648
    v_accvgpr_read_b32 v68, a108
    v_accvgpr_read_b32 v69, a109
    v_accvgpr_read_b32 v70, a110
    v_accvgpr_read_b32 v71, a111
    s_waitcnt lgkmcnt(0)
    v_add_f32 v64, v64, v68
    v_add_f32 v65, v65, v69
    v_add_f32 v66, v66, v70
    v_add_f32 v67, v67, v71
    s_add_u32 s38, s37, 126976
    buffer_store_dwordx4 v[64:67], v8, s[16:19], s38 offen
    ds_read_b128 v[72:75], v13 offset:28672
    v_accvgpr_read_b32 v76, a112
    v_accvgpr_read_b32 v77, a113
    v_accvgpr_read_b32 v78, a114
    v_accvgpr_read_b32 v79, a115
    s_waitcnt lgkmcnt(0)
    v_add_f32 v72, v72, v76
    v_add_f32 v73, v73, v77
    v_add_f32 v74, v74, v78
    v_add_f32 v75, v75, v79
    s_add_u32 s38, s37, 167936
    buffer_store_dwordx4 v[72:75], v8, s[16:19], s38 offen
    ds_read_b128 v[80:83], v13 offset:29696
    v_accvgpr_read_b32 v84, a116
    v_accvgpr_read_b32 v85, a117
    v_accvgpr_read_b32 v86, a118
    v_accvgpr_read_b32 v87, a119
    s_waitcnt lgkmcnt(0)
    v_add_f32 v80, v80, v84
    v_add_f32 v81, v81, v85
    v_add_f32 v82, v82, v86
    v_add_f32 v83, v83, v87
    s_add_u32 s38, s37, 208896
    buffer_store_dwordx4 v[80:83], v8, s[16:19], s38 offen
    s_waitcnt vmcnt(0)
L2_end:
    s_endpgm
.globl ored_kernel
.p2align 8
.type ored_kernel,@function
ored_kernel:
    s_cmp_ge_u32 s2, 960
    s_cbranch_scc1 L3_end
    s_load_dwordx2 s[20:21], s[0:1], 80
    s_load_dwordx2 s[22:23], s[0:1], 96
    v_lshrrev_b32 v1, 6, v0
    v_and_b32 v2, 63, v0
    v_readfirstlane_b32 s30, v1
    s_waitcnt lgkmcnt(0)
    s_mov_b32 s12, s22
    s_mov_b32 s13, s23
    s_mov_b32 s14, 98566144
    s_mov_b32 s15, 0x00020000
    s_mov_b32 s16, s20
    s_mov_b32 s17, s21
    s_mov_b32 s18, 3932160
    s_mov_b32 s19, 0x00020000
    s_lshl_b32 s31, s2, 2
    s_add_u32 s31, s31, s30
    s_lshl_b32 s31, s31, 1
    v_lshlrev_b32 v8, 4, v2
    s_lshl_b32 s32, s31, 10
    s_add_u32 s32, s32, 67108864
    s_add_u32 s33, s32, 0
    buffer_load_dwordx4 v[16:19], v8, s[12:15], s33 offen offset:0
    buffer_load_dwordx4 v[20:23], v8, s[12:15], s33 offen offset:1024
    s_add_u32 s33, s32, 7864320
    buffer_load_dwordx4 v[24:27], v8, s[12:15], s33 offen offset:0
    buffer_load_dwordx4 v[28:31], v8, s[12:15], s33 offen offset:1024
    s_add_u32 s33, s32, 15728640
    buffer_load_dwordx4 v[32:35], v8, s[12:15], s33 offen offset:0
    buffer_load_dwordx4 v[36:39], v8, s[12:15], s33 offen offset:1024
    s_add_u32 s33, s32, 23592960
    buffer_load_dwordx4 v[40:43], v8, s[12:15], s33 offen offset:0
    buffer_load_dwordx4 v[44:47], v8, s[12:15], s33 offen offset:1024
    s_mul_i32 s34, s31, 52429
    s_lshr_b32 s34, s34, 21
    s_mul_i32 s35, s34, 40
    s_sub_u32 s35, s31, s35
    s_cmp_ge_u32 s34, 96
    s_cselect_b32 s36, 1, 0
    s_mul_i32 s37, s36, 96
    s_sub_u32 s34, s34, s37
    s_mul_i32 s34, s34, 40960
    s_mul_i32 s36, s36, 1280
    s_add_u32 s34, s34, s36
    s_lshl_b32 s35, s35, 5
    s_add_u32 s34, s34, s35
    v_and_b32 v3, 15, v2
    v_lshrrev_b32 v4, 4, v2
    v_mul_u32_u24 v9, 2560, v3
    v_lshl_add_u32 v9, v4, 3, v9
    s_waitcnt vmcnt(5)
    v_add_f32 v16, v16, v24
    v_add_f32 v17, v17, v25
    v_add_f32 v18, v18, v26
    v_add_f32 v19, v19, v27
    s_waitcnt vmcnt(3)
    v_add_f32 v16, v16, v32
    v_add_f32 v17, v17, v33
    v_add_f32 v18, v18, v34
    v_add_f32 v19, v19, v35
    s_waitcnt vmcnt(1)
    v_add_f32 v16, v16, v40
    v_add_f32 v17, v17, v41
    v_add_f32 v18, v18, v42
    v_add_f32 v19, v19, v43
    v_cvt_pk_bf16_f32 v48, v16, v17
    v_cvt_pk_bf16_f32 v49, v18, v19
    buffer_store_dwordx2 v[48:49], v9, s[16:19], s34 offen offset:0
    v_add_f32 v20, v20, v28
    v_add_f32 v21, v21, v29
    v_add_f32 v22, v22, v30
    v_add_f32 v23, v23, v31
    v_add_f32 v20, v20, v36
    v_add_f32 v21, v21, v37
    v_add_f32 v22, v22, v38
    v_add_f32 v23, v23, v39
    s_waitcnt vmcnt(1)
    v_add_f32 v20, v20, v44
    v_add_f32 v21, v21, v45
    v_add_f32 v22, v22, v46
    v_add_f32 v23, v23, v47
    v_cvt_pk_bf16_f32 v50, v20, v21
    v_cvt_pk_bf16_f32 v51, v22, v23
    buffer_store_dwordx2 v[50:51], v9, s[16:19], s34 offen offset:32
    s_waitcnt vmcnt(0)
L3_end:
    s_endpgm
.section .rodata,"a"
.p2align 6
.amdhsa_kernel attn_kernel
  .amdhsa_next_free_vgpr 512
  .amdhsa_next_free_sgpr 96
  .amdhsa_accum_offset 256
  .amdhsa_group_segment_fixed_size 0
  .amdhsa_kernarg_size 104
  .amdhsa_user_sgpr_count 2
  .amdhsa_user_sgpr_kernarg_segment_ptr 1
  .amdhsa_system_sgpr_workgroup_id_x 1
.end_amdhsa_kernel
.p2align 6
.amdhsa_kernel oproj_kernel
  .amdhsa_next_free_vgpr 248
  .amdhsa_next_free_sgpr 64
  .amdhsa_accum_offset 128
  .amdhsa_group_segment_fixed_size 0
  .amdhsa_kernarg_size 104
  .amdhsa_user_sgpr_count 2
  .amdhsa_user_sgpr_kernarg_segment_ptr 1
  .amdhsa_system_sgpr_workgroup_id_x 1
.end_amdhsa_kernel
.p2align 6
.amdhsa_kernel ored_kernel
  .amdhsa_next_free_vgpr 56
  .amdhsa_next_free_sgpr 48
  .amdhsa_accum_offset 56
  .amdhsa_group_segment_fixed_size 0
  .amdhsa_kernarg_size 104
  .amdhsa_user_sgpr_count 2
  .amdhsa_user_sgpr_kernarg_segment_ptr 1
  .amdhsa_system_sgpr_workgroup_id_x 1
.end_amdhsa_kernel
```
